```python
import torch

def _softmax(x, axis=-1):
    return torch.softmax(x, dim=axis)
def _gelu(x):
    return torch.nn.functional.gelu(x, approximate="tanh")
def _silu(x):
    return torch.nn.functional.silu(x)
def _sigmoid(x):
    return torch.sigmoid(x)
def _layernorm(x, axis=-1, eps=1e-5):
    m = x.mean(dim=axis, keepdim=True)
    v = x.var(dim=axis, keepdim=True, unbiased=False)
    return (x - m) / torch.sqrt(v + eps)
def _scatter_add(tgt, idx, src, axis=0):
    return tgt.clone().index_add_(axis, idx, src)
def _segment_sum(src, seg, n):
    out = torch.zeros((n,) + src.shape[1:], dtype=src.dtype)
    return out.index_add_(0, seg, src)
def _pad(x, pw):
    flat = tuple(v for pair in reversed(pw) for v in pair)
    return torch.nn.functional.pad(x, flat)

kernel_name = 'interleave_layers__spectral_fnet__dense_activation_squared_relu__prompt'

def setup_inputs():

    _w = (lambda a: (lambda t: t.to(torch.bfloat16) if t.is_floating_point() else t)(torch.as_tensor(a)))
    def _A_setup():
        B, S, D = 1, 2048, 512
        ns = torch.arange(S)[:, None] * torch.arange(S)[None, :]
        nd = torch.arange(D)[:, None] * torch.arange(D)[None, :]
        Ws_re = torch.cos(-2.0 * torch.pi * ns / S).to(float)
        Ws_im = torch.sin(-2.0 * torch.pi * ns / S).to(float)
        Wd_re = torch.cos(-2.0 * torch.pi * nd / D).to(float)
        Wd_im = torch.sin(-2.0 * torch.pi * nd / D).to(float)
        return {
            "x": _w((lambda *s: torch.randn(*s, dtype=torch.bfloat16) * 0.05)(B, S, D)),
            "dft_seq_re": _w(Ws_re),
            "dft_seq_im": _w(Ws_im),
            "dft_hid_re": _w(Wd_re),
            "dft_hid_im": _w(Wd_im),
        }
    _A_in = _A_setup()

    def _B_setup():
        B, S, D, F = 1, 2048, 512, 1792
        return {
            "x": _w((lambda *s: torch.randn(*s, dtype=torch.bfloat16) * 0.05)(B, S, D)),
            "w1": _w((lambda *s: torch.randn(*s, dtype=torch.bfloat16) * 0.4)(D, F)),
            "b1": _w((lambda *s: torch.randn(*s, dtype=torch.bfloat16) * 0.4)(F)),
            "w2": _w((lambda *s: torch.randn(*s, dtype=torch.bfloat16) * 0.4)(F, D)),
            "b2": _w((lambda *s: torch.randn(*s, dtype=torch.bfloat16) * 0.4)(D)),
        }
    _B_in = _B_setup()

    return {
        "A_x": _A_in["x"],
        "A_dft_seq_re": _A_in["dft_seq_re"],
        "A_dft_seq_im": _A_in["dft_seq_im"],
        "A_dft_hid_re": _A_in["dft_hid_re"],
        "A_dft_hid_im": _A_in["dft_hid_im"],
        "B_x": _B_in["x"],
        "B_w1": _B_in["w1"],
        "B_b1": _B_in["b1"],
        "B_w2": _B_in["w2"],
        "B_b2": _B_in["b2"],
    }

def reference(A_x, A_dft_seq_re, A_dft_seq_im, A_dft_hid_re, A_dft_hid_im, B_x, B_w1, B_b1, B_w2, B_b2):
    def _A_ref(x, dft_seq_re, dft_seq_im, dft_hid_re, dft_hid_im):
        a = torch.einsum("bsd,ed->bse", x, dft_hid_re)
        b = torch.einsum("bsd,ed->bse", x, dft_hid_im)
        y = torch.einsum("ts,bse->bte", dft_seq_re, a) - torch.einsum("ts,bse->bte", dft_seq_im, b)
        return y

    def _B_ref(x, w1, b1, w2, b2):
        h = torch.einsum("bsd,df->bsf", x, w1) + b1
        zero = torch.zeros_like(h)
        r = torch.where(h > zero, h, zero)
        h = r * r
        out = torch.einsum("bsf,fd->bsd", h, w2) + b2
        return out

    x = A_x
    x = x + _A_ref(_layernorm(x, axis=-1), A_dft_seq_re, A_dft_seq_im, A_dft_hid_re, A_dft_hid_im)
    x = x + _B_ref(_layernorm(x, axis=-1), B_w1, B_b1, B_w2, B_b2)
    x = x + _A_ref(_layernorm(x, axis=-1), A_dft_seq_re, A_dft_seq_im, A_dft_hid_re, A_dft_hid_im)
    x = x + _B_ref(_layernorm(x, axis=-1), B_w1, B_b1, B_w2, B_b2)
    return x
```

```asm
; @launch kernel=k1a1_kernel grid=(480,1,1) block=(512,1,1) lds=131072
; @launch kernel=k2a2_kernel grid=(256,1,1) block=(256,1,1) lds=98304
; @launch kernel=k3b1_kernel grid=(224,1,1) block=(512,1,1) lds=65536
; @launch kernel=k4b2_kernel grid=(256,1,1) block=(256,1,1) lds=65536
; @launch kernel=k5a1_kernel grid=(256,1,1) block=(512,1,1) lds=131072
; @launch kernel=k6a2_kernel grid=(256,1,1) block=(256,1,1) lds=98304
; @launch kernel=k7b1_kernel grid=(224,1,1) block=(512,1,1) lds=65536
; @launch kernel=k8b2_kernel grid=(256,1,1) block=(256,1,1) lds=65536
.amdgcn_target "amdgcn-amd-amdhsa--gfx950"
.text
.globl k1a1_kernel
.p2align 8
.type k1a1_kernel,@function
k1a1_kernel:
    s_load_dwordx16 s[16:31], s[0:1], 0
    s_load_dwordx8 s[32:39], s[0:1], 64
    s_load_dwordx2 s[40:41], s[0:1], 96
    s_cmp_ge_u32 s2, 256
    s_cbranch_scc1 .tr_k1a1_kernel_2
    v_lshrrev_b32 v2, 6, v0
    v_and_b32 v1, 63, v0
    v_readfirstlane_b32 s3, v2
    s_and_b32 s5, s2, 7
    s_lshr_b32 s4, s2, 3
    v_lshrrev_b32 v2, 3, v1
    v_and_b32 v3, 7, v1
    v_lshlrev_b32 v4, 10, v2
    v_lshl_add_u32 v4, v3, 4, v4
    s_lshl_b32 s6, s3, 13
    v_add_u32 v22, s6, v4
    s_lshl_b32 s60, s4, 16
    s_waitcnt lgkmcnt(0)
    s_mov_b32 s44, s16
    s_mov_b32 s45, s17
    s_mov_b32 s46, 0x200000
    s_mov_b32 s47, 0x00020000
    buffer_load_dwordx4 v[88:91], v22, s[44:47], s60 offen offset:0
    buffer_load_dwordx4 v[92:95], v22, s[44:47], s60 offen offset:128
    buffer_load_dwordx4 v[96:99], v22, s[44:47], s60 offen offset:256
    buffer_load_dwordx4 v[100:103], v22, s[44:47], s60 offen offset:384
    buffer_load_dwordx4 v[104:107], v22, s[44:47], s60 offen offset:512
    buffer_load_dwordx4 v[108:111], v22, s[44:47], s60 offen offset:640
    buffer_load_dwordx4 v[112:115], v22, s[44:47], s60 offen offset:768
    buffer_load_dwordx4 v[116:119], v22, s[44:47], s60 offen offset:896
    s_cmp_ge_u32 s3, 4
    s_cbranch_scc1 .skipb_k1a1_kernel_3
    v_and_b32 v5, 15, v1
    v_lshrrev_b32 v6, 4, v1
    s_cmp_lt_u32 s5, 4
    s_cselect_b32 s48, s22, s24
    s_cselect_b32 s49, s23, s25
    s_mov_b32 s50, 0x80000
    s_mov_b32 s51, 0x00020000
    s_mov_b32 s52, s40
    s_mov_b32 s53, s41
    s_mov_b32 s54, 0x400000
    s_mov_b32 s55, 0x00020000
    s_and_b32 s6, s5, 3
    s_lshl_b32 s6, s6, 7
    s_lshl_b32 s7, s3, 5
    s_add_u32 s6, s6, s7
    s_lshl_b32 s61, s6, 10
    v_xor_b32 v7, v3, v6
    v_lshl_add_u32 v8, v7, 4, v4
    v_lshlrev_b32 v8, 10, v2
    v_lshl_add_u32 v9, v7, 4, v8
    v_xor_b32 v7, 4, v7
    v_lshl_add_u32 v8, v7, 4, v8
    v_add_u32 v10, 0x0, v9
    v_add_u32 v11, 0x2000, v8
    v_add_u32 v12, 0x4000, v9
    v_add_u32 v13, 0x6000, v8
    s_lshl_b32 s72, s3, 14
    s_add_u32 s72, s72, 0x10000
    v_lshrrev_b32 v7, 1, v5
    v_xor_b32 v7, v7, v6
    v_lshlrev_b32 v7, 4, v7
    v_and_b32 v8, 7, v5
    v_lshl_add_u32 v7, v8, 7, v7
    v_lshrrev_b32 v8, 3, v5
    v_lshl_add_u32 v7, v8, 10, v7
    v_add_u32 v14, s72, v7
    v_xor_b32 v15, 64, v14
    v_add_u32 v7, 0, v6
    v_xor_b32 v7, v7, v5
    v_lshlrev_b32 v7, 4, v7
    v_lshl_add_u32 v16, v5, 10, v7
    v_add_u32 v7, 4, v6
    v_xor_b32 v7, v7, v5
    v_lshlrev_b32 v7, 4, v7
    v_lshl_add_u32 v17, v5, 10, v7
    v_add_u32 v7, 8, v6
    v_xor_b32 v7, v7, v5
    v_lshlrev_b32 v7, 4, v7
    v_lshl_add_u32 v18, v5, 10, v7
    v_add_u32 v7, 12, v6
    v_xor_b32 v7, v7, v5
    v_lshlrev_b32 v7, 4, v7
    v_lshl_add_u32 v19, v5, 10, v7
.skipb_k1a1_kernel_3:
    v_xor_b32 v7, v3, v2
    v_lshlrev_b32 v7, 4, v7
    v_lshl_add_u32 v7, v2, 10, v7
    s_and_b32 s7, s3, 1
    s_lshl_b32 s7, s7, 7
    s_lshl_b32 s6, s3, 13
    s_add_u32 s8, s6, s7
    s_sub_u32 s9, s6, s7
    v_add_u32 v20, s8, v7
    v_add_u32 v21, s9, v7
    s_mov_b32 s8, 0x3f803f80
    v_mov_b32 v24, 0
    v_mov_b32 v25, 0
    v_mov_b32 v26, 0
    v_mov_b32 v27, 0
    s_waitcnt vmcnt(7)
    v_dot2c_f32_bf16 v24, s8, v88
    v_dot2c_f32_bf16 v25, s8, v89
    v_dot2c_f32_bf16 v26, s8, v90
    v_dot2c_f32_bf16 v27, s8, v91
    s_waitcnt vmcnt(6)
    v_dot2c_f32_bf16 v24, s8, v92
    v_dot2c_f32_bf16 v25, s8, v93
    v_dot2c_f32_bf16 v26, s8, v94
    v_dot2c_f32_bf16 v27, s8, v95
    s_waitcnt vmcnt(5)
    v_dot2c_f32_bf16 v24, s8, v96
    v_dot2c_f32_bf16 v25, s8, v97
    v_dot2c_f32_bf16 v26, s8, v98
    v_dot2c_f32_bf16 v27, s8, v99
    s_waitcnt vmcnt(4)
    v_dot2c_f32_bf16 v24, s8, v100
    v_dot2c_f32_bf16 v25, s8, v101
    v_dot2c_f32_bf16 v26, s8, v102
    v_dot2c_f32_bf16 v27, s8, v103
    s_waitcnt vmcnt(3)
    v_dot2c_f32_bf16 v24, s8, v104
    v_dot2c_f32_bf16 v25, s8, v105
    v_dot2c_f32_bf16 v26, s8, v106
    v_dot2c_f32_bf16 v27, s8, v107
    s_waitcnt vmcnt(2)
    v_dot2c_f32_bf16 v24, s8, v108
    v_dot2c_f32_bf16 v25, s8, v109
    v_dot2c_f32_bf16 v26, s8, v110
    v_dot2c_f32_bf16 v27, s8, v111
    s_waitcnt vmcnt(1)
    v_dot2c_f32_bf16 v24, s8, v112
    v_dot2c_f32_bf16 v25, s8, v113
    v_dot2c_f32_bf16 v26, s8, v114
    v_dot2c_f32_bf16 v27, s8, v115
    s_waitcnt vmcnt(0)
    v_dot2c_f32_bf16 v24, s8, v116
    v_dot2c_f32_bf16 v25, s8, v117
    v_dot2c_f32_bf16 v26, s8, v118
    v_dot2c_f32_bf16 v27, s8, v119
    s_nop 2
    s_cmp_ge_u32 s3, 4
    s_cbranch_scc1 .skip2_k1a1_kernel_4
    s_add_u32 m0, s72, 0x0
    s_nop 0
    buffer_load_dwordx4 v10, s[48:51], s61 offen lds
    s_add_u32 m0, s72, 0x400
    s_nop 0
    buffer_load_dwordx4 v11, s[48:51], s61 offen lds
    s_add_u32 m0, s72, 0x800
    s_nop 0
    buffer_load_dwordx4 v12, s[48:51], s61 offen lds
    s_add_u32 m0, s72, 0xc00
    s_nop 0
    buffer_load_dwordx4 v13, s[48:51], s61 offen lds
    s_add_u32 s61, s61, 0x80
    s_add_u32 m0, s72, 0x1000
    s_nop 0
    buffer_load_dwordx4 v10, s[48:51], s61 offen lds
    s_add_u32 m0, s72, 0x1400
    s_nop 0
    buffer_load_dwordx4 v11, s[48:51], s61 offen lds
    s_add_u32 m0, s72, 0x1800
    s_nop 0
    buffer_load_dwordx4 v12, s[48:51], s61 offen lds
    s_add_u32 m0, s72, 0x1c00
    s_nop 0
    buffer_load_dwordx4 v13, s[48:51], s61 offen lds
    s_add_u32 s61, s61, 0x80
    s_add_u32 m0, s72, 0x2000
    s_nop 0
    buffer_load_dwordx4 v10, s[48:51], s61 offen lds
    s_add_u32 m0, s72, 0x2400
    s_nop 0
    buffer_load_dwordx4 v11, s[48:51], s61 offen lds
    s_add_u32 m0, s72, 0x2800
    s_nop 0
    buffer_load_dwordx4 v12, s[48:51], s61 offen lds
    s_add_u32 m0, s72, 0x2c00
    s_nop 0
    buffer_load_dwordx4 v13, s[48:51], s61 offen lds
    s_add_u32 s61, s61, 0x80
    s_add_u32 m0, s72, 0x3000
    s_nop 0
    buffer_load_dwordx4 v10, s[48:51], s61 offen lds
    s_add_u32 m0, s72, 0x3400
    s_nop 0
    buffer_load_dwordx4 v11, s[48:51], s61 offen lds
    s_add_u32 m0, s72, 0x3800
    s_nop 0
    buffer_load_dwordx4 v12, s[48:51], s61 offen lds
    s_add_u32 m0, s72, 0x3c00
    s_nop 0
    buffer_load_dwordx4 v13, s[48:51], s61 offen lds
    s_add_u32 s61, s61, 0x80
.skip2_k1a1_kernel_4:
    v_add_f32 v24, v24, v25
    v_add_f32 v26, v26, v27
    v_add_f32 v24, v24, v26
    s_nop 1
    v_add_f32_dpp v25, v24, v24 quad_perm:[1,0,3,2] row_mask:0xf bank_mask:0xf
    s_nop 1
    v_add_f32_dpp v24, v25, v25 quad_perm:[2,3,0,1] row_mask:0xf bank_mask:0xf
    s_nop 1
    v_add_f32_dpp v25, v24, v24 row_half_mirror row_mask:0xf bank_mask:0xf
    v_mov_b32 v24, v25
    v_mul_f32 v28, 0x3b000000, v24
    v_sub_f32 v30, 0, v28
    v_sub_f32 v31, 0, v28
    v_mov_b32 v32, 0
    v_mov_b32 v33, 0
    v_mov_b32 v34, 0
    v_mov_b32 v35, 0
    v_lshlrev_b32 v120, 16, v88
    v_and_b32 v121, 0xffff0000, v88
    v_pk_add_f32 v[120:121], v[120:121], v[30:31]
    v_pk_fma_f32 v[32:33], v[120:121], v[120:121], v[32:33]
    v_lshlrev_b32 v122, 16, v89
    v_and_b32 v123, 0xffff0000, v89
    v_pk_add_f32 v[122:123], v[122:123], v[30:31]
    v_pk_fma_f32 v[34:35], v[122:123], v[122:123], v[34:35]
    v_lshlrev_b32 v124, 16, v90
    v_and_b32 v125, 0xffff0000, v90
    v_pk_add_f32 v[124:125], v[124:125], v[30:31]
    v_pk_fma_f32 v[32:33], v[124:125], v[124:125], v[32:33]
    v_lshlrev_b32 v126, 16, v91
    v_and_b32 v127, 0xffff0000, v91
    v_pk_add_f32 v[126:127], v[126:127], v[30:31]
    v_pk_fma_f32 v[34:35], v[126:127], v[126:127], v[34:35]
    v_lshlrev_b32 v128, 16, v92
    v_and_b32 v129, 0xffff0000, v92
    v_pk_add_f32 v[128:129], v[128:129], v[30:31]
    v_pk_fma_f32 v[32:33], v[128:129], v[128:129], v[32:33]
    v_lshlrev_b32 v130, 16, v93
    v_and_b32 v131, 0xffff0000, v93
    v_pk_add_f32 v[130:131], v[130:131], v[30:31]
    v_pk_fma_f32 v[34:35], v[130:131], v[130:131], v[34:35]
    v_lshlrev_b32 v132, 16, v94
    v_and_b32 v133, 0xffff0000, v94
    v_pk_add_f32 v[132:133], v[132:133], v[30:31]
    v_pk_fma_f32 v[32:33], v[132:133], v[132:133], v[32:33]
    v_lshlrev_b32 v134, 16, v95
    v_and_b32 v135, 0xffff0000, v95
    v_pk_add_f32 v[134:135], v[134:135], v[30:31]
    v_pk_fma_f32 v[34:35], v[134:135], v[134:135], v[34:35]
    v_lshlrev_b32 v136, 16, v96
    v_and_b32 v137, 0xffff0000, v96
    v_pk_add_f32 v[136:137], v[136:137], v[30:31]
    v_pk_fma_f32 v[32:33], v[136:137], v[136:137], v[32:33]
    v_lshlrev_b32 v138, 16, v97
    v_and_b32 v139, 0xffff0000, v97
    v_pk_add_f32 v[138:139], v[138:139], v[30:31]
    v_pk_fma_f32 v[34:35], v[138:139], v[138:139], v[34:35]
    v_lshlrev_b32 v140, 16, v98
    v_and_b32 v141, 0xffff0000, v98
    v_pk_add_f32 v[140:141], v[140:141], v[30:31]
    v_pk_fma_f32 v[32:33], v[140:141], v[140:141], v[32:33]
    v_lshlrev_b32 v142, 16, v99
    v_and_b32 v143, 0xffff0000, v99
    v_pk_add_f32 v[142:143], v[142:143], v[30:31]
    v_pk_fma_f32 v[34:35], v[142:143], v[142:143], v[34:35]
    v_lshlrev_b32 v144, 16, v100
    v_and_b32 v145, 0xffff0000, v100
    v_pk_add_f32 v[144:145], v[144:145], v[30:31]
    v_pk_fma_f32 v[32:33], v[144:145], v[144:145], v[32:33]
    v_lshlrev_b32 v146, 16, v101
    v_and_b32 v147, 0xffff0000, v101
    v_pk_add_f32 v[146:147], v[146:147], v[30:31]
    v_pk_fma_f32 v[34:35], v[146:147], v[146:147], v[34:35]
    v_lshlrev_b32 v148, 16, v102
    v_and_b32 v149, 0xffff0000, v102
    v_pk_add_f32 v[148:149], v[148:149], v[30:31]
    v_pk_fma_f32 v[32:33], v[148:149], v[148:149], v[32:33]
    v_lshlrev_b32 v150, 16, v103
    v_and_b32 v151, 0xffff0000, v103
    v_pk_add_f32 v[150:151], v[150:151], v[30:31]
    v_pk_fma_f32 v[34:35], v[150:151], v[150:151], v[34:35]
    v_lshlrev_b32 v152, 16, v104
    v_and_b32 v153, 0xffff0000, v104
    v_pk_add_f32 v[152:153], v[152:153], v[30:31]
    v_pk_fma_f32 v[32:33], v[152:153], v[152:153], v[32:33]
    v_lshlrev_b32 v154, 16, v105
    v_and_b32 v155, 0xffff0000, v105
    v_pk_add_f32 v[154:155], v[154:155], v[30:31]
    v_pk_fma_f32 v[34:35], v[154:155], v[154:155], v[34:35]
    v_lshlrev_b32 v156, 16, v106
    v_and_b32 v157, 0xffff0000, v106
    v_pk_add_f32 v[156:157], v[156:157], v[30:31]
    v_pk_fma_f32 v[32:33], v[156:157], v[156:157], v[32:33]
    v_lshlrev_b32 v158, 16, v107
    v_and_b32 v159, 0xffff0000, v107
    v_pk_add_f32 v[158:159], v[158:159], v[30:31]
    v_pk_fma_f32 v[34:35], v[158:159], v[158:159], v[34:35]
    v_lshlrev_b32 v160, 16, v108
    v_and_b32 v161, 0xffff0000, v108
    v_pk_add_f32 v[160:161], v[160:161], v[30:31]
    v_pk_fma_f32 v[32:33], v[160:161], v[160:161], v[32:33]
    v_lshlrev_b32 v162, 16, v109
    v_and_b32 v163, 0xffff0000, v109
    v_pk_add_f32 v[162:163], v[162:163], v[30:31]
    v_pk_fma_f32 v[34:35], v[162:163], v[162:163], v[34:35]
    v_lshlrev_b32 v164, 16, v110
    v_and_b32 v165, 0xffff0000, v110
    v_pk_add_f32 v[164:165], v[164:165], v[30:31]
    v_pk_fma_f32 v[32:33], v[164:165], v[164:165], v[32:33]
    v_lshlrev_b32 v166, 16, v111
    v_and_b32 v167, 0xffff0000, v111
    v_pk_add_f32 v[166:167], v[166:167], v[30:31]
    v_pk_fma_f32 v[34:35], v[166:167], v[166:167], v[34:35]
    v_lshlrev_b32 v168, 16, v112
    v_and_b32 v169, 0xffff0000, v112
    v_pk_add_f32 v[168:169], v[168:169], v[30:31]
    v_pk_fma_f32 v[32:33], v[168:169], v[168:169], v[32:33]
    v_lshlrev_b32 v170, 16, v113
    v_and_b32 v171, 0xffff0000, v113
    v_pk_add_f32 v[170:171], v[170:171], v[30:31]
    v_pk_fma_f32 v[34:35], v[170:171], v[170:171], v[34:35]
    v_lshlrev_b32 v172, 16, v114
    v_and_b32 v173, 0xffff0000, v114
    v_pk_add_f32 v[172:173], v[172:173], v[30:31]
    v_pk_fma_f32 v[32:33], v[172:173], v[172:173], v[32:33]
    v_lshlrev_b32 v174, 16, v115
    v_and_b32 v175, 0xffff0000, v115
    v_pk_add_f32 v[174:175], v[174:175], v[30:31]
    v_pk_fma_f32 v[34:35], v[174:175], v[174:175], v[34:35]
    v_lshlrev_b32 v176, 16, v116
    v_and_b32 v177, 0xffff0000, v116
    v_pk_add_f32 v[176:177], v[176:177], v[30:31]
    v_pk_fma_f32 v[32:33], v[176:177], v[176:177], v[32:33]
    v_lshlrev_b32 v178, 16, v117
    v_and_b32 v179, 0xffff0000, v117
    v_pk_add_f32 v[178:179], v[178:179], v[30:31]
    v_pk_fma_f32 v[34:35], v[178:179], v[178:179], v[34:35]
    v_lshlrev_b32 v180, 16, v118
    v_and_b32 v181, 0xffff0000, v118
    v_pk_add_f32 v[180:181], v[180:181], v[30:31]
    v_pk_fma_f32 v[32:33], v[180:181], v[180:181], v[32:33]
    v_lshlrev_b32 v182, 16, v119
    v_and_b32 v183, 0xffff0000, v119
    v_pk_add_f32 v[182:183], v[182:183], v[30:31]
    v_pk_fma_f32 v[34:35], v[182:183], v[182:183], v[34:35]
    v_add_f32 v32, v32, v33
    v_add_f32 v34, v34, v35
    v_add_f32 v32, v32, v34
    s_nop 1
    v_add_f32_dpp v33, v32, v32 quad_perm:[1,0,3,2] row_mask:0xf bank_mask:0xf
    s_nop 1
    v_add_f32_dpp v32, v33, v33 quad_perm:[2,3,0,1] row_mask:0xf bank_mask:0xf
    s_nop 1
    v_add_f32_dpp v33, v32, v32 row_half_mirror row_mask:0xf bank_mask:0xf
    v_mov_b32 v32, v33
    v_mul_f32 v32, 0x3b000000, v32
    v_cvt_pk_bf16_f32 v33, v32, v28
    v_lshlrev_b32 v34, 16, v33
    v_and_b32 v35, 0xffff0000, v33
    v_add_f32 v34, 0x3727c5ac, v34
    v_cvt_pk_bf16_f32 v33, v34, v34
    v_lshlrev_b32 v34, 16, v33
    v_sqrt_f32 v34, v34
    s_nop 0
    v_cvt_pk_bf16_f32 v33, v34, v34
    v_lshlrev_b32 v34, 16, v33
    v_rcp_f32 v30, v34
    s_nop 0
    v_mov_b32 v31, v30
    v_sub_f32 v36, v28, v35
    v_mul_f32 v36, v36, v30
    v_mov_b32 v37, v36
    v_pk_fma_f32 v[120:121], v[120:121], v[30:31], v[36:37]
    v_cvt_pk_bf16_f32 v88, v120, v121
    v_pk_fma_f32 v[122:123], v[122:123], v[30:31], v[36:37]
    v_cvt_pk_bf16_f32 v89, v122, v123
    v_pk_fma_f32 v[124:125], v[124:125], v[30:31], v[36:37]
    v_cvt_pk_bf16_f32 v90, v124, v125
    v_pk_fma_f32 v[126:127], v[126:127], v[30:31], v[36:37]
    v_cvt_pk_bf16_f32 v91, v126, v127
    s_nop 0
    ds_write_b128 v20, v[88:91] offset:0
    v_pk_fma_f32 v[128:129], v[128:129], v[30:31], v[36:37]
    v_cvt_pk_bf16_f32 v92, v128, v129
    v_pk_fma_f32 v[130:131], v[130:131], v[30:31], v[36:37]
    v_cvt_pk_bf16_f32 v93, v130, v131
    v_pk_fma_f32 v[132:133], v[132:133], v[30:31], v[36:37]
    v_cvt_pk_bf16_f32 v94, v132, v133
    v_pk_fma_f32 v[134:135], v[134:135], v[30:31], v[36:37]
    v_cvt_pk_bf16_f32 v95, v134, v135
    s_nop 0
    ds_write_b128 v21, v[92:95] offset:128
    v_pk_fma_f32 v[136:137], v[136:137], v[30:31], v[36:37]
    v_cvt_pk_bf16_f32 v96, v136, v137
    v_pk_fma_f32 v[138:139], v[138:139], v[30:31], v[36:37]
    v_cvt_pk_bf16_f32 v97, v138, v139
    v_pk_fma_f32 v[140:141], v[140:141], v[30:31], v[36:37]
    v_cvt_pk_bf16_f32 v98, v140, v141
    v_pk_fma_f32 v[142:143], v[142:143], v[30:31], v[36:37]
    v_cvt_pk_bf16_f32 v99, v142, v143
    s_nop 0
    ds_write_b128 v20, v[96:99] offset:256
    v_pk_fma_f32 v[144:145], v[144:145], v[30:31], v[36:37]
    v_cvt_pk_bf16_f32 v100, v144, v145
    v_pk_fma_f32 v[146:147], v[146:147], v[30:31], v[36:37]
    v_cvt_pk_bf16_f32 v101, v146, v147
    v_pk_fma_f32 v[148:149], v[148:149], v[30:31], v[36:37]
    v_cvt_pk_bf16_f32 v102, v148, v149
    v_pk_fma_f32 v[150:151], v[150:151], v[30:31], v[36:37]
    v_cvt_pk_bf16_f32 v103, v150, v151
    s_nop 0
    ds_write_b128 v21, v[100:103] offset:384
    v_pk_fma_f32 v[152:153], v[152:153], v[30:31], v[36:37]
    v_cvt_pk_bf16_f32 v104, v152, v153
    v_pk_fma_f32 v[154:155], v[154:155], v[30:31], v[36:37]
    v_cvt_pk_bf16_f32 v105, v154, v155
    v_pk_fma_f32 v[156:157], v[156:157], v[30:31], v[36:37]
    v_cvt_pk_bf16_f32 v106, v156, v157
    v_pk_fma_f32 v[158:159], v[158:159], v[30:31], v[36:37]
    v_cvt_pk_bf16_f32 v107, v158, v159
    s_nop 0
    ds_write_b128 v20, v[104:107] offset:512
    v_pk_fma_f32 v[160:161], v[160:161], v[30:31], v[36:37]
    v_cvt_pk_bf16_f32 v108, v160, v161
    v_pk_fma_f32 v[162:163], v[162:163], v[30:31], v[36:37]
    v_cvt_pk_bf16_f32 v109, v162, v163
    v_pk_fma_f32 v[164:165], v[164:165], v[30:31], v[36:37]
    v_cvt_pk_bf16_f32 v110, v164, v165
    v_pk_fma_f32 v[166:167], v[166:167], v[30:31], v[36:37]
    v_cvt_pk_bf16_f32 v111, v166, v167
    s_nop 0
    ds_write_b128 v21, v[108:111] offset:640
    v_pk_fma_f32 v[168:169], v[168:169], v[30:31], v[36:37]
    v_cvt_pk_bf16_f32 v112, v168, v169
    v_pk_fma_f32 v[170:171], v[170:171], v[30:31], v[36:37]
    v_cvt_pk_bf16_f32 v113, v170, v171
    v_pk_fma_f32 v[172:173], v[172:173], v[30:31], v[36:37]
    v_cvt_pk_bf16_f32 v114, v172, v173
    v_pk_fma_f32 v[174:175], v[174:175], v[30:31], v[36:37]
    v_cvt_pk_bf16_f32 v115, v174, v175
    s_nop 0
    ds_write_b128 v20, v[112:115] offset:768
    v_pk_fma_f32 v[176:177], v[176:177], v[30:31], v[36:37]
    v_cvt_pk_bf16_f32 v116, v176, v177
    v_pk_fma_f32 v[178:179], v[178:179], v[30:31], v[36:37]
    v_cvt_pk_bf16_f32 v117, v178, v179
    v_pk_fma_f32 v[180:181], v[180:181], v[30:31], v[36:37]
    v_cvt_pk_bf16_f32 v118, v180, v181
    v_pk_fma_f32 v[182:183], v[182:183], v[30:31], v[36:37]
    v_cvt_pk_bf16_f32 v119, v182, v183
    s_nop 0
    ds_write_b128 v21, v[116:119] offset:896
    s_waitcnt lgkmcnt(0)
    s_barrier
    s_cmp_ge_u32 s3, 4
    s_cbranch_scc1 .end_k1a1_kernel_1
    ds_read_b128 v[88:91], v16 offset:0
    ds_read_b128 v[92:95], v16 offset:16384
    ds_read_b128 v[96:99], v16 offset:32768
    ds_read_b128 v[100:103], v16 offset:49152
    s_waitcnt vmcnt(12)
    ds_read_b128 v[40:43], v14 offset:0
    ds_read_b128 v[44:47], v14 offset:2048
    ds_read_b128 v[104:107], v17 offset:0
    ds_read_b128 v[108:111], v17 offset:16384
    ds_read_b128 v[112:115], v17 offset:32768
    ds_read_b128 v[116:119], v17 offset:49152
    ds_read_b128 v[48:51], v15 offset:0
    ds_read_b128 v[52:55], v15 offset:2048
    s_waitcnt lgkmcnt(6)
    v_mfma_f32_16x16x32_bf16 a[0:3], v[88:91], v[40:43], 0
    v_mfma_f32_16x16x32_bf16 a[4:7], v[92:95], v[40:43], 0
    v_mfma_f32_16x16x32_bf16 a[8:11], v[96:99], v[40:43], 0
    v_mfma_f32_16x16x32_bf16 a[12:15], v[100:103], v[40:43], 0
    v_mfma_f32_16x16x32_bf16 a[16:19], v[88:91], v[44:47], 0
    v_mfma_f32_16x16x32_bf16 a[20:23], v[92:95], v[44:47], 0
    v_mfma_f32_16x16x32_bf16 a[24:27], v[96:99], v[44:47], 0
    v_mfma_f32_16x16x32_bf16 a[28:31], v[100:103], v[44:47], 0
    ds_read_b128 v[88:91], v18 offset:0
    ds_read_b128 v[92:95], v18 offset:16384
    ds_read_b128 v[96:99], v18 offset:32768
    ds_read_b128 v[100:103], v18 offset:49152
    s_waitcnt vmcnt(8)
    ds_read_b128 v[40:43], v14 offset:4096
    ds_read_b128 v[44:47], v14 offset:6144
    s_waitcnt lgkmcnt(6)
    v_mfma_f32_16x16x32_bf16 a[0:3], v[104:107], v[48:51], a[0:3]
    v_mfma_f32_16x16x32_bf16 a[4:7], v[108:111], v[48:51], a[4:7]
    v_mfma_f32_16x16x32_bf16 a[8:11], v[112:115], v[48:51], a[8:11]
    v_mfma_f32_16x16x32_bf16 a[12:15], v[116:119], v[48:51], a[12:15]
    v_mfma_f32_16x16x32_bf16 a[16:19], v[104:107], v[52:55], a[16:19]
    v_mfma_f32_16x16x32_bf16 a[20:23], v[108:111], v[52:55], a[20:23]
    v_mfma_f32_16x16x32_bf16 a[24:27], v[112:115], v[52:55], a[24:27]
    v_mfma_f32_16x16x32_bf16 a[28:31], v[116:119], v[52:55], a[28:31]
    s_add_u32 m0, s72, 0x0
    s_nop 0
    buffer_load_dwordx4 v10, s[48:51], s61 offen lds
    s_add_u32 m0, s72, 0x400
    s_nop 0
    buffer_load_dwordx4 v11, s[48:51], s61 offen lds
    s_add_u32 m0, s72, 0x800
    s_nop 0
    buffer_load_dwordx4 v12, s[48:51], s61 offen lds
    s_add_u32 m0, s72, 0xc00
    s_nop 0
    buffer_load_dwordx4 v13, s[48:51], s61 offen lds
    s_add_u32 s61, s61, 0x80
    ds_read_b128 v[104:107], v19 offset:0
    ds_read_b128 v[108:111], v19 offset:16384
    ds_read_b128 v[112:115], v19 offset:32768
    ds_read_b128 v[116:119], v19 offset:49152
    ds_read_b128 v[48:51], v15 offset:4096
    ds_read_b128 v[52:55], v15 offset:6144
    s_waitcnt lgkmcnt(6)
    v_mfma_f32_16x16x32_bf16 a[0:3], v[88:91], v[40:43], a[0:3]
    v_mfma_f32_16x16x32_bf16 a[4:7], v[92:95], v[40:43], a[4:7]
    v_mfma_f32_16x16x32_bf16 a[8:11], v[96:99], v[40:43], a[8:11]
    v_mfma_f32_16x16x32_bf16 a[12:15], v[100:103], v[40:43], a[12:15]
    v_mfma_f32_16x16x32_bf16 a[16:19], v[88:91], v[44:47], a[16:19]
    v_mfma_f32_16x16x32_bf16 a[20:23], v[92:95], v[44:47], a[20:23]
    v_mfma_f32_16x16x32_bf16 a[24:27], v[96:99], v[44:47], a[24:27]
    v_mfma_f32_16x16x32_bf16 a[28:31], v[100:103], v[44:47], a[28:31]
    ds_read_b128 v[88:91], v16 offset:256
    ds_read_b128 v[92:95], v16 offset:16640
    ds_read_b128 v[96:99], v16 offset:33024
    ds_read_b128 v[100:103], v16 offset:49408
    s_waitcnt vmcnt(8)
    ds_read_b128 v[40:43], v14 offset:8192
    ds_read_b128 v[44:47], v14 offset:10240
    s_waitcnt lgkmcnt(6)
    v_mfma_f32_16x16x32_bf16 a[0:3], v[104:107], v[48:51], a[0:3]
    v_mfma_f32_16x16x32_bf16 a[4:7], v[108:111], v[48:51], a[4:7]
    v_mfma_f32_16x16x32_bf16 a[8:11], v[112:115], v[48:51], a[8:11]
    v_mfma_f32_16x16x32_bf16 a[12:15], v[116:119], v[48:51], a[12:15]
    v_mfma_f32_16x16x32_bf16 a[16:19], v[104:107], v[52:55], a[16:19]
    v_mfma_f32_16x16x32_bf16 a[20:23], v[108:111], v[52:55], a[20:23]
    v_mfma_f32_16x16x32_bf16 a[24:27], v[112:115], v[52:55], a[24:27]
    v_mfma_f32_16x16x32_bf16 a[28:31], v[116:119], v[52:55], a[28:31]
    s_add_u32 m0, s72, 0x1000
    s_nop 0
    buffer_load_dwordx4 v10, s[48:51], s61 offen lds
    s_add_u32 m0, s72, 0x1400
    s_nop 0
    buffer_load_dwordx4 v11, s[48:51], s61 offen lds
    s_add_u32 m0, s72, 0x1800
    s_nop 0
    buffer_load_dwordx4 v12, s[48:51], s61 offen lds
    s_add_u32 m0, s72, 0x1c00
    s_nop 0
    buffer_load_dwordx4 v13, s[48:51], s61 offen lds
    s_add_u32 s61, s61, 0x80
    ds_read_b128 v[104:107], v17 offset:256
    ds_read_b128 v[108:111], v17 offset:16640
    ds_read_b128 v[112:115], v17 offset:33024
    ds_read_b128 v[116:119], v17 offset:49408
    ds_read_b128 v[48:51], v15 offset:8192
    ds_read_b128 v[52:55], v15 offset:10240
    s_waitcnt lgkmcnt(6)
    v_mfma_f32_16x16x32_bf16 a[0:3], v[88:91], v[40:43], a[0:3]
    v_mfma_f32_16x16x32_bf16 a[4:7], v[92:95], v[40:43], a[4:7]
    v_mfma_f32_16x16x32_bf16 a[8:11], v[96:99], v[40:43], a[8:11]
    v_mfma_f32_16x16x32_bf16 a[12:15], v[100:103], v[40:43], a[12:15]
    v_mfma_f32_16x16x32_bf16 a[16:19], v[88:91], v[44:47], a[16:19]
    v_mfma_f32_16x16x32_bf16 a[20:23], v[92:95], v[44:47], a[20:23]
    v_mfma_f32_16x16x32_bf16 a[24:27], v[96:99], v[44:47], a[24:27]
    v_mfma_f32_16x16x32_bf16 a[28:31], v[100:103], v[44:47], a[28:31]
    ds_read_b128 v[88:91], v18 offset:256
    ds_read_b128 v[92:95], v18 offset:16640
    ds_read_b128 v[96:99], v18 offset:33024
    ds_read_b128 v[100:103], v18 offset:49408
    s_waitcnt vmcnt(8)
    ds_read_b128 v[40:43], v14 offset:12288
    ds_read_b128 v[44:47], v14 offset:14336
    s_waitcnt lgkmcnt(6)
    v_mfma_f32_16x16x32_bf16 a[0:3], v[104:107], v[48:51], a[0:3]
    v_mfma_f32_16x16x32_bf16 a[4:7], v[108:111], v[48:51], a[4:7]
    v_mfma_f32_16x16x32_bf16 a[8:11], v[112:115], v[48:51], a[8:11]
    v_mfma_f32_16x16x32_bf16 a[12:15], v[116:119], v[48:51], a[12:15]
    v_mfma_f32_16x16x32_bf16 a[16:19], v[104:107], v[52:55], a[16:19]
    v_mfma_f32_16x16x32_bf16 a[20:23], v[108:111], v[52:55], a[20:23]
    v_mfma_f32_16x16x32_bf16 a[24:27], v[112:115], v[52:55], a[24:27]
    v_mfma_f32_16x16x32_bf16 a[28:31], v[116:119], v[52:55], a[28:31]
    s_add_u32 m0, s72, 0x2000
    s_nop 0
    buffer_load_dwordx4 v10, s[48:51], s61 offen lds
    s_add_u32 m0, s72, 0x2400
    s_nop 0
    buffer_load_dwordx4 v11, s[48:51], s61 offen lds
    s_add_u32 m0, s72, 0x2800
    s_nop 0
    buffer_load_dwordx4 v12, s[48:51], s61 offen lds
    s_add_u32 m0, s72, 0x2c00
    s_nop 0
    buffer_load_dwordx4 v13, s[48:51], s61 offen lds
    s_add_u32 s61, s61, 0x80
    ds_read_b128 v[104:107], v19 offset:256
    ds_read_b128 v[108:111], v19 offset:16640
    ds_read_b128 v[112:115], v19 offset:33024
    ds_read_b128 v[116:119], v19 offset:49408
    ds_read_b128 v[48:51], v15 offset:12288
    ds_read_b128 v[52:55], v15 offset:14336
    s_waitcnt lgkmcnt(6)
    v_mfma_f32_16x16x32_bf16 a[0:3], v[88:91], v[40:43], a[0:3]
    v_mfma_f32_16x16x32_bf16 a[4:7], v[92:95], v[40:43], a[4:7]
    v_mfma_f32_16x16x32_bf16 a[8:11], v[96:99], v[40:43], a[8:11]
    v_mfma_f32_16x16x32_bf16 a[12:15], v[100:103], v[40:43], a[12:15]
    v_mfma_f32_16x16x32_bf16 a[16:19], v[88:91], v[44:47], a[16:19]
    v_mfma_f32_16x16x32_bf16 a[20:23], v[92:95], v[44:47], a[20:23]
    v_mfma_f32_16x16x32_bf16 a[24:27], v[96:99], v[44:47], a[24:27]
    v_mfma_f32_16x16x32_bf16 a[28:31], v[100:103], v[44:47], a[28:31]
    ds_read_b128 v[88:91], v16 offset:512
    ds_read_b128 v[92:95], v16 offset:16896
    ds_read_b128 v[96:99], v16 offset:33280
    ds_read_b128 v[100:103], v16 offset:49664
    s_waitcnt vmcnt(8)
    ds_read_b128 v[40:43], v14 offset:0
    ds_read_b128 v[44:47], v14 offset:2048
    s_waitcnt lgkmcnt(6)
    v_mfma_f32_16x16x32_bf16 a[0:3], v[104:107], v[48:51], a[0:3]
    v_mfma_f32_16x16x32_bf16 a[4:7], v[108:111], v[48:51], a[4:7]
    v_mfma_f32_16x16x32_bf16 a[8:11], v[112:115], v[48:51], a[8:11]
    v_mfma_f32_16x16x32_bf16 a[12:15], v[116:119], v[48:51], a[12:15]
    v_mfma_f32_16x16x32_bf16 a[16:19], v[104:107], v[52:55], a[16:19]
    v_mfma_f32_16x16x32_bf16 a[20:23], v[108:111], v[52:55], a[20:23]
    v_mfma_f32_16x16x32_bf16 a[24:27], v[112:115], v[52:55], a[24:27]
    v_mfma_f32_16x16x32_bf16 a[28:31], v[116:119], v[52:55], a[28:31]
    s_add_u32 m0, s72, 0x3000
    s_nop 0
    buffer_load_dwordx4 v10, s[48:51], s61 offen lds
    s_add_u32 m0, s72, 0x3400
    s_nop 0
    buffer_load_dwordx4 v11, s[48:51], s61 offen lds
    s_add_u32 m0, s72, 0x3800
    s_nop 0
    buffer_load_dwordx4 v12, s[48:51], s61 offen lds
    s_add_u32 m0, s72, 0x3c00
    s_nop 0
    buffer_load_dwordx4 v13, s[48:51], s61 offen lds
    s_add_u32 s61, s61, 0x80
    ds_read_b128 v[104:107], v17 offset:512
    ds_read_b128 v[108:111], v17 offset:16896
    ds_read_b128 v[112:115], v17 offset:33280
    ds_read_b128 v[116:119], v17 offset:49664
    ds_read_b128 v[48:51], v15 offset:0
    ds_read_b128 v[52:55], v15 offset:2048
    s_waitcnt lgkmcnt(6)
    v_mfma_f32_16x16x32_bf16 a[0:3], v[88:91], v[40:43], a[0:3]
    v_mfma_f32_16x16x32_bf16 a[4:7], v[92:95], v[40:43], a[4:7]
    v_mfma_f32_16x16x32_bf16 a[8:11], v[96:99], v[40:43], a[8:11]
    v_mfma_f32_16x16x32_bf16 a[12:15], v[100:103], v[40:43], a[12:15]
    v_mfma_f32_16x16x32_bf16 a[16:19], v[88:91], v[44:47], a[16:19]
    v_mfma_f32_16x16x32_bf16 a[20:23], v[92:95], v[44:47], a[20:23]
    v_mfma_f32_16x16x32_bf16 a[24:27], v[96:99], v[44:47], a[24:27]
    v_mfma_f32_16x16x32_bf16 a[28:31], v[100:103], v[44:47], a[28:31]
    ds_read_b128 v[88:91], v18 offset:512
    ds_read_b128 v[92:95], v18 offset:16896
    ds_read_b128 v[96:99], v18 offset:33280
    ds_read_b128 v[100:103], v18 offset:49664
    s_waitcnt vmcnt(8)
    ds_read_b128 v[40:43], v14 offset:4096
    ds_read_b128 v[44:47], v14 offset:6144
    s_waitcnt lgkmcnt(6)
    v_mfma_f32_16x16x32_bf16 a[0:3], v[104:107], v[48:51], a[0:3]
    v_mfma_f32_16x16x32_bf16 a[4:7], v[108:111], v[48:51], a[4:7]
    v_mfma_f32_16x16x32_bf16 a[8:11], v[112:115], v[48:51], a[8:11]
    v_mfma_f32_16x16x32_bf16 a[12:15], v[116:119], v[48:51], a[12:15]
    v_mfma_f32_16x16x32_bf16 a[16:19], v[104:107], v[52:55], a[16:19]
    v_mfma_f32_16x16x32_bf16 a[20:23], v[108:111], v[52:55], a[20:23]
    v_mfma_f32_16x16x32_bf16 a[24:27], v[112:115], v[52:55], a[24:27]
    v_mfma_f32_16x16x32_bf16 a[28:31], v[116:119], v[52:55], a[28:31]
    ds_read_b128 v[104:107], v19 offset:512
    ds_read_b128 v[108:111], v19 offset:16896
    ds_read_b128 v[112:115], v19 offset:33280
    ds_read_b128 v[116:119], v19 offset:49664
    ds_read_b128 v[48:51], v15 offset:4096
    ds_read_b128 v[52:55], v15 offset:6144
    s_waitcnt lgkmcnt(6)
    v_mfma_f32_16x16x32_bf16 a[0:3], v[88:91], v[40:43], a[0:3]
    v_mfma_f32_16x16x32_bf16 a[4:7], v[92:95], v[40:43], a[4:7]
    v_mfma_f32_16x16x32_bf16 a[8:11], v[96:99], v[40:43], a[8:11]
    v_mfma_f32_16x16x32_bf16 a[12:15], v[100:103], v[40:43], a[12:15]
    v_mfma_f32_16x16x32_bf16 a[16:19], v[88:91], v[44:47], a[16:19]
    v_mfma_f32_16x16x32_bf16 a[20:23], v[92:95], v[44:47], a[20:23]
    v_mfma_f32_16x16x32_bf16 a[24:27], v[96:99], v[44:47], a[24:27]
    v_mfma_f32_16x16x32_bf16 a[28:31], v[100:103], v[44:47], a[28:31]
    ds_read_b128 v[88:91], v16 offset:768
    ds_read_b128 v[92:95], v16 offset:17152
    ds_read_b128 v[96:99], v16 offset:33536
    ds_read_b128 v[100:103], v16 offset:49920
    s_waitcnt vmcnt(4)
    ds_read_b128 v[40:43], v14 offset:8192
    ds_read_b128 v[44:47], v14 offset:10240
    s_waitcnt lgkmcnt(6)
    v_mfma_f32_16x16x32_bf16 a[0:3], v[104:107], v[48:51], a[0:3]
    v_mfma_f32_16x16x32_bf16 a[4:7], v[108:111], v[48:51], a[4:7]
    v_mfma_f32_16x16x32_bf16 a[8:11], v[112:115], v[48:51], a[8:11]
    v_mfma_f32_16x16x32_bf16 a[12:15], v[116:119], v[48:51], a[12:15]
    v_mfma_f32_16x16x32_bf16 a[16:19], v[104:107], v[52:55], a[16:19]
    v_mfma_f32_16x16x32_bf16 a[20:23], v[108:111], v[52:55], a[20:23]
    v_mfma_f32_16x16x32_bf16 a[24:27], v[112:115], v[52:55], a[24:27]
    v_mfma_f32_16x16x32_bf16 a[28:31], v[116:119], v[52:55], a[28:31]
    ds_read_b128 v[104:107], v17 offset:768
    ds_read_b128 v[108:111], v17 offset:17152
    ds_read_b128 v[112:115], v17 offset:33536
    ds_read_b128 v[116:119], v17 offset:49920
    ds_read_b128 v[48:51], v15 offset:8192
    ds_read_b128 v[52:55], v15 offset:10240
    s_waitcnt lgkmcnt(6)
    v_mfma_f32_16x16x32_bf16 a[0:3], v[88:91], v[40:43], a[0:3]
    v_mfma_f32_16x16x32_bf16 a[4:7], v[92:95], v[40:43], a[4:7]
    v_mfma_f32_16x16x32_bf16 a[8:11], v[96:99], v[40:43], a[8:11]
    v_mfma_f32_16x16x32_bf16 a[12:15], v[100:103], v[40:43], a[12:15]
    v_mfma_f32_16x16x32_bf16 a[16:19], v[88:91], v[44:47], a[16:19]
    v_mfma_f32_16x16x32_bf16 a[20:23], v[92:95], v[44:47], a[20:23]
    v_mfma_f32_16x16x32_bf16 a[24:27], v[96:99], v[44:47], a[24:27]
    v_mfma_f32_16x16x32_bf16 a[28:31], v[100:103], v[44:47], a[28:31]
    ds_read_b128 v[88:91], v18 offset:768
    ds_read_b128 v[92:95], v18 offset:17152
    ds_read_b128 v[96:99], v18 offset:33536
    ds_read_b128 v[100:103], v18 offset:49920
    s_waitcnt vmcnt(0)
    ds_read_b128 v[40:43], v14 offset:12288
    ds_read_b128 v[44:47], v14 offset:14336
    s_waitcnt lgkmcnt(6)
    v_mfma_f32_16x16x32_bf16 a[0:3], v[104:107], v[48:51], a[0:3]
    v_mfma_f32_16x16x32_bf16 a[4:7], v[108:111], v[48:51], a[4:7]
    v_mfma_f32_16x16x32_bf16 a[8:11], v[112:115], v[48:51], a[8:11]
    v_mfma_f32_16x16x32_bf16 a[12:15], v[116:119], v[48:51], a[12:15]
    v_mfma_f32_16x16x32_bf16 a[16:19], v[104:107], v[52:55], a[16:19]
    v_mfma_f32_16x16x32_bf16 a[20:23], v[108:111], v[52:55], a[20:23]
    v_mfma_f32_16x16x32_bf16 a[24:27], v[112:115], v[52:55], a[24:27]
    v_mfma_f32_16x16x32_bf16 a[28:31], v[116:119], v[52:55], a[28:31]
    ds_read_b128 v[104:107], v19 offset:768
    ds_read_b128 v[108:111], v19 offset:17152
    ds_read_b128 v[112:115], v19 offset:33536
    ds_read_b128 v[116:119], v19 offset:49920
    ds_read_b128 v[48:51], v15 offset:12288
    ds_read_b128 v[52:55], v15 offset:14336
    s_waitcnt lgkmcnt(6)
    v_mfma_f32_16x16x32_bf16 a[0:3], v[88:91], v[40:43], a[0:3]
    v_mfma_f32_16x16x32_bf16 a[4:7], v[92:95], v[40:43], a[4:7]
    v_mfma_f32_16x16x32_bf16 a[8:11], v[96:99], v[40:43], a[8:11]
    v_mfma_f32_16x16x32_bf16 a[12:15], v[100:103], v[40:43], a[12:15]
    v_mfma_f32_16x16x32_bf16 a[16:19], v[88:91], v[44:47], a[16:19]
    v_mfma_f32_16x16x32_bf16 a[20:23], v[92:95], v[44:47], a[20:23]
    v_mfma_f32_16x16x32_bf16 a[24:27], v[96:99], v[44:47], a[24:27]
    v_mfma_f32_16x16x32_bf16 a[28:31], v[100:103], v[44:47], a[28:31]
    s_waitcnt lgkmcnt(0)
    v_mfma_f32_16x16x32_bf16 a[0:3], v[104:107], v[48:51], a[0:3]
    v_mfma_f32_16x16x32_bf16 a[4:7], v[108:111], v[48:51], a[4:7]
    v_mfma_f32_16x16x32_bf16 a[8:11], v[112:115], v[48:51], a[8:11]
    v_mfma_f32_16x16x32_bf16 a[12:15], v[116:119], v[48:51], a[12:15]
    v_mfma_f32_16x16x32_bf16 a[16:19], v[104:107], v[52:55], a[16:19]
    v_mfma_f32_16x16x32_bf16 a[20:23], v[108:111], v[52:55], a[20:23]
    v_mfma_f32_16x16x32_bf16 a[24:27], v[112:115], v[52:55], a[24:27]
    v_mfma_f32_16x16x32_bf16 a[28:31], v[116:119], v[52:55], a[28:31]
    v_and_b32 v2, 15, v1
    v_lshrrev_b32 v3, 4, v1
    v_lshlrev_b32 v4, 4, v2
    v_lshrrev_b32 v5, 1, v3
    v_lshl_add_u32 v4, v5, 8, v4
    v_and_b32 v5, 1, v3
    v_lshl_add_u32 v4, v5, 3, v4
    s_lshl_b32 s6, s5, 3
    s_lshl_b32 s7, s3, 1
    s_add_u32 s6, s6, s7
    s_lshl_b32 s6, s6, 16
    s_lshl_b32 s7, s4, 11
    s_add_u32 s64, s6, s7
    s_add_u32 s65, s64, 0x10000
    s_nop 7
    s_nop 7
    v_accvgpr_read_b32 v120, a0
    v_accvgpr_read_b32 v121, a1
    v_accvgpr_read_b32 v122, a2
    v_accvgpr_read_b32 v123, a3
    v_cvt_pk_bf16_f32 v124, v120, v121
    v_cvt_pk_bf16_f32 v125, v122, v123
    buffer_store_dwordx2 v[124:125], v4, s[52:55], s64 offen offset:0
    v_accvgpr_read_b32 v128, a4
    v_accvgpr_read_b32 v129, a5
    v_accvgpr_read_b32 v130, a6
    v_accvgpr_read_b32 v131, a7
    v_cvt_pk_bf16_f32 v132, v128, v129
    v_cvt_pk_bf16_f32 v133, v130, v131
    buffer_store_dwordx2 v[132:133], v4, s[52:55], s64 offen offset:512
    v_accvgpr_read_b32 v120, a8
    v_accvgpr_read_b32 v121, a9
    v_accvgpr_read_b32 v122, a10
    v_accvgpr_read_b32 v123, a11
    v_cvt_pk_bf16_f32 v124, v120, v121
    v_cvt_pk_bf16_f32 v125, v122, v123
    buffer_store_dwordx2 v[124:125], v4, s[52:55], s64 offen offset:1024
    v_accvgpr_read_b32 v128, a12
    v_accvgpr_read_b32 v129, a13
    v_accvgpr_read_b32 v130, a14
    v_accvgpr_read_b32 v131, a15
    v_cvt_pk_bf16_f32 v132, v128, v129
    v_cvt_pk_bf16_f32 v133, v130, v131
    buffer_store_dwordx2 v[132:133], v4, s[52:55], s64 offen offset:1536
    v_accvgpr_read_b32 v120, a16
    v_accvgpr_read_b32 v121, a17
    v_accvgpr_read_b32 v122, a18
    v_accvgpr_read_b32 v123, a19
    v_cvt_pk_bf16_f32 v124, v120, v121
    v_cvt_pk_bf16_f32 v125, v122, v123
    buffer_store_dwordx2 v[124:125], v4, s[52:55], s65 offen offset:0
    v_accvgpr_read_b32 v128, a20
    v_accvgpr_read_b32 v129, a21
    v_accvgpr_read_b32 v130, a22
    v_accvgpr_read_b32 v131, a23
    v_cvt_pk_bf16_f32 v132, v128, v129
    v_cvt_pk_bf16_f32 v133, v130, v131
    buffer_store_dwordx2 v[132:133], v4, s[52:55], s65 offen offset:512
    v_accvgpr_read_b32 v120, a24
    v_accvgpr_read_b32 v121, a25
    v_accvgpr_read_b32 v122, a26
    v_accvgpr_read_b32 v123, a27
    v_cvt_pk_bf16_f32 v124, v120, v121
    v_cvt_pk_bf16_f32 v125, v122, v123
    buffer_store_dwordx2 v[124:125], v4, s[52:55], s65 offen offset:1024
    v_accvgpr_read_b32 v128, a28
    v_accvgpr_read_b32 v129, a29
    v_accvgpr_read_b32 v130, a30
    v_accvgpr_read_b32 v131, a31
    v_cvt_pk_bf16_f32 v132, v128, v129
    v_cvt_pk_bf16_f32 v133, v130, v131
    buffer_store_dwordx2 v[132:133], v4, s[52:55], s65 offen offset:1536
    s_branch .end_k1a1_kernel_1
.tr_k1a1_kernel_2:
    v_lshrrev_b32 v1, 8, v0
    s_nop 1
    v_readfirstlane_b32 s4, v1
    v_and_b32 v0, 255, v0
    s_sub_u32 s3, s2, 256
    s_lshl_b32 s3, s3, 1
    s_add_u32 s3, s3, s4
    s_cmp_ge_u32 s3, 448
    s_cbranch_scc1 .end_k1a1_kernel_1
    s_waitcnt lgkmcnt(0)
    s_mov_b32 s44, s28
    s_mov_b32 s45, s29
    s_mov_b32 s46, 0x1c0000
    s_mov_b32 s47, 0x00020000
    s_add_u32 s48, s40, 0x1100000
    s_addc_u32 s49, s41, 0
    s_mov_b32 s50, 0x1c0000
    s_mov_b32 s51, 0x00020000
    s_mov_b32 s52, s32
    s_mov_b32 s53, s33
    s_mov_b32 s54, 0x1c0000
    s_mov_b32 s55, 0x00020000
    s_add_u32 s56, s40, 0x1300000
    s_addc_u32 s57, s41, 0
    s_mov_b32 s58, 0x1c0000
    s_mov_b32 s59, 0x00020000
    s_lshr_b32 s4, s3, 6
    s_and_b32 s5, s3, 63
    s_lshl_b32 s6, s4, 8
    v_add_u32 v1, s6, v0
    v_lshlrev_b32 v2, 1, v1
    s_mul_i32 s7, s5, 0x7000
    s_add_u32 s9, s7, 0x0
    buffer_load_ushort v8, v2, s[44:47], s9 offen
    s_add_u32 s9, s7, 0xe00
    buffer_load_ushort v9, v2, s[44:47], s9 offen
    s_add_u32 s9, s7, 0x1c00
    buffer_load_ushort v10, v2, s[44:47], s9 offen
    s_add_u32 s9, s7, 0x2a00
    buffer_load_ushort v11, v2, s[44:47], s9 offen
    s_add_u32 s9, s7, 0x3800
    buffer_load_ushort v12, v2, s[44:47], s9 offen
    s_add_u32 s9, s7, 0x4600
    buffer_load_ushort v13, v2, s[44:47], s9 offen
    s_add_u32 s9, s7, 0x5400
    buffer_load_ushort v14, v2, s[44:47], s9 offen
    s_add_u32 s9, s7, 0x6200
    buffer_load_ushort v15, v2, s[44:47], s9 offen
    v_lshrrev_b32 v3, 4, v1
    v_lshlrev_b32 v3, 14, v3
    v_and_b32 v7, 15, v1
    v_lshl_add_u32 v3, v7, 4, v3
    s_lshr_b32 s10, s5, 2
    s_lshl_b32 s10, s10, 10
    s_and_b32 s15, s5, 3
    s_lshl_b32 s15, s15, 8
    s_add_u32 s10, s10, s15
    s_lshr_b32 s11, s3, 1
    s_and_b32 s12, s3, 1
    s_lshl_b32 s12, s12, 8
    v_add_u32 v4, s12, v0
    v_lshlrev_b32 v5, 1, v4
    s_lshl_b32 s13, s11, 13
    s_add_u32 s9, s13, 0x0
    buffer_load_ushort v16, v5, s[52:55], s9 offen
    s_add_u32 s9, s13, 0x400
    buffer_load_ushort v17, v5, s[52:55], s9 offen
    s_add_u32 s9, s13, 0x800
    buffer_load_ushort v18, v5, s[52:55], s9 offen
    s_add_u32 s9, s13, 0xc00
    buffer_load_ushort v19, v5, s[52:55], s9 offen
    s_add_u32 s9, s13, 0x1000
    buffer_load_ushort v20, v5, s[52:55], s9 offen
    s_add_u32 s9, s13, 0x1400
    buffer_load_ushort v21, v5, s[52:55], s9 offen
    s_add_u32 s9, s13, 0x1800
    buffer_load_ushort v22, v5, s[52:55], s9 offen
    s_add_u32 s9, s13, 0x1c00
    buffer_load_ushort v23, v5, s[52:55], s9 offen
    v_lshrrev_b32 v6, 4, v4
    v_mul_u32_u24 v6, 0xe000, v6
    v_and_b32 v7, 15, v4
    v_lshl_add_u32 v6, v7, 4, v6
    s_lshr_b32 s14, s11, 2
    s_lshl_b32 s14, s14, 10
    s_and_b32 s15, s11, 3
    s_lshl_b32 s15, s15, 8
    s_add_u32 s14, s14, s15
    s_waitcnt vmcnt(8)
    v_lshl_or_b32 v24, v9, 16, v8
    v_lshl_or_b32 v25, v11, 16, v10
    v_lshl_or_b32 v26, v13, 16, v12
    v_lshl_or_b32 v27, v15, 16, v14
    buffer_store_dwordx4 v[24:27], v3, s[48:51], s10 offen
    s_waitcnt vmcnt(1)
    v_lshl_or_b32 v28, v17, 16, v16
    v_lshl_or_b32 v29, v19, 16, v18
    v_lshl_or_b32 v30, v21, 16, v20
    v_lshl_or_b32 v31, v23, 16, v22
    buffer_store_dwordx4 v[28:31], v6, s[56:59], s14 offen
.end_k1a1_kernel_1:
    s_endpgm
.section .rodata,"a"
.p2align 6
.amdhsa_kernel k1a1_kernel
  .amdhsa_next_free_vgpr 216
  .amdhsa_next_free_sgpr 100
  .amdhsa_accum_offset 184
  .amdhsa_group_segment_fixed_size 0
  .amdhsa_kernarg_size 104
  .amdhsa_user_sgpr_count 2
  .amdhsa_user_sgpr_kernarg_segment_ptr 1
  .amdhsa_system_sgpr_workgroup_id_x 1
  .amdhsa_float_denorm_mode_32 3
.end_amdhsa_kernel
.text

.globl k2a2_kernel
.p2align 8
.type k2a2_kernel,@function
k2a2_kernel:
    s_load_dwordx16 s[16:31], s[0:1], 0
    s_load_dwordx8 s[32:39], s[0:1], 64
    s_load_dwordx2 s[40:41], s[0:1], 96
    s_cmp_ge_u32 s2, 256
    s_cbranch_scc1 .end_k2a2_kernel_1
    v_lshrrev_b32 v2, 6, v0
    v_and_b32 v1, 63, v0
    v_readfirstlane_b32 s3, v2
    s_and_b32 s6, s2, 7
    s_lshr_b32 s7, s2, 3
    s_lshr_b32 s4, s7, 3
    s_lshl_b32 s6, s6, 2
    s_add_u32 s4, s4, s6
    s_and_b32 s5, s7, 7
    s_waitcnt lgkmcnt(0)
    s_cmp_lt_u32 s3, 2
    s_cselect_b32 s44, s18, s20
    s_cselect_b32 s45, s19, s21
    s_mov_b32 s46, 0x800000
    s_mov_b32 s47, 0x00020000
    s_mov_b32 s48, s40
    s_mov_b32 s49, s41
    s_mov_b32 s50, 0x400000
    s_mov_b32 s51, 0x00020000
    s_and_b32 s6, s3, 1
    s_lshl_b32 s6, s6, 11
    s_lshl_b32 s7, s4, 18
    s_add_u32 s60, s6, s7
    s_lshr_b32 s8, s3, 1
    s_lshl_b32 s8, s8, 21
    s_lshl_b32 s9, s5, 18
    s_add_u32 s8, s8, s9
    s_lshl_b32 s9, s6, 4
    s_add_u32 s61, s8, s9
    s_mov_b32 s64, s16
    s_mov_b32 s65, s17
    s_mov_b32 s66, 0x200000
    s_mov_b32 s67, 0x00020000
    s_add_u32 s68, s40, 0xb00000
    s_addc_u32 s69, s41, 0
    s_mov_b32 s70, 0x200000
    s_mov_b32 s71, 0x00020000
    v_and_b32 v10, 15, v1
    v_lshrrev_b32 v11, 4, v1
    v_lshlrev_b32 v12, 12, v10
    v_lshl_add_u32 v12, v11, 4, v12
    v_lshlrev_b32 v17, 4, v1
    v_add_u32 v2, 0x0, v12
    v_add_u32 v6, 0x0, v17
    v_add_u32 v3, 0x10000, v12
    v_add_u32 v7, 0x10000, v17
    v_add_u32 v4, 0x20000, v12
    v_add_u32 v8, 0x20000, v17
    v_add_u32 v5, 0x30000, v12
    v_add_u32 v9, 0x30000, v17
    v_lshrrev_b32 v13, 3, v1
    v_and_b32 v14, 7, v1
    v_lshrrev_b32 v15, 4, v1
    v_xor_b32 v14, v14, v15
    v_lshlrev_b32 v13, 12, v13
    v_lshl_add_u32 v15, v14, 4, v13
    v_xor_b32 v14, 4, v14
    v_lshl_add_u32 v14, v14, 4, v13
    v_add_u32 v136, 0x0, v15
    v_add_u32 v137, 0x8000, v14
    v_add_u32 v138, 0x10000, v15
    v_add_u32 v139, 0x18000, v14
    v_add_u32 v140, 0x20000, v15
    v_add_u32 v141, 0x28000, v14
    v_add_u32 v142, 0x30000, v15
    v_add_u32 v143, 0x38000, v14
    s_mul_i32 s72, s3, 24576
    v_lshrrev_b32 v13, 1, v10
    v_xor_b32 v13, v13, v11
    v_lshlrev_b32 v13, 4, v13
    v_and_b32 v14, 7, v10
    v_lshl_add_u32 v13, v14, 7, v13
    v_lshrrev_b32 v14, 3, v10
    v_lshl_add_u32 v13, v14, 10, v13
    v_add_u32 v144, s72, v13
    v_xor_b32 v145, 64, v144
    s_add_u32 m0, s72, 0x0
    s_nop 0
    buffer_load_dwordx4 v136, s[44:47], s60 offen lds
    s_add_u32 m0, s72, 0x400
    s_nop 0
    buffer_load_dwordx4 v137, s[44:47], s60 offen lds
    s_add_u32 m0, s72, 0x800
    s_nop 0
    buffer_load_dwordx4 v138, s[44:47], s60 offen lds
    s_add_u32 m0, s72, 0xc00
    s_nop 0
    buffer_load_dwordx4 v139, s[44:47], s60 offen lds
    s_add_u32 m0, s72, 0x1000
    s_nop 0
    buffer_load_dwordx4 v140, s[44:47], s60 offen lds
    s_add_u32 m0, s72, 0x1400
    s_nop 0
    buffer_load_dwordx4 v141, s[44:47], s60 offen lds
    s_add_u32 m0, s72, 0x1800
    s_nop 0
    buffer_load_dwordx4 v142, s[44:47], s60 offen lds
    s_add_u32 m0, s72, 0x1c00
    s_nop 0
    buffer_load_dwordx4 v143, s[44:47], s60 offen lds
    s_add_u32 s60, s60, 0x80
    s_add_u32 m0, s72, 0x2000
    s_nop 0
    buffer_load_dwordx4 v136, s[44:47], s60 offen lds
    s_add_u32 m0, s72, 0x2400
    s_nop 0
    buffer_load_dwordx4 v137, s[44:47], s60 offen lds
    s_add_u32 m0, s72, 0x2800
    s_nop 0
    buffer_load_dwordx4 v138, s[44:47], s60 offen lds
    s_add_u32 m0, s72, 0x2c00
    s_nop 0
    buffer_load_dwordx4 v139, s[44:47], s60 offen lds
    s_add_u32 m0, s72, 0x3000
    s_nop 0
    buffer_load_dwordx4 v140, s[44:47], s60 offen lds
    s_add_u32 m0, s72, 0x3400
    s_nop 0
    buffer_load_dwordx4 v141, s[44:47], s60 offen lds
    s_add_u32 m0, s72, 0x3800
    s_nop 0
    buffer_load_dwordx4 v142, s[44:47], s60 offen lds
    s_add_u32 m0, s72, 0x3c00
    s_nop 0
    buffer_load_dwordx4 v143, s[44:47], s60 offen lds
    s_add_u32 s60, s60, 0x80
    s_add_u32 m0, s72, 0x4000
    s_nop 0
    buffer_load_dwordx4 v136, s[44:47], s60 offen lds
    s_add_u32 m0, s72, 0x4400
    s_nop 0
    buffer_load_dwordx4 v137, s[44:47], s60 offen lds
    s_add_u32 m0, s72, 0x4800
    s_nop 0
    buffer_load_dwordx4 v138, s[44:47], s60 offen lds
    s_add_u32 m0, s72, 0x4c00
    s_nop 0
    buffer_load_dwordx4 v139, s[44:47], s60 offen lds
    s_add_u32 m0, s72, 0x5000
    s_nop 0
    buffer_load_dwordx4 v140, s[44:47], s60 offen lds
    s_add_u32 m0, s72, 0x5400
    s_nop 0
    buffer_load_dwordx4 v141, s[44:47], s60 offen lds
    s_add_u32 m0, s72, 0x5800
    s_nop 0
    buffer_load_dwordx4 v142, s[44:47], s60 offen lds
    s_add_u32 m0, s72, 0x5c00
    s_nop 0
    buffer_load_dwordx4 v143, s[44:47], s60 offen lds
    s_add_u32 s60, s60, 0x80
    buffer_load_dwordx4 v[72:75], v6, s[48:51], s61 offen
    buffer_load_dwordx4 v[76:79], v7, s[48:51], s61 offen
    buffer_load_dwordx4 v[80:83], v8, s[48:51], s61 offen
    buffer_load_dwordx4 v[84:87], v9, s[48:51], s61 offen
    s_add_u32 s61, s61, 0x400
    buffer_load_dwordx4 v[88:91], v6, s[48:51], s61 offen
    buffer_load_dwordx4 v[92:95], v7, s[48:51], s61 offen
    buffer_load_dwordx4 v[96:99], v8, s[48:51], s61 offen
    buffer_load_dwordx4 v[100:103], v9, s[48:51], s61 offen
    s_add_u32 s61, s61, 0x400
    buffer_load_dwordx4 v[104:107], v6, s[48:51], s61 offen
    buffer_load_dwordx4 v[108:111], v7, s[48:51], s61 offen
    buffer_load_dwordx4 v[112:115], v8, s[48:51], s61 offen
    buffer_load_dwordx4 v[116:119], v9, s[48:51], s61 offen
    s_add_u32 s61, s61, 0x400
    buffer_load_dwordx4 v[120:123], v6, s[48:51], s61 offen
    buffer_load_dwordx4 v[124:127], v7, s[48:51], s61 offen
    buffer_load_dwordx4 v[128:131], v8, s[48:51], s61 offen
    buffer_load_dwordx4 v[132:135], v9, s[48:51], s61 offen
    s_add_u32 s61, s61, 0x400
    v_lshlrev_b32 v13, 10, v10
    v_lshl_add_u32 v13, v11, 3, v13
    v_mov_b32 v16, v13
    s_lshl_b32 s6, s4, 16
    s_lshl_b32 s7, s3, 14
    s_add_u32 s6, s6, s7
    s_lshl_b32 s7, s5, 7
    s_add_u32 s62, s6, s7
    buffer_load_dwordx2 v[24:25], v16, s[64:67], s62 offen offset:0
    buffer_load_dwordx2 v[26:27], v16, s[64:67], s62 offen offset:32
    buffer_load_dwordx2 v[28:29], v16, s[64:67], s62 offen offset:64
    buffer_load_dwordx2 v[30:31], v16, s[64:67], s62 offen offset:96
    s_waitcnt vmcnt(36)
    ds_read_b128 v[40:43], v144 offset:0
    ds_read_b128 v[44:47], v144 offset:2048
    ds_read_b128 v[48:51], v144 offset:4096
    ds_read_b128 v[52:55], v144 offset:6144
    ds_read_b128 v[56:59], v145 offset:0
    ds_read_b128 v[60:63], v145 offset:2048
    ds_read_b128 v[64:67], v145 offset:4096
    ds_read_b128 v[68:71], v145 offset:6144
    s_waitcnt lgkmcnt(4)
    s_waitcnt vmcnt(16)
    v_mfma_f32_16x16x32_bf16 a[0:3], v[72:75], v[40:43], 0
    v_mfma_f32_16x16x32_bf16 a[4:7], v[72:75], v[44:47], 0
    v_mfma_f32_16x16x32_bf16 a[8:11], v[72:75], v[48:51], 0
    v_mfma_f32_16x16x32_bf16 a[12:15], v[72:75], v[52:55], 0
    v_mfma_f32_16x16x32_bf16 a[16:19], v[76:79], v[40:43], 0
    v_mfma_f32_16x16x32_bf16 a[20:23], v[76:79], v[44:47], 0
    v_mfma_f32_16x16x32_bf16 a[24:27], v[76:79], v[48:51], 0
    v_mfma_f32_16x16x32_bf16 a[28:31], v[76:79], v[52:55], 0
    v_mfma_f32_16x16x32_bf16 a[32:35], v[80:83], v[40:43], 0
    v_mfma_f32_16x16x32_bf16 a[36:39], v[80:83], v[44:47], 0
    v_mfma_f32_16x16x32_bf16 a[40:43], v[80:83], v[48:51], 0
    v_mfma_f32_16x16x32_bf16 a[44:47], v[80:83], v[52:55], 0
    v_mfma_f32_16x16x32_bf16 a[48:51], v[84:87], v[40:43], 0
    v_mfma_f32_16x16x32_bf16 a[52:55], v[84:87], v[44:47], 0
    v_mfma_f32_16x16x32_bf16 a[56:59], v[84:87], v[48:51], 0
    v_mfma_f32_16x16x32_bf16 a[60:63], v[84:87], v[52:55], 0
    buffer_load_dwordx4 v[72:75], v6, s[48:51], s61 offen
    buffer_load_dwordx4 v[76:79], v7, s[48:51], s61 offen
    buffer_load_dwordx4 v[80:83], v8, s[48:51], s61 offen
    buffer_load_dwordx4 v[84:87], v9, s[48:51], s61 offen
    s_add_u32 s61, s61, 0x400
    ds_read_b128 v[40:43], v144 offset:8192
    ds_read_b128 v[44:47], v144 offset:10240
    ds_read_b128 v[48:51], v144 offset:12288
    ds_read_b128 v[52:55], v144 offset:14336
    s_waitcnt lgkmcnt(4)
    s_waitcnt vmcnt(16)
    v_mfma_f32_16x16x32_bf16 a[0:3], v[88:91], v[56:59], a[0:3]
    v_mfma_f32_16x16x32_bf16 a[4:7], v[88:91], v[60:63], a[4:7]
    v_mfma_f32_16x16x32_bf16 a[8:11], v[88:91], v[64:67], a[8:11]
    v_mfma_f32_16x16x32_bf16 a[12:15], v[88:91], v[68:71], a[12:15]
    v_mfma_f32_16x16x32_bf16 a[16:19], v[92:95], v[56:59], a[16:19]
    v_mfma_f32_16x16x32_bf16 a[20:23], v[92:95], v[60:63], a[20:23]
    v_mfma_f32_16x16x32_bf16 a[24:27], v[92:95], v[64:67], a[24:27]
    v_mfma_f32_16x16x32_bf16 a[28:31], v[92:95], v[68:71], a[28:31]
    v_mfma_f32_16x16x32_bf16 a[32:35], v[96:99], v[56:59], a[32:35]
    v_mfma_f32_16x16x32_bf16 a[36:39], v[96:99], v[60:63], a[36:39]
    v_mfma_f32_16x16x32_bf16 a[40:43], v[96:99], v[64:67], a[40:43]
    v_mfma_f32_16x16x32_bf16 a[44:47], v[96:99], v[68:71], a[44:47]
    v_mfma_f32_16x16x32_bf16 a[48:51], v[100:103], v[56:59], a[48:51]
    v_mfma_f32_16x16x32_bf16 a[52:55], v[100:103], v[60:63], a[52:55]
    v_mfma_f32_16x16x32_bf16 a[56:59], v[100:103], v[64:67], a[56:59]
    v_mfma_f32_16x16x32_bf16 a[60:63], v[100:103], v[68:71], a[60:63]
    s_add_u32 m0, s72, 0x0
    s_nop 0
    buffer_load_dwordx4 v136, s[44:47], s60 offen lds
    s_add_u32 m0, s72, 0x400
    s_nop 0
    buffer_load_dwordx4 v137, s[44:47], s60 offen lds
    s_add_u32 m0, s72, 0x800
    s_nop 0
    buffer_load_dwordx4 v138, s[44:47], s60 offen lds
    s_add_u32 m0, s72, 0xc00
    s_nop 0
    buffer_load_dwordx4 v139, s[44:47], s60 offen lds
    s_add_u32 m0, s72, 0x1000
    s_nop 0
    buffer_load_dwordx4 v140, s[44:47], s60 offen lds
    s_add_u32 m0, s72, 0x1400
    s_nop 0
    buffer_load_dwordx4 v141, s[44:47], s60 offen lds
    s_add_u32 m0, s72, 0x1800
    s_nop 0
    buffer_load_dwordx4 v142, s[44:47], s60 offen lds
    s_add_u32 m0, s72, 0x1c00
    s_nop 0
    buffer_load_dwordx4 v143, s[44:47], s60 offen lds
    s_add_u32 s60, s60, 0x80
    buffer_load_dwordx4 v[88:91], v6, s[48:51], s61 offen
    buffer_load_dwordx4 v[92:95], v7, s[48:51], s61 offen
    buffer_load_dwordx4 v[96:99], v8, s[48:51], s61 offen
    buffer_load_dwordx4 v[100:103], v9, s[48:51], s61 offen
    s_add_u32 s61, s61, 0x400
    ds_read_b128 v[56:59], v145 offset:8192
    ds_read_b128 v[60:63], v145 offset:10240
    ds_read_b128 v[64:67], v145 offset:12288
    ds_read_b128 v[68:71], v145 offset:14336
    s_waitcnt lgkmcnt(4)
    s_waitcnt vmcnt(24)
    v_mfma_f32_16x16x32_bf16 a[0:3], v[104:107], v[40:43], a[0:3]
    v_mfma_f32_16x16x32_bf16 a[4:7], v[104:107], v[44:47], a[4:7]
    v_mfma_f32_16x16x32_bf16 a[8:11], v[104:107], v[48:51], a[8:11]
    v_mfma_f32_16x16x32_bf16 a[12:15], v[104:107], v[52:55], a[12:15]
    v_mfma_f32_16x16x32_bf16 a[16:19], v[108:111], v[40:43], a[16:19]
    v_mfma_f32_16x16x32_bf16 a[20:23], v[108:111], v[44:47], a[20:23]
    v_mfma_f32_16x16x32_bf16 a[24:27], v[108:111], v[48:51], a[24:27]
    v_mfma_f32_16x16x32_bf16 a[28:31], v[108:111], v[52:55], a[28:31]
    v_mfma_f32_16x16x32_bf16 a[32:35], v[112:115], v[40:43], a[32:35]
    v_mfma_f32_16x16x32_bf16 a[36:39], v[112:115], v[44:47], a[36:39]
    v_mfma_f32_16x16x32_bf16 a[40:43], v[112:115], v[48:51], a[40:43]
    v_mfma_f32_16x16x32_bf16 a[44:47], v[112:115], v[52:55], a[44:47]
    v_mfma_f32_16x16x32_bf16 a[48:51], v[116:119], v[40:43], a[48:51]
    v_mfma_f32_16x16x32_bf16 a[52:55], v[116:119], v[44:47], a[52:55]
    v_mfma_f32_16x16x32_bf16 a[56:59], v[116:119], v[48:51], a[56:59]
    v_mfma_f32_16x16x32_bf16 a[60:63], v[116:119], v[52:55], a[60:63]
    buffer_load_dwordx4 v[104:107], v6, s[48:51], s61 offen
    buffer_load_dwordx4 v[108:111], v7, s[48:51], s61 offen
    buffer_load_dwordx4 v[112:115], v8, s[48:51], s61 offen
    buffer_load_dwordx4 v[116:119], v9, s[48:51], s61 offen
    s_add_u32 s61, s61, 0x400
    ds_read_b128 v[40:43], v144 offset:16384
    ds_read_b128 v[44:47], v144 offset:18432
    ds_read_b128 v[48:51], v144 offset:20480
    ds_read_b128 v[52:55], v144 offset:22528
    s_waitcnt lgkmcnt(4)
    s_waitcnt vmcnt(24)
    v_mfma_f32_16x16x32_bf16 a[0:3], v[120:123], v[56:59], a[0:3]
    v_mfma_f32_16x16x32_bf16 a[4:7], v[120:123], v[60:63], a[4:7]
    v_mfma_f32_16x16x32_bf16 a[8:11], v[120:123], v[64:67], a[8:11]
    v_mfma_f32_16x16x32_bf16 a[12:15], v[120:123], v[68:71], a[12:15]
    v_mfma_f32_16x16x32_bf16 a[16:19], v[124:127], v[56:59], a[16:19]
    v_mfma_f32_16x16x32_bf16 a[20:23], v[124:127], v[60:63], a[20:23]
    v_mfma_f32_16x16x32_bf16 a[24:27], v[124:127], v[64:67], a[24:27]
    v_mfma_f32_16x16x32_bf16 a[28:31], v[124:127], v[68:71], a[28:31]
    v_mfma_f32_16x16x32_bf16 a[32:35], v[128:131], v[56:59], a[32:35]
    v_mfma_f32_16x16x32_bf16 a[36:39], v[128:131], v[60:63], a[36:39]
    v_mfma_f32_16x16x32_bf16 a[40:43], v[128:131], v[64:67], a[40:43]
    v_mfma_f32_16x16x32_bf16 a[44:47], v[128:131], v[68:71], a[44:47]
    v_mfma_f32_16x16x32_bf16 a[48:51], v[132:135], v[56:59], a[48:51]
    v_mfma_f32_16x16x32_bf16 a[52:55], v[132:135], v[60:63], a[52:55]
    v_mfma_f32_16x16x32_bf16 a[56:59], v[132:135], v[64:67], a[56:59]
    v_mfma_f32_16x16x32_bf16 a[60:63], v[132:135], v[68:71], a[60:63]
    s_add_u32 m0, s72, 0x2000
    s_nop 0
    buffer_load_dwordx4 v136, s[44:47], s60 offen lds
    s_add_u32 m0, s72, 0x2400
    s_nop 0
    buffer_load_dwordx4 v137, s[44:47], s60 offen lds
    s_add_u32 m0, s72, 0x2800
    s_nop 0
    buffer_load_dwordx4 v138, s[44:47], s60 offen lds
    s_add_u32 m0, s72, 0x2c00
    s_nop 0
    buffer_load_dwordx4 v139, s[44:47], s60 offen lds
    s_add_u32 m0, s72, 0x3000
    s_nop 0
    buffer_load_dwordx4 v140, s[44:47], s60 offen lds
    s_add_u32 m0, s72, 0x3400
    s_nop 0
    buffer_load_dwordx4 v141, s[44:47], s60 offen lds
    s_add_u32 m0, s72, 0x3800
    s_nop 0
    buffer_load_dwordx4 v142, s[44:47], s60 offen lds
    s_add_u32 m0, s72, 0x3c00
    s_nop 0
    buffer_load_dwordx4 v143, s[44:47], s60 offen lds
    s_add_u32 s60, s60, 0x80
    buffer_load_dwordx4 v[120:123], v6, s[48:51], s61 offen
    buffer_load_dwordx4 v[124:127], v7, s[48:51], s61 offen
    buffer_load_dwordx4 v[128:131], v8, s[48:51], s61 offen
    buffer_load_dwordx4 v[132:135], v9, s[48:51], s61 offen
    s_add_u32 s61, s61, 0x400
    ds_read_b128 v[56:59], v145 offset:16384
    ds_read_b128 v[60:63], v145 offset:18432
    ds_read_b128 v[64:67], v145 offset:20480
    ds_read_b128 v[68:71], v145 offset:22528
    s_waitcnt lgkmcnt(4)
    s_waitcnt vmcnt(28)
    v_mfma_f32_16x16x32_bf16 a[0:3], v[72:75], v[40:43], a[0:3]
    v_mfma_f32_16x16x32_bf16 a[4:7], v[72:75], v[44:47], a[4:7]
    v_mfma_f32_16x16x32_bf16 a[8:11], v[72:75], v[48:51], a[8:11]
    v_mfma_f32_16x16x32_bf16 a[12:15], v[72:75], v[52:55], a[12:15]
    v_mfma_f32_16x16x32_bf16 a[16:19], v[76:79], v[40:43], a[16:19]
    v_mfma_f32_16x16x32_bf16 a[20:23], v[76:79], v[44:47], a[20:23]
    v_mfma_f32_16x16x32_bf16 a[24:27], v[76:79], v[48:51], a[24:27]
    v_mfma_f32_16x16x32_bf16 a[28:31], v[76:79], v[52:55], a[28:31]
    v_mfma_f32_16x16x32_bf16 a[32:35], v[80:83], v[40:43], a[32:35]
    v_mfma_f32_16x16x32_bf16 a[36:39], v[80:83], v[44:47], a[36:39]
    v_mfma_f32_16x16x32_bf16 a[40:43], v[80:83], v[48:51], a[40:43]
    v_mfma_f32_16x16x32_bf16 a[44:47], v[80:83], v[52:55], a[44:47]
    v_mfma_f32_16x16x32_bf16 a[48:51], v[84:87], v[40:43], a[48:51]
    v_mfma_f32_16x16x32_bf16 a[52:55], v[84:87], v[44:47], a[52:55]
    v_mfma_f32_16x16x32_bf16 a[56:59], v[84:87], v[48:51], a[56:59]
    v_mfma_f32_16x16x32_bf16 a[60:63], v[84:87], v[52:55], a[60:63]
    buffer_load_dwordx4 v[72:75], v6, s[48:51], s61 offen
    buffer_load_dwordx4 v[76:79], v7, s[48:51], s61 offen
    buffer_load_dwordx4 v[80:83], v8, s[48:51], s61 offen
    buffer_load_dwordx4 v[84:87], v9, s[48:51], s61 offen
    s_add_u32 s61, s61, 0x400
    s_waitcnt vmcnt(24)
    ds_read_b128 v[40:43], v144 offset:0
    ds_read_b128 v[44:47], v144 offset:2048
    ds_read_b128 v[48:51], v144 offset:4096
    ds_read_b128 v[52:55], v144 offset:6144
    s_waitcnt lgkmcnt(4)
    s_waitcnt vmcnt(20)
    v_mfma_f32_16x16x32_bf16 a[0:3], v[88:91], v[56:59], a[0:3]
    v_mfma_f32_16x16x32_bf16 a[4:7], v[88:91], v[60:63], a[4:7]
    v_mfma_f32_16x16x32_bf16 a[8:11], v[88:91], v[64:67], a[8:11]
    v_mfma_f32_16x16x32_bf16 a[12:15], v[88:91], v[68:71], a[12:15]
    v_mfma_f32_16x16x32_bf16 a[16:19], v[92:95], v[56:59], a[16:19]
    v_mfma_f32_16x16x32_bf16 a[20:23], v[92:95], v[60:63], a[20:23]
    v_mfma_f32_16x16x32_bf16 a[24:27], v[92:95], v[64:67], a[24:27]
    v_mfma_f32_16x16x32_bf16 a[28:31], v[92:95], v[68:71], a[28:31]
    v_mfma_f32_16x16x32_bf16 a[32:35], v[96:99], v[56:59], a[32:35]
    v_mfma_f32_16x16x32_bf16 a[36:39], v[96:99], v[60:63], a[36:39]
    v_mfma_f32_16x16x32_bf16 a[40:43], v[96:99], v[64:67], a[40:43]
    v_mfma_f32_16x16x32_bf16 a[44:47], v[96:99], v[68:71], a[44:47]
    v_mfma_f32_16x16x32_bf16 a[48:51], v[100:103], v[56:59], a[48:51]
    v_mfma_f32_16x16x32_bf16 a[52:55], v[100:103], v[60:63], a[52:55]
    v_mfma_f32_16x16x32_bf16 a[56:59], v[100:103], v[64:67], a[56:59]
    v_mfma_f32_16x16x32_bf16 a[60:63], v[100:103], v[68:71], a[60:63]
    s_add_u32 m0, s72, 0x4000
    s_nop 0
    buffer_load_dwordx4 v136, s[44:47], s60 offen lds
    s_add_u32 m0, s72, 0x4400
    s_nop 0
    buffer_load_dwordx4 v137, s[44:47], s60 offen lds
    s_add_u32 m0, s72, 0x4800
    s_nop 0
    buffer_load_dwordx4 v138, s[44:47], s60 offen lds
    s_add_u32 m0, s72, 0x4c00
    s_nop 0
    buffer_load_dwordx4 v139, s[44:47], s60 offen lds
    s_add_u32 m0, s72, 0x5000
    s_nop 0
    buffer_load_dwordx4 v140, s[44:47], s60 offen lds
    s_add_u32 m0, s72, 0x5400
    s_nop 0
    buffer_load_dwordx4 v141, s[44:47], s60 offen lds
    s_add_u32 m0, s72, 0x5800
    s_nop 0
    buffer_load_dwordx4 v142, s[44:47], s60 offen lds
    s_add_u32 m0, s72, 0x5c00
    s_nop 0
    buffer_load_dwordx4 v143, s[44:47], s60 offen lds
    s_add_u32 s60, s60, 0x80
    buffer_load_dwordx4 v[88:91], v6, s[48:51], s61 offen
    buffer_load_dwordx4 v[92:95], v7, s[48:51], s61 offen
    buffer_load_dwordx4 v[96:99], v8, s[48:51], s61 offen
    buffer_load_dwordx4 v[100:103], v9, s[48:51], s61 offen
    s_add_u32 s61, s61, 0x400
    ds_read_b128 v[56:59], v145 offset:0
    ds_read_b128 v[60:63], v145 offset:2048
    ds_read_b128 v[64:67], v145 offset:4096
    ds_read_b128 v[68:71], v145 offset:6144
    s_waitcnt lgkmcnt(4)
    s_waitcnt vmcnt(28)
    v_mfma_f32_16x16x32_bf16 a[0:3], v[104:107], v[40:43], a[0:3]
    v_mfma_f32_16x16x32_bf16 a[4:7], v[104:107], v[44:47], a[4:7]
    v_mfma_f32_16x16x32_bf16 a[8:11], v[104:107], v[48:51], a[8:11]
    v_mfma_f32_16x16x32_bf16 a[12:15], v[104:107], v[52:55], a[12:15]
    v_mfma_f32_16x16x32_bf16 a[16:19], v[108:111], v[40:43], a[16:19]
    v_mfma_f32_16x16x32_bf16 a[20:23], v[108:111], v[44:47], a[20:23]
    v_mfma_f32_16x16x32_bf16 a[24:27], v[108:111], v[48:51], a[24:27]
    v_mfma_f32_16x16x32_bf16 a[28:31], v[108:111], v[52:55], a[28:31]
    v_mfma_f32_16x16x32_bf16 a[32:35], v[112:115], v[40:43], a[32:35]
    v_mfma_f32_16x16x32_bf16 a[36:39], v[112:115], v[44:47], a[36:39]
    v_mfma_f32_16x16x32_bf16 a[40:43], v[112:115], v[48:51], a[40:43]
    v_mfma_f32_16x16x32_bf16 a[44:47], v[112:115], v[52:55], a[44:47]
    v_mfma_f32_16x16x32_bf16 a[48:51], v[116:119], v[40:43], a[48:51]
    v_mfma_f32_16x16x32_bf16 a[52:55], v[116:119], v[44:47], a[52:55]
    v_mfma_f32_16x16x32_bf16 a[56:59], v[116:119], v[48:51], a[56:59]
    v_mfma_f32_16x16x32_bf16 a[60:63], v[116:119], v[52:55], a[60:63]
    buffer_load_dwordx4 v[104:107], v6, s[48:51], s61 offen
    buffer_load_dwordx4 v[108:111], v7, s[48:51], s61 offen
    buffer_load_dwordx4 v[112:115], v8, s[48:51], s61 offen
    buffer_load_dwordx4 v[116:119], v9, s[48:51], s61 offen
    s_add_u32 s61, s61, 0x400
    s_waitcnt vmcnt(24)
    ds_read_b128 v[40:43], v144 offset:8192
    ds_read_b128 v[44:47], v144 offset:10240
    ds_read_b128 v[48:51], v144 offset:12288
    ds_read_b128 v[52:55], v144 offset:14336
    s_waitcnt lgkmcnt(4)
    s_waitcnt vmcnt(20)
    v_mfma_f32_16x16x32_bf16 a[0:3], v[120:123], v[56:59], a[0:3]
    v_mfma_f32_16x16x32_bf16 a[4:7], v[120:123], v[60:63], a[4:7]
    v_mfma_f32_16x16x32_bf16 a[8:11], v[120:123], v[64:67], a[8:11]
    v_mfma_f32_16x16x32_bf16 a[12:15], v[120:123], v[68:71], a[12:15]
    v_mfma_f32_16x16x32_bf16 a[16:19], v[124:127], v[56:59], a[16:19]
    v_mfma_f32_16x16x32_bf16 a[20:23], v[124:127], v[60:63], a[20:23]
    v_mfma_f32_16x16x32_bf16 a[24:27], v[124:127], v[64:67], a[24:27]
    v_mfma_f32_16x16x32_bf16 a[28:31], v[124:127], v[68:71], a[28:31]
    v_mfma_f32_16x16x32_bf16 a[32:35], v[128:131], v[56:59], a[32:35]
    v_mfma_f32_16x16x32_bf16 a[36:39], v[128:131], v[60:63], a[36:39]
    v_mfma_f32_16x16x32_bf16 a[40:43], v[128:131], v[64:67], a[40:43]
    v_mfma_f32_16x16x32_bf16 a[44:47], v[128:131], v[68:71], a[44:47]
    v_mfma_f32_16x16x32_bf16 a[48:51], v[132:135], v[56:59], a[48:51]
    v_mfma_f32_16x16x32_bf16 a[52:55], v[132:135], v[60:63], a[52:55]
    v_mfma_f32_16x16x32_bf16 a[56:59], v[132:135], v[64:67], a[56:59]
    v_mfma_f32_16x16x32_bf16 a[60:63], v[132:135], v[68:71], a[60:63]
    s_add_u32 m0, s72, 0x0
    s_nop 0
    buffer_load_dwordx4 v136, s[44:47], s60 offen lds
    s_add_u32 m0, s72, 0x400
    s_nop 0
    buffer_load_dwordx4 v137, s[44:47], s60 offen lds
    s_add_u32 m0, s72, 0x800
    s_nop 0
    buffer_load_dwordx4 v138, s[44:47], s60 offen lds
    s_add_u32 m0, s72, 0xc00
    s_nop 0
    buffer_load_dwordx4 v139, s[44:47], s60 offen lds
    s_add_u32 m0, s72, 0x1000
    s_nop 0
    buffer_load_dwordx4 v140, s[44:47], s60 offen lds
    s_add_u32 m0, s72, 0x1400
    s_nop 0
    buffer_load_dwordx4 v141, s[44:47], s60 offen lds
    s_add_u32 m0, s72, 0x1800
    s_nop 0
    buffer_load_dwordx4 v142, s[44:47], s60 offen lds
    s_add_u32 m0, s72, 0x1c00
    s_nop 0
    buffer_load_dwordx4 v143, s[44:47], s60 offen lds
    s_add_u32 s60, s60, 0x80
    buffer_load_dwordx4 v[120:123], v6, s[48:51], s61 offen
    buffer_load_dwordx4 v[124:127], v7, s[48:51], s61 offen
    buffer_load_dwordx4 v[128:131], v8, s[48:51], s61 offen
    buffer_load_dwordx4 v[132:135], v9, s[48:51], s61 offen
    s_add_u32 s61, s61, 0x400
    ds_read_b128 v[56:59], v145 offset:8192
    ds_read_b128 v[60:63], v145 offset:10240
    ds_read_b128 v[64:67], v145 offset:12288
    ds_read_b128 v[68:71], v145 offset:14336
    s_waitcnt lgkmcnt(4)
    s_waitcnt vmcnt(28)
    v_mfma_f32_16x16x32_bf16 a[0:3], v[72:75], v[40:43], a[0:3]
    v_mfma_f32_16x16x32_bf16 a[4:7], v[72:75], v[44:47], a[4:7]
    v_mfma_f32_16x16x32_bf16 a[8:11], v[72:75], v[48:51], a[8:11]
    v_mfma_f32_16x16x32_bf16 a[12:15], v[72:75], v[52:55], a[12:15]
    v_mfma_f32_16x16x32_bf16 a[16:19], v[76:79], v[40:43], a[16:19]
    v_mfma_f32_16x16x32_bf16 a[20:23], v[76:79], v[44:47], a[20:23]
    v_mfma_f32_16x16x32_bf16 a[24:27], v[76:79], v[48:51], a[24:27]
    v_mfma_f32_16x16x32_bf16 a[28:31], v[76:79], v[52:55], a[28:31]
    v_mfma_f32_16x16x32_bf16 a[32:35], v[80:83], v[40:43], a[32:35]
    v_mfma_f32_16x16x32_bf16 a[36:39], v[80:83], v[44:47], a[36:39]
    v_mfma_f32_16x16x32_bf16 a[40:43], v[80:83], v[48:51], a[40:43]
    v_mfma_f32_16x16x32_bf16 a[44:47], v[80:83], v[52:55], a[44:47]
    v_mfma_f32_16x16x32_bf16 a[48:51], v[84:87], v[40:43], a[48:51]
    v_mfma_f32_16x16x32_bf16 a[52:55], v[84:87], v[44:47], a[52:55]
    v_mfma_f32_16x16x32_bf16 a[56:59], v[84:87], v[48:51], a[56:59]
    v_mfma_f32_16x16x32_bf16 a[60:63], v[84:87], v[52:55], a[60:63]
    buffer_load_dwordx4 v[72:75], v6, s[48:51], s61 offen
    buffer_load_dwordx4 v[76:79], v7, s[48:51], s61 offen
    buffer_load_dwordx4 v[80:83], v8, s[48:51], s61 offen
    buffer_load_dwordx4 v[84:87], v9, s[48:51], s61 offen
    s_add_u32 s61, s61, 0x400
    s_waitcnt vmcnt(24)
    ds_read_b128 v[40:43], v144 offset:16384
    ds_read_b128 v[44:47], v144 offset:18432
    ds_read_b128 v[48:51], v144 offset:20480
    ds_read_b128 v[52:55], v144 offset:22528
    s_waitcnt lgkmcnt(4)
    s_waitcnt vmcnt(20)
    v_mfma_f32_16x16x32_bf16 a[0:3], v[88:91], v[56:59], a[0:3]
    v_mfma_f32_16x16x32_bf16 a[4:7], v[88:91], v[60:63], a[4:7]
    v_mfma_f32_16x16x32_bf16 a[8:11], v[88:91], v[64:67], a[8:11]
    v_mfma_f32_16x16x32_bf16 a[12:15], v[88:91], v[68:71], a[12:15]
    v_mfma_f32_16x16x32_bf16 a[16:19], v[92:95], v[56:59], a[16:19]
    v_mfma_f32_16x16x32_bf16 a[20:23], v[92:95], v[60:63], a[20:23]
    v_mfma_f32_16x16x32_bf16 a[24:27], v[92:95], v[64:67], a[24:27]
    v_mfma_f32_16x16x32_bf16 a[28:31], v[92:95], v[68:71], a[28:31]
    v_mfma_f32_16x16x32_bf16 a[32:35], v[96:99], v[56:59], a[32:35]
    v_mfma_f32_16x16x32_bf16 a[36:39], v[96:99], v[60:63], a[36:39]
    v_mfma_f32_16x16x32_bf16 a[40:43], v[96:99], v[64:67], a[40:43]
    v_mfma_f32_16x16x32_bf16 a[44:47], v[96:99], v[68:71], a[44:47]
    v_mfma_f32_16x16x32_bf16 a[48:51], v[100:103], v[56:59], a[48:51]
    v_mfma_f32_16x16x32_bf16 a[52:55], v[100:103], v[60:63], a[52:55]
    v_mfma_f32_16x16x32_bf16 a[56:59], v[100:103], v[64:67], a[56:59]
    v_mfma_f32_16x16x32_bf16 a[60:63], v[100:103], v[68:71], a[60:63]
    s_add_u32 m0, s72, 0x2000
    s_nop 0
    buffer_load_dwordx4 v136, s[44:47], s60 offen lds
    s_add_u32 m0, s72, 0x2400
    s_nop 0
    buffer_load_dwordx4 v137, s[44:47], s60 offen lds
    s_add_u32 m0, s72, 0x2800
    s_nop 0
    buffer_load_dwordx4 v138, s[44:47], s60 offen lds
    s_add_u32 m0, s72, 0x2c00
    s_nop 0
    buffer_load_dwordx4 v139, s[44:47], s60 offen lds
    s_add_u32 m0, s72, 0x3000
    s_nop 0
    buffer_load_dwordx4 v140, s[44:47], s60 offen lds
    s_add_u32 m0, s72, 0x3400
    s_nop 0
    buffer_load_dwordx4 v141, s[44:47], s60 offen lds
    s_add_u32 m0, s72, 0x3800
    s_nop 0
    buffer_load_dwordx4 v142, s[44:47], s60 offen lds
    s_add_u32 m0, s72, 0x3c00
    s_nop 0
    buffer_load_dwordx4 v143, s[44:47], s60 offen lds
    s_add_u32 s60, s60, 0x80
    buffer_load_dwordx4 v[88:91], v6, s[48:51], s61 offen
    buffer_load_dwordx4 v[92:95], v7, s[48:51], s61 offen
    buffer_load_dwordx4 v[96:99], v8, s[48:51], s61 offen
    buffer_load_dwordx4 v[100:103], v9, s[48:51], s61 offen
    s_add_u32 s61, s61, 0x400
    ds_read_b128 v[56:59], v145 offset:16384
    ds_read_b128 v[60:63], v145 offset:18432
    ds_read_b128 v[64:67], v145 offset:20480
    ds_read_b128 v[68:71], v145 offset:22528
    s_waitcnt lgkmcnt(4)
    s_waitcnt vmcnt(28)
    v_mfma_f32_16x16x32_bf16 a[0:3], v[104:107], v[40:43], a[0:3]
    v_mfma_f32_16x16x32_bf16 a[4:7], v[104:107], v[44:47], a[4:7]
    v_mfma_f32_16x16x32_bf16 a[8:11], v[104:107], v[48:51], a[8:11]
    v_mfma_f32_16x16x32_bf16 a[12:15], v[104:107], v[52:55], a[12:15]
    v_mfma_f32_16x16x32_bf16 a[16:19], v[108:111], v[40:43], a[16:19]
    v_mfma_f32_16x16x32_bf16 a[20:23], v[108:111], v[44:47], a[20:23]
    v_mfma_f32_16x16x32_bf16 a[24:27], v[108:111], v[48:51], a[24:27]
    v_mfma_f32_16x16x32_bf16 a[28:31], v[108:111], v[52:55], a[28:31]
    v_mfma_f32_16x16x32_bf16 a[32:35], v[112:115], v[40:43], a[32:35]
    v_mfma_f32_16x16x32_bf16 a[36:39], v[112:115], v[44:47], a[36:39]
    v_mfma_f32_16x16x32_bf16 a[40:43], v[112:115], v[48:51], a[40:43]
    v_mfma_f32_16x16x32_bf16 a[44:47], v[112:115], v[52:55], a[44:47]
    v_mfma_f32_16x16x32_bf16 a[48:51], v[116:119], v[40:43], a[48:51]
    v_mfma_f32_16x16x32_bf16 a[52:55], v[116:119], v[44:47], a[52:55]
    v_mfma_f32_16x16x32_bf16 a[56:59], v[116:119], v[48:51], a[56:59]
    v_mfma_f32_16x16x32_bf16 a[60:63], v[116:119], v[52:55], a[60:63]
    buffer_load_dwordx4 v[104:107], v6, s[48:51], s61 offen
    buffer_load_dwordx4 v[108:111], v7, s[48:51], s61 offen
    buffer_load_dwordx4 v[112:115], v8, s[48:51], s61 offen
    buffer_load_dwordx4 v[116:119], v9, s[48:51], s61 offen
    s_add_u32 s61, s61, 0x400
    s_waitcnt vmcnt(24)
    ds_read_b128 v[40:43], v144 offset:0
    ds_read_b128 v[44:47], v144 offset:2048
    ds_read_b128 v[48:51], v144 offset:4096
    ds_read_b128 v[52:55], v144 offset:6144
    s_waitcnt lgkmcnt(4)
    s_waitcnt vmcnt(20)
    v_mfma_f32_16x16x32_bf16 a[0:3], v[120:123], v[56:59], a[0:3]
    v_mfma_f32_16x16x32_bf16 a[4:7], v[120:123], v[60:63], a[4:7]
    v_mfma_f32_16x16x32_bf16 a[8:11], v[120:123], v[64:67], a[8:11]
    v_mfma_f32_16x16x32_bf16 a[12:15], v[120:123], v[68:71], a[12:15]
    v_mfma_f32_16x16x32_bf16 a[16:19], v[124:127], v[56:59], a[16:19]
    v_mfma_f32_16x16x32_bf16 a[20:23], v[124:127], v[60:63], a[20:23]
    v_mfma_f32_16x16x32_bf16 a[24:27], v[124:127], v[64:67], a[24:27]
    v_mfma_f32_16x16x32_bf16 a[28:31], v[124:127], v[68:71], a[28:31]
    v_mfma_f32_16x16x32_bf16 a[32:35], v[128:131], v[56:59], a[32:35]
    v_mfma_f32_16x16x32_bf16 a[36:39], v[128:131], v[60:63], a[36:39]
    v_mfma_f32_16x16x32_bf16 a[40:43], v[128:131], v[64:67], a[40:43]
    v_mfma_f32_16x16x32_bf16 a[44:47], v[128:131], v[68:71], a[44:47]
    v_mfma_f32_16x16x32_bf16 a[48:51], v[132:135], v[56:59], a[48:51]
    v_mfma_f32_16x16x32_bf16 a[52:55], v[132:135], v[60:63], a[52:55]
    v_mfma_f32_16x16x32_bf16 a[56:59], v[132:135], v[64:67], a[56:59]
    v_mfma_f32_16x16x32_bf16 a[60:63], v[132:135], v[68:71], a[60:63]
    s_add_u32 m0, s72, 0x4000
    s_nop 0
    buffer_load_dwordx4 v136, s[44:47], s60 offen lds
    s_add_u32 m0, s72, 0x4400
    s_nop 0
    buffer_load_dwordx4 v137, s[44:47], s60 offen lds
    s_add_u32 m0, s72, 0x4800
    s_nop 0
    buffer_load_dwordx4 v138, s[44:47], s60 offen lds
    s_add_u32 m0, s72, 0x4c00
    s_nop 0
    buffer_load_dwordx4 v139, s[44:47], s60 offen lds
    s_add_u32 m0, s72, 0x5000
    s_nop 0
    buffer_load_dwordx4 v140, s[44:47], s60 offen lds
    s_add_u32 m0, s72, 0x5400
    s_nop 0
    buffer_load_dwordx4 v141, s[44:47], s60 offen lds
    s_add_u32 m0, s72, 0x5800
    s_nop 0
    buffer_load_dwordx4 v142, s[44:47], s60 offen lds
    s_add_u32 m0, s72, 0x5c00
    s_nop 0
    buffer_load_dwordx4 v143, s[44:47], s60 offen lds
    s_add_u32 s60, s60, 0x80
    buffer_load_dwordx4 v[120:123], v6, s[48:51], s61 offen
    buffer_load_dwordx4 v[124:127], v7, s[48:51], s61 offen
    buffer_load_dwordx4 v[128:131], v8, s[48:51], s61 offen
    buffer_load_dwordx4 v[132:135], v9, s[48:51], s61 offen
    s_add_u32 s61, s61, 0x400
    ds_read_b128 v[56:59], v145 offset:0
    ds_read_b128 v[60:63], v145 offset:2048
    ds_read_b128 v[64:67], v145 offset:4096
    ds_read_b128 v[68:71], v145 offset:6144
    s_waitcnt lgkmcnt(4)
    s_waitcnt vmcnt(28)
    v_mfma_f32_16x16x32_bf16 a[0:3], v[72:75], v[40:43], a[0:3]
    v_mfma_f32_16x16x32_bf16 a[4:7], v[72:75], v[44:47], a[4:7]
    v_mfma_f32_16x16x32_bf16 a[8:11], v[72:75], v[48:51], a[8:11]
    v_mfma_f32_16x16x32_bf16 a[12:15], v[72:75], v[52:55], a[12:15]
    v_mfma_f32_16x16x32_bf16 a[16:19], v[76:79], v[40:43], a[16:19]
    v_mfma_f32_16x16x32_bf16 a[20:23], v[76:79], v[44:47], a[20:23]
    v_mfma_f32_16x16x32_bf16 a[24:27], v[76:79], v[48:51], a[24:27]
    v_mfma_f32_16x16x32_bf16 a[28:31], v[76:79], v[52:55], a[28:31]
    v_mfma_f32_16x16x32_bf16 a[32:35], v[80:83], v[40:43], a[32:35]
    v_mfma_f32_16x16x32_bf16 a[36:39], v[80:83], v[44:47], a[36:39]
    v_mfma_f32_16x16x32_bf16 a[40:43], v[80:83], v[48:51], a[40:43]
    v_mfma_f32_16x16x32_bf16 a[44:47], v[80:83], v[52:55], a[44:47]
    v_mfma_f32_16x16x32_bf16 a[48:51], v[84:87], v[40:43], a[48:51]
    v_mfma_f32_16x16x32_bf16 a[52:55], v[84:87], v[44:47], a[52:55]
    v_mfma_f32_16x16x32_bf16 a[56:59], v[84:87], v[48:51], a[56:59]
    v_mfma_f32_16x16x32_bf16 a[60:63], v[84:87], v[52:55], a[60:63]
    buffer_load_dwordx4 v[72:75], v6, s[48:51], s61 offen
    buffer_load_dwordx4 v[76:79], v7, s[48:51], s61 offen
    buffer_load_dwordx4 v[80:83], v8, s[48:51], s61 offen
    buffer_load_dwordx4 v[84:87], v9, s[48:51], s61 offen
    s_add_u32 s61, s61, 0x400
    s_waitcnt vmcnt(24)
    ds_read_b128 v[40:43], v144 offset:8192
    ds_read_b128 v[44:47], v144 offset:10240
    ds_read_b128 v[48:51], v144 offset:12288
    ds_read_b128 v[52:55], v144 offset:14336
    s_waitcnt lgkmcnt(4)
    s_waitcnt vmcnt(20)
    v_mfma_f32_16x16x32_bf16 a[0:3], v[88:91], v[56:59], a[0:3]
    v_mfma_f32_16x16x32_bf16 a[4:7], v[88:91], v[60:63], a[4:7]
    v_mfma_f32_16x16x32_bf16 a[8:11], v[88:91], v[64:67], a[8:11]
    v_mfma_f32_16x16x32_bf16 a[12:15], v[88:91], v[68:71], a[12:15]
    v_mfma_f32_16x16x32_bf16 a[16:19], v[92:95], v[56:59], a[16:19]
    v_mfma_f32_16x16x32_bf16 a[20:23], v[92:95], v[60:63], a[20:23]
    v_mfma_f32_16x16x32_bf16 a[24:27], v[92:95], v[64:67], a[24:27]
    v_mfma_f32_16x16x32_bf16 a[28:31], v[92:95], v[68:71], a[28:31]
    v_mfma_f32_16x16x32_bf16 a[32:35], v[96:99], v[56:59], a[32:35]
    v_mfma_f32_16x16x32_bf16 a[36:39], v[96:99], v[60:63], a[36:39]
    v_mfma_f32_16x16x32_bf16 a[40:43], v[96:99], v[64:67], a[40:43]
    v_mfma_f32_16x16x32_bf16 a[44:47], v[96:99], v[68:71], a[44:47]
    v_mfma_f32_16x16x32_bf16 a[48:51], v[100:103], v[56:59], a[48:51]
    v_mfma_f32_16x16x32_bf16 a[52:55], v[100:103], v[60:63], a[52:55]
    v_mfma_f32_16x16x32_bf16 a[56:59], v[100:103], v[64:67], a[56:59]
    v_mfma_f32_16x16x32_bf16 a[60:63], v[100:103], v[68:71], a[60:63]
    s_add_u32 m0, s72, 0x0
    s_nop 0
    buffer_load_dwordx4 v136, s[44:47], s60 offen lds
    s_add_u32 m0, s72, 0x400
    s_nop 0
    buffer_load_dwordx4 v137, s[44:47], s60 offen lds
    s_add_u32 m0, s72, 0x800
    s_nop 0
    buffer_load_dwordx4 v138, s[44:47], s60 offen lds
    s_add_u32 m0, s72, 0xc00
    s_nop 0
    buffer_load_dwordx4 v139, s[44:47], s60 offen lds
    s_add_u32 m0, s72, 0x1000
    s_nop 0
    buffer_load_dwordx4 v140, s[44:47], s60 offen lds
    s_add_u32 m0, s72, 0x1400
    s_nop 0
    buffer_load_dwordx4 v141, s[44:47], s60 offen lds
    s_add_u32 m0, s72, 0x1800
    s_nop 0
    buffer_load_dwordx4 v142, s[44:47], s60 offen lds
    s_add_u32 m0, s72, 0x1c00
    s_nop 0
    buffer_load_dwordx4 v143, s[44:47], s60 offen lds
    s_add_u32 s60, s60, 0x80
    buffer_load_dwordx4 v[88:91], v6, s[48:51], s61 offen
    buffer_load_dwordx4 v[92:95], v7, s[48:51], s61 offen
    buffer_load_dwordx4 v[96:99], v8, s[48:51], s61 offen
    buffer_load_dwordx4 v[100:103], v9, s[48:51], s61 offen
    s_add_u32 s61, s61, 0x400
    ds_read_b128 v[56:59], v145 offset:8192
    ds_read_b128 v[60:63], v145 offset:10240
    ds_read_b128 v[64:67], v145 offset:12288
    ds_read_b128 v[68:71], v145 offset:14336
    s_waitcnt lgkmcnt(4)
    s_waitcnt vmcnt(28)
    v_mfma_f32_16x16x32_bf16 a[0:3], v[104:107], v[40:43], a[0:3]
    v_mfma_f32_16x16x32_bf16 a[4:7], v[104:107], v[44:47], a[4:7]
    v_mfma_f32_16x16x32_bf16 a[8:11], v[104:107], v[48:51], a[8:11]
    v_mfma_f32_16x16x32_bf16 a[12:15], v[104:107], v[52:55], a[12:15]
    v_mfma_f32_16x16x32_bf16 a[16:19], v[108:111], v[40:43], a[16:19]
    v_mfma_f32_16x16x32_bf16 a[20:23], v[108:111], v[44:47], a[20:23]
    v_mfma_f32_16x16x32_bf16 a[24:27], v[108:111], v[48:51], a[24:27]
    v_mfma_f32_16x16x32_bf16 a[28:31], v[108:111], v[52:55], a[28:31]
    v_mfma_f32_16x16x32_bf16 a[32:35], v[112:115], v[40:43], a[32:35]
    v_mfma_f32_16x16x32_bf16 a[36:39], v[112:115], v[44:47], a[36:39]
    v_mfma_f32_16x16x32_bf16 a[40:43], v[112:115], v[48:51], a[40:43]
    v_mfma_f32_16x16x32_bf16 a[44:47], v[112:115], v[52:55], a[44:47]
    v_mfma_f32_16x16x32_bf16 a[48:51], v[116:119], v[40:43], a[48:51]
    v_mfma_f32_16x16x32_bf16 a[52:55], v[116:119], v[44:47], a[52:55]
    v_mfma_f32_16x16x32_bf16 a[56:59], v[116:119], v[48:51], a[56:59]
    v_mfma_f32_16x16x32_bf16 a[60:63], v[116:119], v[52:55], a[60:63]
    buffer_load_dwordx4 v[104:107], v6, s[48:51], s61 offen
    buffer_load_dwordx4 v[108:111], v7, s[48:51], s61 offen
    buffer_load_dwordx4 v[112:115], v8, s[48:51], s61 offen
    buffer_load_dwordx4 v[116:119], v9, s[48:51], s61 offen
    s_add_u32 s61, s61, 0x400
    s_waitcnt vmcnt(24)
    ds_read_b128 v[40:43], v144 offset:16384
    ds_read_b128 v[44:47], v144 offset:18432
    ds_read_b128 v[48:51], v144 offset:20480
    ds_read_b128 v[52:55], v144 offset:22528
    s_waitcnt lgkmcnt(4)
    s_waitcnt vmcnt(20)
    v_mfma_f32_16x16x32_bf16 a[0:3], v[120:123], v[56:59], a[0:3]
    v_mfma_f32_16x16x32_bf16 a[4:7], v[120:123], v[60:63], a[4:7]
    v_mfma_f32_16x16x32_bf16 a[8:11], v[120:123], v[64:67], a[8:11]
    v_mfma_f32_16x16x32_bf16 a[12:15], v[120:123], v[68:71], a[12:15]
    v_mfma_f32_16x16x32_bf16 a[16:19], v[124:127], v[56:59], a[16:19]
    v_mfma_f32_16x16x32_bf16 a[20:23], v[124:127], v[60:63], a[20:23]
    v_mfma_f32_16x16x32_bf16 a[24:27], v[124:127], v[64:67], a[24:27]
    v_mfma_f32_16x16x32_bf16 a[28:31], v[124:127], v[68:71], a[28:31]
    v_mfma_f32_16x16x32_bf16 a[32:35], v[128:131], v[56:59], a[32:35]
    v_mfma_f32_16x16x32_bf16 a[36:39], v[128:131], v[60:63], a[36:39]
    v_mfma_f32_16x16x32_bf16 a[40:43], v[128:131], v[64:67], a[40:43]
    v_mfma_f32_16x16x32_bf16 a[44:47], v[128:131], v[68:71], a[44:47]
    v_mfma_f32_16x16x32_bf16 a[48:51], v[132:135], v[56:59], a[48:51]
    v_mfma_f32_16x16x32_bf16 a[52:55], v[132:135], v[60:63], a[52:55]
    v_mfma_f32_16x16x32_bf16 a[56:59], v[132:135], v[64:67], a[56:59]
    v_mfma_f32_16x16x32_bf16 a[60:63], v[132:135], v[68:71], a[60:63]
    s_add_u32 m0, s72, 0x2000
    s_nop 0
    buffer_load_dwordx4 v136, s[44:47], s60 offen lds
    s_add_u32 m0, s72, 0x2400
    s_nop 0
    buffer_load_dwordx4 v137, s[44:47], s60 offen lds
    s_add_u32 m0, s72, 0x2800
    s_nop 0
    buffer_load_dwordx4 v138, s[44:47], s60 offen lds
    s_add_u32 m0, s72, 0x2c00
    s_nop 0
    buffer_load_dwordx4 v139, s[44:47], s60 offen lds
    s_add_u32 m0, s72, 0x3000
    s_nop 0
    buffer_load_dwordx4 v140, s[44:47], s60 offen lds
    s_add_u32 m0, s72, 0x3400
    s_nop 0
    buffer_load_dwordx4 v141, s[44:47], s60 offen lds
    s_add_u32 m0, s72, 0x3800
    s_nop 0
    buffer_load_dwordx4 v142, s[44:47], s60 offen lds
    s_add_u32 m0, s72, 0x3c00
    s_nop 0
    buffer_load_dwordx4 v143, s[44:47], s60 offen lds
    s_add_u32 s60, s60, 0x80
    buffer_load_dwordx4 v[120:123], v6, s[48:51], s61 offen
    buffer_load_dwordx4 v[124:127], v7, s[48:51], s61 offen
    buffer_load_dwordx4 v[128:131], v8, s[48:51], s61 offen
    buffer_load_dwordx4 v[132:135], v9, s[48:51], s61 offen
    s_add_u32 s61, s61, 0x400
    ds_read_b128 v[56:59], v145 offset:16384
    ds_read_b128 v[60:63], v145 offset:18432
    ds_read_b128 v[64:67], v145 offset:20480
    ds_read_b128 v[68:71], v145 offset:22528
    s_waitcnt lgkmcnt(4)
    s_waitcnt vmcnt(28)
    v_mfma_f32_16x16x32_bf16 a[0:3], v[72:75], v[40:43], a[0:3]
    v_mfma_f32_16x16x32_bf16 a[4:7], v[72:75], v[44:47], a[4:7]
    v_mfma_f32_16x16x32_bf16 a[8:11], v[72:75], v[48:51], a[8:11]
    v_mfma_f32_16x16x32_bf16 a[12:15], v[72:75], v[52:55], a[12:15]
    v_mfma_f32_16x16x32_bf16 a[16:19], v[76:79], v[40:43], a[16:19]
    v_mfma_f32_16x16x32_bf16 a[20:23], v[76:79], v[44:47], a[20:23]
    v_mfma_f32_16x16x32_bf16 a[24:27], v[76:79], v[48:51], a[24:27]
    v_mfma_f32_16x16x32_bf16 a[28:31], v[76:79], v[52:55], a[28:31]
    v_mfma_f32_16x16x32_bf16 a[32:35], v[80:83], v[40:43], a[32:35]
    v_mfma_f32_16x16x32_bf16 a[36:39], v[80:83], v[44:47], a[36:39]
    v_mfma_f32_16x16x32_bf16 a[40:43], v[80:83], v[48:51], a[40:43]
    v_mfma_f32_16x16x32_bf16 a[44:47], v[80:83], v[52:55], a[44:47]
    v_mfma_f32_16x16x32_bf16 a[48:51], v[84:87], v[40:43], a[48:51]
    v_mfma_f32_16x16x32_bf16 a[52:55], v[84:87], v[44:47], a[52:55]
    v_mfma_f32_16x16x32_bf16 a[56:59], v[84:87], v[48:51], a[56:59]
    v_mfma_f32_16x16x32_bf16 a[60:63], v[84:87], v[52:55], a[60:63]
    buffer_load_dwordx4 v[72:75], v6, s[48:51], s61 offen
    buffer_load_dwordx4 v[76:79], v7, s[48:51], s61 offen
    buffer_load_dwordx4 v[80:83], v8, s[48:51], s61 offen
    buffer_load_dwordx4 v[84:87], v9, s[48:51], s61 offen
    s_add_u32 s61, s61, 0x400
    s_waitcnt vmcnt(24)
    ds_read_b128 v[40:43], v144 offset:0
    ds_read_b128 v[44:47], v144 offset:2048
    ds_read_b128 v[48:51], v144 offset:4096
    ds_read_b128 v[52:55], v144 offset:6144
    s_waitcnt lgkmcnt(4)
    s_waitcnt vmcnt(20)
    v_mfma_f32_16x16x32_bf16 a[0:3], v[88:91], v[56:59], a[0:3]
    v_mfma_f32_16x16x32_bf16 a[4:7], v[88:91], v[60:63], a[4:7]
    v_mfma_f32_16x16x32_bf16 a[8:11], v[88:91], v[64:67], a[8:11]
    v_mfma_f32_16x16x32_bf16 a[12:15], v[88:91], v[68:71], a[12:15]
    v_mfma_f32_16x16x32_bf16 a[16:19], v[92:95], v[56:59], a[16:19]
    v_mfma_f32_16x16x32_bf16 a[20:23], v[92:95], v[60:63], a[20:23]
    v_mfma_f32_16x16x32_bf16 a[24:27], v[92:95], v[64:67], a[24:27]
    v_mfma_f32_16x16x32_bf16 a[28:31], v[92:95], v[68:71], a[28:31]
    v_mfma_f32_16x16x32_bf16 a[32:35], v[96:99], v[56:59], a[32:35]
    v_mfma_f32_16x16x32_bf16 a[36:39], v[96:99], v[60:63], a[36:39]
    v_mfma_f32_16x16x32_bf16 a[40:43], v[96:99], v[64:67], a[40:43]
    v_mfma_f32_16x16x32_bf16 a[44:47], v[96:99], v[68:71], a[44:47]
    v_mfma_f32_16x16x32_bf16 a[48:51], v[100:103], v[56:59], a[48:51]
    v_mfma_f32_16x16x32_bf16 a[52:55], v[100:103], v[60:63], a[52:55]
    v_mfma_f32_16x16x32_bf16 a[56:59], v[100:103], v[64:67], a[56:59]
    v_mfma_f32_16x16x32_bf16 a[60:63], v[100:103], v[68:71], a[60:63]
    s_add_u32 m0, s72, 0x4000
    s_nop 0
    buffer_load_dwordx4 v136, s[44:47], s60 offen lds
    s_add_u32 m0, s72, 0x4400
    s_nop 0
    buffer_load_dwordx4 v137, s[44:47], s60 offen lds
    s_add_u32 m0, s72, 0x4800
    s_nop 0
    buffer_load_dwordx4 v138, s[44:47], s60 offen lds
    s_add_u32 m0, s72, 0x4c00
    s_nop 0
    buffer_load_dwordx4 v139, s[44:47], s60 offen lds
    s_add_u32 m0, s72, 0x5000
    s_nop 0
    buffer_load_dwordx4 v140, s[44:47], s60 offen lds
    s_add_u32 m0, s72, 0x5400
    s_nop 0
    buffer_load_dwordx4 v141, s[44:47], s60 offen lds
    s_add_u32 m0, s72, 0x5800
    s_nop 0
    buffer_load_dwordx4 v142, s[44:47], s60 offen lds
    s_add_u32 m0, s72, 0x5c00
    s_nop 0
    buffer_load_dwordx4 v143, s[44:47], s60 offen lds
    s_add_u32 s60, s60, 0x80
    buffer_load_dwordx4 v[88:91], v6, s[48:51], s61 offen
    buffer_load_dwordx4 v[92:95], v7, s[48:51], s61 offen
    buffer_load_dwordx4 v[96:99], v8, s[48:51], s61 offen
    buffer_load_dwordx4 v[100:103], v9, s[48:51], s61 offen
    s_add_u32 s61, s61, 0x400
    ds_read_b128 v[56:59], v145 offset:0
    ds_read_b128 v[60:63], v145 offset:2048
    ds_read_b128 v[64:67], v145 offset:4096
    ds_read_b128 v[68:71], v145 offset:6144
    s_waitcnt lgkmcnt(4)
    s_waitcnt vmcnt(28)
    v_mfma_f32_16x16x32_bf16 a[0:3], v[104:107], v[40:43], a[0:3]
    v_mfma_f32_16x16x32_bf16 a[4:7], v[104:107], v[44:47], a[4:7]
    v_mfma_f32_16x16x32_bf16 a[8:11], v[104:107], v[48:51], a[8:11]
    v_mfma_f32_16x16x32_bf16 a[12:15], v[104:107], v[52:55], a[12:15]
    v_mfma_f32_16x16x32_bf16 a[16:19], v[108:111], v[40:43], a[16:19]
    v_mfma_f32_16x16x32_bf16 a[20:23], v[108:111], v[44:47], a[20:23]
    v_mfma_f32_16x16x32_bf16 a[24:27], v[108:111], v[48:51], a[24:27]
    v_mfma_f32_16x16x32_bf16 a[28:31], v[108:111], v[52:55], a[28:31]
    v_mfma_f32_16x16x32_bf16 a[32:35], v[112:115], v[40:43], a[32:35]
    v_mfma_f32_16x16x32_bf16 a[36:39], v[112:115], v[44:47], a[36:39]
    v_mfma_f32_16x16x32_bf16 a[40:43], v[112:115], v[48:51], a[40:43]
    v_mfma_f32_16x16x32_bf16 a[44:47], v[112:115], v[52:55], a[44:47]
    v_mfma_f32_16x16x32_bf16 a[48:51], v[116:119], v[40:43], a[48:51]
    v_mfma_f32_16x16x32_bf16 a[52:55], v[116:119], v[44:47], a[52:55]
    v_mfma_f32_16x16x32_bf16 a[56:59], v[116:119], v[48:51], a[56:59]
    v_mfma_f32_16x16x32_bf16 a[60:63], v[116:119], v[52:55], a[60:63]
    buffer_load_dwordx4 v[104:107], v6, s[48:51], s61 offen
    buffer_load_dwordx4 v[108:111], v7, s[48:51], s61 offen
    buffer_load_dwordx4 v[112:115], v8, s[48:51], s61 offen
    buffer_load_dwordx4 v[116:119], v9, s[48:51], s61 offen
    s_add_u32 s61, s61, 0x400
    s_waitcnt vmcnt(24)
    ds_read_b128 v[40:43], v144 offset:8192
    ds_read_b128 v[44:47], v144 offset:10240
    ds_read_b128 v[48:51], v144 offset:12288
    ds_read_b128 v[52:55], v144 offset:14336
    s_waitcnt lgkmcnt(4)
    s_waitcnt vmcnt(20)
    v_mfma_f32_16x16x32_bf16 a[0:3], v[120:123], v[56:59], a[0:3]
    v_mfma_f32_16x16x32_bf16 a[4:7], v[120:123], v[60:63], a[4:7]
    v_mfma_f32_16x16x32_bf16 a[8:11], v[120:123], v[64:67], a[8:11]
    v_mfma_f32_16x16x32_bf16 a[12:15], v[120:123], v[68:71], a[12:15]
    v_mfma_f32_16x16x32_bf16 a[16:19], v[124:127], v[56:59], a[16:19]
    v_mfma_f32_16x16x32_bf16 a[20:23], v[124:127], v[60:63], a[20:23]
    v_mfma_f32_16x16x32_bf16 a[24:27], v[124:127], v[64:67], a[24:27]
    v_mfma_f32_16x16x32_bf16 a[28:31], v[124:127], v[68:71], a[28:31]
    v_mfma_f32_16x16x32_bf16 a[32:35], v[128:131], v[56:59], a[32:35]
    v_mfma_f32_16x16x32_bf16 a[36:39], v[128:131], v[60:63], a[36:39]
    v_mfma_f32_16x16x32_bf16 a[40:43], v[128:131], v[64:67], a[40:43]
    v_mfma_f32_16x16x32_bf16 a[44:47], v[128:131], v[68:71], a[44:47]
    v_mfma_f32_16x16x32_bf16 a[48:51], v[132:135], v[56:59], a[48:51]
    v_mfma_f32_16x16x32_bf16 a[52:55], v[132:135], v[60:63], a[52:55]
    v_mfma_f32_16x16x32_bf16 a[56:59], v[132:135], v[64:67], a[56:59]
    v_mfma_f32_16x16x32_bf16 a[60:63], v[132:135], v[68:71], a[60:63]
    s_add_u32 m0, s72, 0x0
    s_nop 0
    buffer_load_dwordx4 v136, s[44:47], s60 offen lds
    s_add_u32 m0, s72, 0x400
    s_nop 0
    buffer_load_dwordx4 v137, s[44:47], s60 offen lds
    s_add_u32 m0, s72, 0x800
    s_nop 0
    buffer_load_dwordx4 v138, s[44:47], s60 offen lds
    s_add_u32 m0, s72, 0xc00
    s_nop 0
    buffer_load_dwordx4 v139, s[44:47], s60 offen lds
    s_add_u32 m0, s72, 0x1000
    s_nop 0
    buffer_load_dwordx4 v140, s[44:47], s60 offen lds
    s_add_u32 m0, s72, 0x1400
    s_nop 0
    buffer_load_dwordx4 v141, s[44:47], s60 offen lds
    s_add_u32 m0, s72, 0x1800
    s_nop 0
    buffer_load_dwordx4 v142, s[44:47], s60 offen lds
    s_add_u32 m0, s72, 0x1c00
    s_nop 0
    buffer_load_dwordx4 v143, s[44:47], s60 offen lds
    s_add_u32 s60, s60, 0x80
    buffer_load_dwordx4 v[120:123], v6, s[48:51], s61 offen
    buffer_load_dwordx4 v[124:127], v7, s[48:51], s61 offen
    buffer_load_dwordx4 v[128:131], v8, s[48:51], s61 offen
    buffer_load_dwordx4 v[132:135], v9, s[48:51], s61 offen
    s_add_u32 s61, s61, 0x400
    ds_read_b128 v[56:59], v145 offset:8192
    ds_read_b128 v[60:63], v145 offset:10240
    ds_read_b128 v[64:67], v145 offset:12288
    ds_read_b128 v[68:71], v145 offset:14336
    s_waitcnt lgkmcnt(4)
    s_waitcnt vmcnt(28)
    v_mfma_f32_16x16x32_bf16 a[0:3], v[72:75], v[40:43], a[0:3]
    v_mfma_f32_16x16x32_bf16 a[4:7], v[72:75], v[44:47], a[4:7]
    v_mfma_f32_16x16x32_bf16 a[8:11], v[72:75], v[48:51], a[8:11]
    v_mfma_f32_16x16x32_bf16 a[12:15], v[72:75], v[52:55], a[12:15]
    v_mfma_f32_16x16x32_bf16 a[16:19], v[76:79], v[40:43], a[16:19]
    v_mfma_f32_16x16x32_bf16 a[20:23], v[76:79], v[44:47], a[20:23]
    v_mfma_f32_16x16x32_bf16 a[24:27], v[76:79], v[48:51], a[24:27]
    v_mfma_f32_16x16x32_bf16 a[28:31], v[76:79], v[52:55], a[28:31]
    v_mfma_f32_16x16x32_bf16 a[32:35], v[80:83], v[40:43], a[32:35]
    v_mfma_f32_16x16x32_bf16 a[36:39], v[80:83], v[44:47], a[36:39]
    v_mfma_f32_16x16x32_bf16 a[40:43], v[80:83], v[48:51], a[40:43]
    v_mfma_f32_16x16x32_bf16 a[44:47], v[80:83], v[52:55], a[44:47]
    v_mfma_f32_16x16x32_bf16 a[48:51], v[84:87], v[40:43], a[48:51]
    v_mfma_f32_16x16x32_bf16 a[52:55], v[84:87], v[44:47], a[52:55]
    v_mfma_f32_16x16x32_bf16 a[56:59], v[84:87], v[48:51], a[56:59]
    v_mfma_f32_16x16x32_bf16 a[60:63], v[84:87], v[52:55], a[60:63]
    buffer_load_dwordx4 v[72:75], v6, s[48:51], s61 offen
    buffer_load_dwordx4 v[76:79], v7, s[48:51], s61 offen
    buffer_load_dwordx4 v[80:83], v8, s[48:51], s61 offen
    buffer_load_dwordx4 v[84:87], v9, s[48:51], s61 offen
    s_add_u32 s61, s61, 0x400
    s_waitcnt vmcnt(24)
    ds_read_b128 v[40:43], v144 offset:16384
    ds_read_b128 v[44:47], v144 offset:18432
    ds_read_b128 v[48:51], v144 offset:20480
    ds_read_b128 v[52:55], v144 offset:22528
    s_waitcnt lgkmcnt(4)
    s_waitcnt vmcnt(20)
    v_mfma_f32_16x16x32_bf16 a[0:3], v[88:91], v[56:59], a[0:3]
    v_mfma_f32_16x16x32_bf16 a[4:7], v[88:91], v[60:63], a[4:7]
    v_mfma_f32_16x16x32_bf16 a[8:11], v[88:91], v[64:67], a[8:11]
    v_mfma_f32_16x16x32_bf16 a[12:15], v[88:91], v[68:71], a[12:15]
    v_mfma_f32_16x16x32_bf16 a[16:19], v[92:95], v[56:59], a[16:19]
    v_mfma_f32_16x16x32_bf16 a[20:23], v[92:95], v[60:63], a[20:23]
    v_mfma_f32_16x16x32_bf16 a[24:27], v[92:95], v[64:67], a[24:27]
    v_mfma_f32_16x16x32_bf16 a[28:31], v[92:95], v[68:71], a[28:31]
    v_mfma_f32_16x16x32_bf16 a[32:35], v[96:99], v[56:59], a[32:35]
    v_mfma_f32_16x16x32_bf16 a[36:39], v[96:99], v[60:63], a[36:39]
    v_mfma_f32_16x16x32_bf16 a[40:43], v[96:99], v[64:67], a[40:43]
    v_mfma_f32_16x16x32_bf16 a[44:47], v[96:99], v[68:71], a[44:47]
    v_mfma_f32_16x16x32_bf16 a[48:51], v[100:103], v[56:59], a[48:51]
    v_mfma_f32_16x16x32_bf16 a[52:55], v[100:103], v[60:63], a[52:55]
    v_mfma_f32_16x16x32_bf16 a[56:59], v[100:103], v[64:67], a[56:59]
    v_mfma_f32_16x16x32_bf16 a[60:63], v[100:103], v[68:71], a[60:63]
    s_add_u32 m0, s72, 0x2000
    s_nop 0
    buffer_load_dwordx4 v136, s[44:47], s60 offen lds
    s_add_u32 m0, s72, 0x2400
    s_nop 0
    buffer_load_dwordx4 v137, s[44:47], s60 offen lds
    s_add_u32 m0, s72, 0x2800
    s_nop 0
    buffer_load_dwordx4 v138, s[44:47], s60 offen lds
    s_add_u32 m0, s72, 0x2c00
    s_nop 0
    buffer_load_dwordx4 v139, s[44:47], s60 offen lds
    s_add_u32 m0, s72, 0x3000
    s_nop 0
    buffer_load_dwordx4 v140, s[44:47], s60 offen lds
    s_add_u32 m0, s72, 0x3400
    s_nop 0
    buffer_load_dwordx4 v141, s[44:47], s60 offen lds
    s_add_u32 m0, s72, 0x3800
    s_nop 0
    buffer_load_dwordx4 v142, s[44:47], s60 offen lds
    s_add_u32 m0, s72, 0x3c00
    s_nop 0
    buffer_load_dwordx4 v143, s[44:47], s60 offen lds
    s_add_u32 s60, s60, 0x80
    buffer_load_dwordx4 v[88:91], v6, s[48:51], s61 offen
    buffer_load_dwordx4 v[92:95], v7, s[48:51], s61 offen
    buffer_load_dwordx4 v[96:99], v8, s[48:51], s61 offen
    buffer_load_dwordx4 v[100:103], v9, s[48:51], s61 offen
    s_add_u32 s61, s61, 0x400
    ds_read_b128 v[56:59], v145 offset:16384
    ds_read_b128 v[60:63], v145 offset:18432
    ds_read_b128 v[64:67], v145 offset:20480
    ds_read_b128 v[68:71], v145 offset:22528
    s_waitcnt lgkmcnt(4)
    s_waitcnt vmcnt(28)
    v_mfma_f32_16x16x32_bf16 a[0:3], v[104:107], v[40:43], a[0:3]
    v_mfma_f32_16x16x32_bf16 a[4:7], v[104:107], v[44:47], a[4:7]
    v_mfma_f32_16x16x32_bf16 a[8:11], v[104:107], v[48:51], a[8:11]
    v_mfma_f32_16x16x32_bf16 a[12:15], v[104:107], v[52:55], a[12:15]
    v_mfma_f32_16x16x32_bf16 a[16:19], v[108:111], v[40:43], a[16:19]
    v_mfma_f32_16x16x32_bf16 a[20:23], v[108:111], v[44:47], a[20:23]
    v_mfma_f32_16x16x32_bf16 a[24:27], v[108:111], v[48:51], a[24:27]
    v_mfma_f32_16x16x32_bf16 a[28:31], v[108:111], v[52:55], a[28:31]
    v_mfma_f32_16x16x32_bf16 a[32:35], v[112:115], v[40:43], a[32:35]
    v_mfma_f32_16x16x32_bf16 a[36:39], v[112:115], v[44:47], a[36:39]
    v_mfma_f32_16x16x32_bf16 a[40:43], v[112:115], v[48:51], a[40:43]
    v_mfma_f32_16x16x32_bf16 a[44:47], v[112:115], v[52:55], a[44:47]
    v_mfma_f32_16x16x32_bf16 a[48:51], v[116:119], v[40:43], a[48:51]
    v_mfma_f32_16x16x32_bf16 a[52:55], v[116:119], v[44:47], a[52:55]
    v_mfma_f32_16x16x32_bf16 a[56:59], v[116:119], v[48:51], a[56:59]
    v_mfma_f32_16x16x32_bf16 a[60:63], v[116:119], v[52:55], a[60:63]
    buffer_load_dwordx4 v[104:107], v6, s[48:51], s61 offen
    buffer_load_dwordx4 v[108:111], v7, s[48:51], s61 offen
    buffer_load_dwordx4 v[112:115], v8, s[48:51], s61 offen
    buffer_load_dwordx4 v[116:119], v9, s[48:51], s61 offen
    s_add_u32 s61, s61, 0x400
    s_waitcnt vmcnt(24)
    ds_read_b128 v[40:43], v144 offset:0
    ds_read_b128 v[44:47], v144 offset:2048
    ds_read_b128 v[48:51], v144 offset:4096
    ds_read_b128 v[52:55], v144 offset:6144
    s_waitcnt lgkmcnt(4)
    s_waitcnt vmcnt(20)
    v_mfma_f32_16x16x32_bf16 a[0:3], v[120:123], v[56:59], a[0:3]
    v_mfma_f32_16x16x32_bf16 a[4:7], v[120:123], v[60:63], a[4:7]
    v_mfma_f32_16x16x32_bf16 a[8:11], v[120:123], v[64:67], a[8:11]
    v_mfma_f32_16x16x32_bf16 a[12:15], v[120:123], v[68:71], a[12:15]
    v_mfma_f32_16x16x32_bf16 a[16:19], v[124:127], v[56:59], a[16:19]
    v_mfma_f32_16x16x32_bf16 a[20:23], v[124:127], v[60:63], a[20:23]
    v_mfma_f32_16x16x32_bf16 a[24:27], v[124:127], v[64:67], a[24:27]
    v_mfma_f32_16x16x32_bf16 a[28:31], v[124:127], v[68:71], a[28:31]
    v_mfma_f32_16x16x32_bf16 a[32:35], v[128:131], v[56:59], a[32:35]
    v_mfma_f32_16x16x32_bf16 a[36:39], v[128:131], v[60:63], a[36:39]
    v_mfma_f32_16x16x32_bf16 a[40:43], v[128:131], v[64:67], a[40:43]
    v_mfma_f32_16x16x32_bf16 a[44:47], v[128:131], v[68:71], a[44:47]
    v_mfma_f32_16x16x32_bf16 a[48:51], v[132:135], v[56:59], a[48:51]
    v_mfma_f32_16x16x32_bf16 a[52:55], v[132:135], v[60:63], a[52:55]
    v_mfma_f32_16x16x32_bf16 a[56:59], v[132:135], v[64:67], a[56:59]
    v_mfma_f32_16x16x32_bf16 a[60:63], v[132:135], v[68:71], a[60:63]
    s_add_u32 m0, s72, 0x4000
    s_nop 0
    buffer_load_dwordx4 v136, s[44:47], s60 offen lds
    s_add_u32 m0, s72, 0x4400
    s_nop 0
    buffer_load_dwordx4 v137, s[44:47], s60 offen lds
    s_add_u32 m0, s72, 0x4800
    s_nop 0
    buffer_load_dwordx4 v138, s[44:47], s60 offen lds
    s_add_u32 m0, s72, 0x4c00
    s_nop 0
    buffer_load_dwordx4 v139, s[44:47], s60 offen lds
    s_add_u32 m0, s72, 0x5000
    s_nop 0
    buffer_load_dwordx4 v140, s[44:47], s60 offen lds
    s_add_u32 m0, s72, 0x5400
    s_nop 0
    buffer_load_dwordx4 v141, s[44:47], s60 offen lds
    s_add_u32 m0, s72, 0x5800
    s_nop 0
    buffer_load_dwordx4 v142, s[44:47], s60 offen lds
    s_add_u32 m0, s72, 0x5c00
    s_nop 0
    buffer_load_dwordx4 v143, s[44:47], s60 offen lds
    s_add_u32 s60, s60, 0x80
    buffer_load_dwordx4 v[120:123], v6, s[48:51], s61 offen
    buffer_load_dwordx4 v[124:127], v7, s[48:51], s61 offen
    buffer_load_dwordx4 v[128:131], v8, s[48:51], s61 offen
    buffer_load_dwordx4 v[132:135], v9, s[48:51], s61 offen
    s_add_u32 s61, s61, 0x400
    ds_read_b128 v[56:59], v145 offset:0
    ds_read_b128 v[60:63], v145 offset:2048
    ds_read_b128 v[64:67], v145 offset:4096
    ds_read_b128 v[68:71], v145 offset:6144
    s_waitcnt lgkmcnt(4)
    s_waitcnt vmcnt(28)
    v_mfma_f32_16x16x32_bf16 a[0:3], v[72:75], v[40:43], a[0:3]
    v_mfma_f32_16x16x32_bf16 a[4:7], v[72:75], v[44:47], a[4:7]
    v_mfma_f32_16x16x32_bf16 a[8:11], v[72:75], v[48:51], a[8:11]
    v_mfma_f32_16x16x32_bf16 a[12:15], v[72:75], v[52:55], a[12:15]
    v_mfma_f32_16x16x32_bf16 a[16:19], v[76:79], v[40:43], a[16:19]
    v_mfma_f32_16x16x32_bf16 a[20:23], v[76:79], v[44:47], a[20:23]
    v_mfma_f32_16x16x32_bf16 a[24:27], v[76:79], v[48:51], a[24:27]
    v_mfma_f32_16x16x32_bf16 a[28:31], v[76:79], v[52:55], a[28:31]
    v_mfma_f32_16x16x32_bf16 a[32:35], v[80:83], v[40:43], a[32:35]
    v_mfma_f32_16x16x32_bf16 a[36:39], v[80:83], v[44:47], a[36:39]
    v_mfma_f32_16x16x32_bf16 a[40:43], v[80:83], v[48:51], a[40:43]
    v_mfma_f32_16x16x32_bf16 a[44:47], v[80:83], v[52:55], a[44:47]
    v_mfma_f32_16x16x32_bf16 a[48:51], v[84:87], v[40:43], a[48:51]
    v_mfma_f32_16x16x32_bf16 a[52:55], v[84:87], v[44:47], a[52:55]
    v_mfma_f32_16x16x32_bf16 a[56:59], v[84:87], v[48:51], a[56:59]
    v_mfma_f32_16x16x32_bf16 a[60:63], v[84:87], v[52:55], a[60:63]
    buffer_load_dwordx4 v[72:75], v6, s[48:51], s61 offen
    buffer_load_dwordx4 v[76:79], v7, s[48:51], s61 offen
    buffer_load_dwordx4 v[80:83], v8, s[48:51], s61 offen
    buffer_load_dwordx4 v[84:87], v9, s[48:51], s61 offen
    s_add_u32 s61, s61, 0x400
    s_waitcnt vmcnt(24)
    ds_read_b128 v[40:43], v144 offset:8192
    ds_read_b128 v[44:47], v144 offset:10240
    ds_read_b128 v[48:51], v144 offset:12288
    ds_read_b128 v[52:55], v144 offset:14336
    s_waitcnt lgkmcnt(4)
    s_waitcnt vmcnt(20)
    v_mfma_f32_16x16x32_bf16 a[0:3], v[88:91], v[56:59], a[0:3]
    v_mfma_f32_16x16x32_bf16 a[4:7], v[88:91], v[60:63], a[4:7]
    v_mfma_f32_16x16x32_bf16 a[8:11], v[88:91], v[64:67], a[8:11]
    v_mfma_f32_16x16x32_bf16 a[12:15], v[88:91], v[68:71], a[12:15]
    v_mfma_f32_16x16x32_bf16 a[16:19], v[92:95], v[56:59], a[16:19]
    v_mfma_f32_16x16x32_bf16 a[20:23], v[92:95], v[60:63], a[20:23]
    v_mfma_f32_16x16x32_bf16 a[24:27], v[92:95], v[64:67], a[24:27]
    v_mfma_f32_16x16x32_bf16 a[28:31], v[92:95], v[68:71], a[28:31]
    v_mfma_f32_16x16x32_bf16 a[32:35], v[96:99], v[56:59], a[32:35]
    v_mfma_f32_16x16x32_bf16 a[36:39], v[96:99], v[60:63], a[36:39]
    v_mfma_f32_16x16x32_bf16 a[40:43], v[96:99], v[64:67], a[40:43]
    v_mfma_f32_16x16x32_bf16 a[44:47], v[96:99], v[68:71], a[44:47]
    v_mfma_f32_16x16x32_bf16 a[48:51], v[100:103], v[56:59], a[48:51]
    v_mfma_f32_16x16x32_bf16 a[52:55], v[100:103], v[60:63], a[52:55]
    v_mfma_f32_16x16x32_bf16 a[56:59], v[100:103], v[64:67], a[56:59]
    v_mfma_f32_16x16x32_bf16 a[60:63], v[100:103], v[68:71], a[60:63]
    s_add_u32 m0, s72, 0x0
    s_nop 0
    buffer_load_dwordx4 v136, s[44:47], s60 offen lds
    s_add_u32 m0, s72, 0x400
    s_nop 0
    buffer_load_dwordx4 v137, s[44:47], s60 offen lds
    s_add_u32 m0, s72, 0x800
    s_nop 0
    buffer_load_dwordx4 v138, s[44:47], s60 offen lds
    s_add_u32 m0, s72, 0xc00
    s_nop 0
    buffer_load_dwordx4 v139, s[44:47], s60 offen lds
    s_add_u32 m0, s72, 0x1000
    s_nop 0
    buffer_load_dwordx4 v140, s[44:47], s60 offen lds
    s_add_u32 m0, s72, 0x1400
    s_nop 0
    buffer_load_dwordx4 v141, s[44:47], s60 offen lds
    s_add_u32 m0, s72, 0x1800
    s_nop 0
    buffer_load_dwordx4 v142, s[44:47], s60 offen lds
    s_add_u32 m0, s72, 0x1c00
    s_nop 0
    buffer_load_dwordx4 v143, s[44:47], s60 offen lds
    s_add_u32 s60, s60, 0x80
    buffer_load_dwordx4 v[88:91], v6, s[48:51], s61 offen
    buffer_load_dwordx4 v[92:95], v7, s[48:51], s61 offen
    buffer_load_dwordx4 v[96:99], v8, s[48:51], s61 offen
    buffer_load_dwordx4 v[100:103], v9, s[48:51], s61 offen
    s_add_u32 s61, s61, 0x400
    ds_read_b128 v[56:59], v145 offset:8192
    ds_read_b128 v[60:63], v145 offset:10240
    ds_read_b128 v[64:67], v145 offset:12288
    ds_read_b128 v[68:71], v145 offset:14336
    s_waitcnt lgkmcnt(4)
    s_waitcnt vmcnt(28)
    v_mfma_f32_16x16x32_bf16 a[0:3], v[104:107], v[40:43], a[0:3]
    v_mfma_f32_16x16x32_bf16 a[4:7], v[104:107], v[44:47], a[4:7]
    v_mfma_f32_16x16x32_bf16 a[8:11], v[104:107], v[48:51], a[8:11]
    v_mfma_f32_16x16x32_bf16 a[12:15], v[104:107], v[52:55], a[12:15]
    v_mfma_f32_16x16x32_bf16 a[16:19], v[108:111], v[40:43], a[16:19]
    v_mfma_f32_16x16x32_bf16 a[20:23], v[108:111], v[44:47], a[20:23]
    v_mfma_f32_16x16x32_bf16 a[24:27], v[108:111], v[48:51], a[24:27]
    v_mfma_f32_16x16x32_bf16 a[28:31], v[108:111], v[52:55], a[28:31]
    v_mfma_f32_16x16x32_bf16 a[32:35], v[112:115], v[40:43], a[32:35]
    v_mfma_f32_16x16x32_bf16 a[36:39], v[112:115], v[44:47], a[36:39]
    v_mfma_f32_16x16x32_bf16 a[40:43], v[112:115], v[48:51], a[40:43]
    v_mfma_f32_16x16x32_bf16 a[44:47], v[112:115], v[52:55], a[44:47]
    v_mfma_f32_16x16x32_bf16 a[48:51], v[116:119], v[40:43], a[48:51]
    v_mfma_f32_16x16x32_bf16 a[52:55], v[116:119], v[44:47], a[52:55]
    v_mfma_f32_16x16x32_bf16 a[56:59], v[116:119], v[48:51], a[56:59]
    v_mfma_f32_16x16x32_bf16 a[60:63], v[116:119], v[52:55], a[60:63]
    buffer_load_dwordx4 v[104:107], v6, s[48:51], s61 offen
    buffer_load_dwordx4 v[108:111], v7, s[48:51], s61 offen
    buffer_load_dwordx4 v[112:115], v8, s[48:51], s61 offen
    buffer_load_dwordx4 v[116:119], v9, s[48:51], s61 offen
    s_add_u32 s61, s61, 0x400
    s_waitcnt vmcnt(24)
    ds_read_b128 v[40:43], v144 offset:16384
    ds_read_b128 v[44:47], v144 offset:18432
    ds_read_b128 v[48:51], v144 offset:20480
    ds_read_b128 v[52:55], v144 offset:22528
    s_waitcnt lgkmcnt(4)
    s_waitcnt vmcnt(20)
    v_mfma_f32_16x16x32_bf16 a[0:3], v[120:123], v[56:59], a[0:3]
    v_mfma_f32_16x16x32_bf16 a[4:7], v[120:123], v[60:63], a[4:7]
    v_mfma_f32_16x16x32_bf16 a[8:11], v[120:123], v[64:67], a[8:11]
    v_mfma_f32_16x16x32_bf16 a[12:15], v[120:123], v[68:71], a[12:15]
    v_mfma_f32_16x16x32_bf16 a[16:19], v[124:127], v[56:59], a[16:19]
    v_mfma_f32_16x16x32_bf16 a[20:23], v[124:127], v[60:63], a[20:23]
    v_mfma_f32_16x16x32_bf16 a[24:27], v[124:127], v[64:67], a[24:27]
    v_mfma_f32_16x16x32_bf16 a[28:31], v[124:127], v[68:71], a[28:31]
    v_mfma_f32_16x16x32_bf16 a[32:35], v[128:131], v[56:59], a[32:35]
    v_mfma_f32_16x16x32_bf16 a[36:39], v[128:131], v[60:63], a[36:39]
    v_mfma_f32_16x16x32_bf16 a[40:43], v[128:131], v[64:67], a[40:43]
    v_mfma_f32_16x16x32_bf16 a[44:47], v[128:131], v[68:71], a[44:47]
    v_mfma_f32_16x16x32_bf16 a[48:51], v[132:135], v[56:59], a[48:51]
    v_mfma_f32_16x16x32_bf16 a[52:55], v[132:135], v[60:63], a[52:55]
    v_mfma_f32_16x16x32_bf16 a[56:59], v[132:135], v[64:67], a[56:59]
    v_mfma_f32_16x16x32_bf16 a[60:63], v[132:135], v[68:71], a[60:63]
    buffer_load_dwordx4 v[120:123], v6, s[48:51], s61 offen
    buffer_load_dwordx4 v[124:127], v7, s[48:51], s61 offen
    buffer_load_dwordx4 v[128:131], v8, s[48:51], s61 offen
    buffer_load_dwordx4 v[132:135], v9, s[48:51], s61 offen
    s_add_u32 s61, s61, 0x400
    ds_read_b128 v[56:59], v145 offset:16384
    ds_read_b128 v[60:63], v145 offset:18432
    ds_read_b128 v[64:67], v145 offset:20480
    ds_read_b128 v[68:71], v145 offset:22528
    s_waitcnt lgkmcnt(4)
    s_waitcnt vmcnt(20)
    v_mfma_f32_16x16x32_bf16 a[0:3], v[72:75], v[40:43], a[0:3]
    v_mfma_f32_16x16x32_bf16 a[4:7], v[72:75], v[44:47], a[4:7]
    v_mfma_f32_16x16x32_bf16 a[8:11], v[72:75], v[48:51], a[8:11]
    v_mfma_f32_16x16x32_bf16 a[12:15], v[72:75], v[52:55], a[12:15]
    v_mfma_f32_16x16x32_bf16 a[16:19], v[76:79], v[40:43], a[16:19]
    v_mfma_f32_16x16x32_bf16 a[20:23], v[76:79], v[44:47], a[20:23]
    v_mfma_f32_16x16x32_bf16 a[24:27], v[76:79], v[48:51], a[24:27]
    v_mfma_f32_16x16x32_bf16 a[28:31], v[76:79], v[52:55], a[28:31]
    v_mfma_f32_16x16x32_bf16 a[32:35], v[80:83], v[40:43], a[32:35]
    v_mfma_f32_16x16x32_bf16 a[36:39], v[80:83], v[44:47], a[36:39]
    v_mfma_f32_16x16x32_bf16 a[40:43], v[80:83], v[48:51], a[40:43]
    v_mfma_f32_16x16x32_bf16 a[44:47], v[80:83], v[52:55], a[44:47]
    v_mfma_f32_16x16x32_bf16 a[48:51], v[84:87], v[40:43], a[48:51]
    v_mfma_f32_16x16x32_bf16 a[52:55], v[84:87], v[44:47], a[52:55]
    v_mfma_f32_16x16x32_bf16 a[56:59], v[84:87], v[48:51], a[56:59]
    v_mfma_f32_16x16x32_bf16 a[60:63], v[84:87], v[52:55], a[60:63]
    s_waitcnt vmcnt(12)
    ds_read_b128 v[40:43], v144 offset:0
    ds_read_b128 v[44:47], v144 offset:2048
    ds_read_b128 v[48:51], v144 offset:4096
    ds_read_b128 v[52:55], v144 offset:6144
    s_waitcnt lgkmcnt(4)
    s_waitcnt vmcnt(8)
    v_mfma_f32_16x16x32_bf16 a[0:3], v[88:91], v[56:59], a[0:3]
    v_mfma_f32_16x16x32_bf16 a[4:7], v[88:91], v[60:63], a[4:7]
    v_mfma_f32_16x16x32_bf16 a[8:11], v[88:91], v[64:67], a[8:11]
    v_mfma_f32_16x16x32_bf16 a[12:15], v[88:91], v[68:71], a[12:15]
    v_mfma_f32_16x16x32_bf16 a[16:19], v[92:95], v[56:59], a[16:19]
    v_mfma_f32_16x16x32_bf16 a[20:23], v[92:95], v[60:63], a[20:23]
    v_mfma_f32_16x16x32_bf16 a[24:27], v[92:95], v[64:67], a[24:27]
    v_mfma_f32_16x16x32_bf16 a[28:31], v[92:95], v[68:71], a[28:31]
    v_mfma_f32_16x16x32_bf16 a[32:35], v[96:99], v[56:59], a[32:35]
    v_mfma_f32_16x16x32_bf16 a[36:39], v[96:99], v[60:63], a[36:39]
    v_mfma_f32_16x16x32_bf16 a[40:43], v[96:99], v[64:67], a[40:43]
    v_mfma_f32_16x16x32_bf16 a[44:47], v[96:99], v[68:71], a[44:47]
    v_mfma_f32_16x16x32_bf16 a[48:51], v[100:103], v[56:59], a[48:51]
    v_mfma_f32_16x16x32_bf16 a[52:55], v[100:103], v[60:63], a[52:55]
    v_mfma_f32_16x16x32_bf16 a[56:59], v[100:103], v[64:67], a[56:59]
    v_mfma_f32_16x16x32_bf16 a[60:63], v[100:103], v[68:71], a[60:63]
    ds_read_b128 v[56:59], v145 offset:0
    ds_read_b128 v[60:63], v145 offset:2048
    ds_read_b128 v[64:67], v145 offset:4096
    ds_read_b128 v[68:71], v145 offset:6144
    s_waitcnt lgkmcnt(4)
    s_waitcnt vmcnt(4)
    v_mfma_f32_16x16x32_bf16 a[0:3], v[104:107], v[40:43], a[0:3]
    v_mfma_f32_16x16x32_bf16 a[4:7], v[104:107], v[44:47], a[4:7]
    v_mfma_f32_16x16x32_bf16 a[8:11], v[104:107], v[48:51], a[8:11]
    v_mfma_f32_16x16x32_bf16 a[12:15], v[104:107], v[52:55], a[12:15]
    v_mfma_f32_16x16x32_bf16 a[16:19], v[108:111], v[40:43], a[16:19]
    v_mfma_f32_16x16x32_bf16 a[20:23], v[108:111], v[44:47], a[20:23]
    v_mfma_f32_16x16x32_bf16 a[24:27], v[108:111], v[48:51], a[24:27]
    v_mfma_f32_16x16x32_bf16 a[28:31], v[108:111], v[52:55], a[28:31]
    v_mfma_f32_16x16x32_bf16 a[32:35], v[112:115], v[40:43], a[32:35]
    v_mfma_f32_16x16x32_bf16 a[36:39], v[112:115], v[44:47], a[36:39]
    v_mfma_f32_16x16x32_bf16 a[40:43], v[112:115], v[48:51], a[40:43]
    v_mfma_f32_16x16x32_bf16 a[44:47], v[112:115], v[52:55], a[44:47]
    v_mfma_f32_16x16x32_bf16 a[48:51], v[116:119], v[40:43], a[48:51]
    v_mfma_f32_16x16x32_bf16 a[52:55], v[116:119], v[44:47], a[52:55]
    v_mfma_f32_16x16x32_bf16 a[56:59], v[116:119], v[48:51], a[56:59]
    v_mfma_f32_16x16x32_bf16 a[60:63], v[116:119], v[52:55], a[60:63]
    s_waitcnt lgkmcnt(0)
    s_waitcnt vmcnt(0)
    v_mfma_f32_16x16x32_bf16 a[0:3], v[120:123], v[56:59], a[0:3]
    v_mfma_f32_16x16x32_bf16 a[4:7], v[120:123], v[60:63], a[4:7]
    v_mfma_f32_16x16x32_bf16 a[8:11], v[120:123], v[64:67], a[8:11]
    v_mfma_f32_16x16x32_bf16 a[12:15], v[120:123], v[68:71], a[12:15]
    v_mfma_f32_16x16x32_bf16 a[16:19], v[124:127], v[56:59], a[16:19]
    v_mfma_f32_16x16x32_bf16 a[20:23], v[124:127], v[60:63], a[20:23]
    v_mfma_f32_16x16x32_bf16 a[24:27], v[124:127], v[64:67], a[24:27]
    v_mfma_f32_16x16x32_bf16 a[28:31], v[124:127], v[68:71], a[28:31]
    v_mfma_f32_16x16x32_bf16 a[32:35], v[128:131], v[56:59], a[32:35]
    v_mfma_f32_16x16x32_bf16 a[36:39], v[128:131], v[60:63], a[36:39]
    v_mfma_f32_16x16x32_bf16 a[40:43], v[128:131], v[64:67], a[40:43]
    v_mfma_f32_16x16x32_bf16 a[44:47], v[128:131], v[68:71], a[44:47]
    v_mfma_f32_16x16x32_bf16 a[48:51], v[132:135], v[56:59], a[48:51]
    v_mfma_f32_16x16x32_bf16 a[52:55], v[132:135], v[60:63], a[52:55]
    v_mfma_f32_16x16x32_bf16 a[56:59], v[132:135], v[64:67], a[56:59]
    v_mfma_f32_16x16x32_bf16 a[60:63], v[132:135], v[68:71], a[60:63]
    s_barrier
    v_lshlrev_b32 v13, 4, v1
    s_lshl_b32 s6, s3, 12
    v_add_u32 v14, s6, v13
    s_lshl_b32 s7, s3, 14
    v_add_u32 v15, s7, v13
    s_nop 7
    s_nop 3
    ds_write_b128 v14, a[0:3] offset:0
    ds_write_b128 v14, a[16:19] offset:1024
    ds_write_b128 v14, a[32:35] offset:2048
    ds_write_b128 v14, a[48:51] offset:3072
    ds_write_b128 v14, a[4:7] offset:16384
    ds_write_b128 v14, a[20:23] offset:17408
    ds_write_b128 v14, a[36:39] offset:18432
    ds_write_b128 v14, a[52:55] offset:19456
    ds_write_b128 v14, a[8:11] offset:32768
    ds_write_b128 v14, a[24:27] offset:33792
    ds_write_b128 v14, a[40:43] offset:34816
    ds_write_b128 v14, a[56:59] offset:35840
    ds_write_b128 v14, a[12:15] offset:49152
    ds_write_b128 v14, a[28:31] offset:50176
    ds_write_b128 v14, a[44:47] offset:51200
    ds_write_b128 v14, a[60:63] offset:52224
    s_waitcnt lgkmcnt(0)
    s_barrier
    ds_read_b128 v[40:43], v15 offset:0
    ds_read_b128 v[44:47], v15 offset:1024
    ds_read_b128 v[48:51], v15 offset:2048
    ds_read_b128 v[52:55], v15 offset:3072
    ds_read_b128 v[56:59], v15 offset:4096
    ds_read_b128 v[60:63], v15 offset:5120
    ds_read_b128 v[64:67], v15 offset:6144
    ds_read_b128 v[68:71], v15 offset:7168
    ds_read_b128 v[72:75], v15 offset:8192
    ds_read_b128 v[76:79], v15 offset:9216
    ds_read_b128 v[80:83], v15 offset:10240
    ds_read_b128 v[84:87], v15 offset:11264
    ds_read_b128 v[88:91], v15 offset:12288
    ds_read_b128 v[92:95], v15 offset:13312
    ds_read_b128 v[96:99], v15 offset:14336
    ds_read_b128 v[100:103], v15 offset:15360
    s_waitcnt lgkmcnt(3)
    v_add_f32 v40, v40, v56
    v_add_f32 v72, v72, v88
    v_add_f32 v41, v41, v57
    v_add_f32 v73, v73, v89
    v_add_f32 v42, v42, v58
    v_add_f32 v74, v74, v90
    v_add_f32 v43, v43, v59
    v_add_f32 v75, v75, v91
    v_cvt_pk_bf16_f32 v104, v40, v41
    v_cvt_pk_bf16_f32 v105, v42, v43
    v_cvt_pk_bf16_f32 v106, v72, v73
    v_cvt_pk_bf16_f32 v107, v74, v75
    v_lshlrev_b32 v40, 16, v104
    v_and_b32 v41, 0xffff0000, v104
    v_lshlrev_b32 v42, 16, v105
    v_and_b32 v43, 0xffff0000, v105
    v_lshlrev_b32 v72, 16, v106
    v_and_b32 v73, 0xffff0000, v106
    v_lshlrev_b32 v74, 16, v107
    v_and_b32 v75, 0xffff0000, v107
    v_sub_f32 v40, v40, v72
    v_sub_f32 v41, v41, v73
    v_sub_f32 v42, v42, v74
    v_sub_f32 v43, v43, v75
    v_cvt_pk_bf16_f32 v104, v40, v41
    v_cvt_pk_bf16_f32 v105, v42, v43
    v_lshlrev_b32 v40, 16, v104
    v_and_b32 v41, 0xffff0000, v104
    v_lshlrev_b32 v42, 16, v105
    v_and_b32 v43, 0xffff0000, v105
    v_lshlrev_b32 v72, 16, v24
    v_and_b32 v73, 0xffff0000, v24
    v_lshlrev_b32 v74, 16, v25
    v_and_b32 v75, 0xffff0000, v25
    v_add_f32 v40, v40, v72
    v_add_f32 v41, v41, v73
    v_add_f32 v42, v42, v74
    v_add_f32 v43, v43, v75
    v_cvt_pk_bf16_f32 v108, v40, v41
    v_cvt_pk_bf16_f32 v109, v42, v43
    buffer_store_dwordx2 v[108:109], v16, s[68:71], s62 offen offset:0
    s_waitcnt lgkmcnt(2)
    v_add_f32 v44, v44, v60
    v_add_f32 v76, v76, v92
    v_add_f32 v45, v45, v61
    v_add_f32 v77, v77, v93
    v_add_f32 v46, v46, v62
    v_add_f32 v78, v78, v94
    v_add_f32 v47, v47, v63
    v_add_f32 v79, v79, v95
    v_cvt_pk_bf16_f32 v104, v44, v45
    v_cvt_pk_bf16_f32 v105, v46, v47
    v_cvt_pk_bf16_f32 v106, v76, v77
    v_cvt_pk_bf16_f32 v107, v78, v79
    v_lshlrev_b32 v44, 16, v104
    v_and_b32 v45, 0xffff0000, v104
    v_lshlrev_b32 v46, 16, v105
    v_and_b32 v47, 0xffff0000, v105
    v_lshlrev_b32 v76, 16, v106
    v_and_b32 v77, 0xffff0000, v106
    v_lshlrev_b32 v78, 16, v107
    v_and_b32 v79, 0xffff0000, v107
    v_sub_f32 v44, v44, v76
    v_sub_f32 v45, v45, v77
    v_sub_f32 v46, v46, v78
    v_sub_f32 v47, v47, v79
    v_cvt_pk_bf16_f32 v104, v44, v45
    v_cvt_pk_bf16_f32 v105, v46, v47
    v_lshlrev_b32 v44, 16, v104
    v_and_b32 v45, 0xffff0000, v104
    v_lshlrev_b32 v46, 16, v105
    v_and_b32 v47, 0xffff0000, v105
    v_lshlrev_b32 v76, 16, v26
    v_and_b32 v77, 0xffff0000, v26
    v_lshlrev_b32 v78, 16, v27
    v_and_b32 v79, 0xffff0000, v27
    v_add_f32 v44, v44, v76
    v_add_f32 v45, v45, v77
    v_add_f32 v46, v46, v78
    v_add_f32 v47, v47, v79
    v_cvt_pk_bf16_f32 v110, v44, v45
    v_cvt_pk_bf16_f32 v111, v46, v47
    buffer_store_dwordx2 v[110:111], v16, s[68:71], s62 offen offset:32
    s_waitcnt lgkmcnt(1)
    v_add_f32 v48, v48, v64
    v_add_f32 v80, v80, v96
    v_add_f32 v49, v49, v65
    v_add_f32 v81, v81, v97
    v_add_f32 v50, v50, v66
    v_add_f32 v82, v82, v98
    v_add_f32 v51, v51, v67
    v_add_f32 v83, v83, v99
    v_cvt_pk_bf16_f32 v104, v48, v49
    v_cvt_pk_bf16_f32 v105, v50, v51
    v_cvt_pk_bf16_f32 v106, v80, v81
    v_cvt_pk_bf16_f32 v107, v82, v83
    v_lshlrev_b32 v48, 16, v104
    v_and_b32 v49, 0xffff0000, v104
    v_lshlrev_b32 v50, 16, v105
    v_and_b32 v51, 0xffff0000, v105
    v_lshlrev_b32 v80, 16, v106
    v_and_b32 v81, 0xffff0000, v106
    v_lshlrev_b32 v82, 16, v107
    v_and_b32 v83, 0xffff0000, v107
    v_sub_f32 v48, v48, v80
    v_sub_f32 v49, v49, v81
    v_sub_f32 v50, v50, v82
    v_sub_f32 v51, v51, v83
    v_cvt_pk_bf16_f32 v104, v48, v49
    v_cvt_pk_bf16_f32 v105, v50, v51
    v_lshlrev_b32 v48, 16, v104
    v_and_b32 v49, 0xffff0000, v104
    v_lshlrev_b32 v50, 16, v105
    v_and_b32 v51, 0xffff0000, v105
    v_lshlrev_b32 v80, 16, v28
    v_and_b32 v81, 0xffff0000, v28
    v_lshlrev_b32 v82, 16, v29
    v_and_b32 v83, 0xffff0000, v29
    v_add_f32 v48, v48, v80
    v_add_f32 v49, v49, v81
    v_add_f32 v50, v50, v82
    v_add_f32 v51, v51, v83
    v_cvt_pk_bf16_f32 v108, v48, v49
    v_cvt_pk_bf16_f32 v109, v50, v51
    buffer_store_dwordx2 v[108:109], v16, s[68:71], s62 offen offset:64
    s_waitcnt lgkmcnt(0)
    v_add_f32 v52, v52, v68
    v_add_f32 v84, v84, v100
    v_add_f32 v53, v53, v69
    v_add_f32 v85, v85, v101
    v_add_f32 v54, v54, v70
    v_add_f32 v86, v86, v102
    v_add_f32 v55, v55, v71
    v_add_f32 v87, v87, v103
    v_cvt_pk_bf16_f32 v104, v52, v53
    v_cvt_pk_bf16_f32 v105, v54, v55
    v_cvt_pk_bf16_f32 v106, v84, v85
    v_cvt_pk_bf16_f32 v107, v86, v87
    v_lshlrev_b32 v52, 16, v104
    v_and_b32 v53, 0xffff0000, v104
    v_lshlrev_b32 v54, 16, v105
    v_and_b32 v55, 0xffff0000, v105
    v_lshlrev_b32 v84, 16, v106
    v_and_b32 v85, 0xffff0000, v106
    v_lshlrev_b32 v86, 16, v107
    v_and_b32 v87, 0xffff0000, v107
    v_sub_f32 v52, v52, v84
    v_sub_f32 v53, v53, v85
    v_sub_f32 v54, v54, v86
    v_sub_f32 v55, v55, v87
    v_cvt_pk_bf16_f32 v104, v52, v53
    v_cvt_pk_bf16_f32 v105, v54, v55
    v_lshlrev_b32 v52, 16, v104
    v_and_b32 v53, 0xffff0000, v104
    v_lshlrev_b32 v54, 16, v105
    v_and_b32 v55, 0xffff0000, v105
    v_lshlrev_b32 v84, 16, v30
    v_and_b32 v85, 0xffff0000, v30
    v_lshlrev_b32 v86, 16, v31
    v_and_b32 v87, 0xffff0000, v31
    v_add_f32 v52, v52, v84
    v_add_f32 v53, v53, v85
    v_add_f32 v54, v54, v86
    v_add_f32 v55, v55, v87
    v_cvt_pk_bf16_f32 v110, v52, v53
    v_cvt_pk_bf16_f32 v111, v54, v55
    buffer_store_dwordx2 v[110:111], v16, s[68:71], s62 offen offset:96
.end_k2a2_kernel_1:
    s_endpgm
.section .rodata,"a"
.p2align 6
.amdhsa_kernel k2a2_kernel
  .amdhsa_next_free_vgpr 264
  .amdhsa_next_free_sgpr 100
  .amdhsa_accum_offset 200
  .amdhsa_group_segment_fixed_size 0
  .amdhsa_kernarg_size 104
  .amdhsa_user_sgpr_count 2
  .amdhsa_user_sgpr_kernarg_segment_ptr 1
  .amdhsa_system_sgpr_workgroup_id_x 1
  .amdhsa_float_denorm_mode_32 3
.end_amdhsa_kernel
.text

.globl k3b1_kernel
.p2align 8
.type k3b1_kernel,@function
k3b1_kernel:
    s_load_dwordx16 s[16:31], s[0:1], 0
    s_load_dwordx8 s[32:39], s[0:1], 64
    s_load_dwordx2 s[40:41], s[0:1], 96
    s_cmp_ge_u32 s2, 224
    s_cbranch_scc1 .end_k3b1_kernel_1
    v_lshrrev_b32 v2, 6, v0
    v_and_b32 v1, 63, v0
    v_readfirstlane_b32 s3, v2
    s_mul_i32 s4, s2, 0x4925
    s_lshr_b32 s4, s4, 17
    s_mul_i32 s6, s4, 7
    s_sub_u32 s5, s2, s6
    v_lshrrev_b32 v2, 3, v1
    v_and_b32 v3, 7, v1
    v_lshlrev_b32 v4, 10, v2
    v_lshl_add_u32 v4, v3, 4, v4
    s_lshl_b32 s6, s3, 13
    v_add_u32 v22, s6, v4
    s_lshl_b32 s60, s4, 16
    s_waitcnt lgkmcnt(0)
    s_add_u32 s44, s40, 0xb00000
    s_addc_u32 s45, s41, 0
    s_mov_b32 s46, 0x200000
    s_mov_b32 s47, 0x00020000
    buffer_load_dwordx4 v[88:91], v22, s[44:47], s60 offen offset:0
    buffer_load_dwordx4 v[92:95], v22, s[44:47], s60 offen offset:128
    buffer_load_dwordx4 v[96:99], v22, s[44:47], s60 offen offset:256
    buffer_load_dwordx4 v[100:103], v22, s[44:47], s60 offen offset:384
    buffer_load_dwordx4 v[104:107], v22, s[44:47], s60 offen offset:512
    buffer_load_dwordx4 v[108:111], v22, s[44:47], s60 offen offset:640
    buffer_load_dwordx4 v[112:115], v22, s[44:47], s60 offen offset:768
    buffer_load_dwordx4 v[116:119], v22, s[44:47], s60 offen offset:896
    s_cmp_ge_u32 s3, 4
    s_cbranch_scc1 .skipb_k3b1_kernel_2
    v_and_b32 v5, 15, v1
    v_lshrrev_b32 v6, 4, v1
    s_add_u32 s48, s40, 0x1100000
    s_addc_u32 s49, s41, 0
    s_mov_b32 s50, 0x1c0000
    s_mov_b32 s51, 0x00020000
    s_add_u32 s52, s40, 0x400000
    s_addc_u32 s53, s41, 0
    s_mov_b32 s54, 0x700000
    s_mov_b32 s55, 0x00020000
    s_mov_b32 s56, s30
    s_mov_b32 s57, s31
    s_mov_b32 s58, 0xe00
    s_mov_b32 s59, 0x00020000
    s_lshl_b32 s6, s5, 8
    s_lshl_b32 s7, s3, 6
    s_add_u32 s6, s6, s7
    s_lshl_b32 s61, s6, 10
    s_lshl_b32 s63, s6, 1
    v_lshlrev_b32 v7, 4, v1
    v_add_u32 v10, 0x0, v7
    v_add_u32 v11, 0x4000, v7
    v_add_u32 v12, 0x8000, v7
    v_add_u32 v13, 0xc000, v7
    v_add_u32 v7, 0, v6
    v_xor_b32 v7, v7, v5
    v_lshlrev_b32 v7, 4, v7
    v_lshl_add_u32 v16, v5, 10, v7
    v_add_u32 v7, 4, v6
    v_xor_b32 v7, v7, v5
    v_lshlrev_b32 v7, 4, v7
    v_lshl_add_u32 v17, v5, 10, v7
    v_add_u32 v7, 8, v6
    v_xor_b32 v7, v7, v5
    v_lshlrev_b32 v7, 4, v7
    v_lshl_add_u32 v18, v5, 10, v7
    v_add_u32 v7, 12, v6
    v_xor_b32 v7, v7, v5
    v_lshlrev_b32 v7, 4, v7
    v_lshl_add_u32 v19, v5, 10, v7
.skipb_k3b1_kernel_2:
    v_xor_b32 v7, v3, v2
    v_lshlrev_b32 v7, 4, v7
    v_lshl_add_u32 v7, v2, 10, v7
    s_and_b32 s7, s3, 1
    s_lshl_b32 s7, s7, 7
    s_lshl_b32 s6, s3, 13
    s_add_u32 s8, s6, s7
    s_sub_u32 s9, s6, s7
    v_add_u32 v20, s8, v7
    v_add_u32 v21, s9, v7
    s_mov_b32 s8, 0x3f803f80
    v_mov_b32 v24, 0
    v_mov_b32 v25, 0
    v_mov_b32 v26, 0
    v_mov_b32 v27, 0
    s_waitcnt vmcnt(7)
    v_dot2c_f32_bf16 v24, s8, v88
    v_dot2c_f32_bf16 v25, s8, v89
    v_dot2c_f32_bf16 v26, s8, v90
    v_dot2c_f32_bf16 v27, s8, v91
    s_waitcnt vmcnt(6)
    v_dot2c_f32_bf16 v24, s8, v92
    v_dot2c_f32_bf16 v25, s8, v93
    v_dot2c_f32_bf16 v26, s8, v94
    v_dot2c_f32_bf16 v27, s8, v95
    s_waitcnt vmcnt(5)
    v_dot2c_f32_bf16 v24, s8, v96
    v_dot2c_f32_bf16 v25, s8, v97
    v_dot2c_f32_bf16 v26, s8, v98
    v_dot2c_f32_bf16 v27, s8, v99
    s_waitcnt vmcnt(4)
    v_dot2c_f32_bf16 v24, s8, v100
    v_dot2c_f32_bf16 v25, s8, v101
    v_dot2c_f32_bf16 v26, s8, v102
    v_dot2c_f32_bf16 v27, s8, v103
    s_waitcnt vmcnt(3)
    v_dot2c_f32_bf16 v24, s8, v104
    v_dot2c_f32_bf16 v25, s8, v105
    v_dot2c_f32_bf16 v26, s8, v106
    v_dot2c_f32_bf16 v27, s8, v107
    s_waitcnt vmcnt(2)
    v_dot2c_f32_bf16 v24, s8, v108
    v_dot2c_f32_bf16 v25, s8, v109
    v_dot2c_f32_bf16 v26, s8, v110
    v_dot2c_f32_bf16 v27, s8, v111
    s_waitcnt vmcnt(1)
    v_dot2c_f32_bf16 v24, s8, v112
    v_dot2c_f32_bf16 v25, s8, v113
    v_dot2c_f32_bf16 v26, s8, v114
    v_dot2c_f32_bf16 v27, s8, v115
    s_waitcnt vmcnt(0)
    v_dot2c_f32_bf16 v24, s8, v116
    v_dot2c_f32_bf16 v25, s8, v117
    v_dot2c_f32_bf16 v26, s8, v118
    v_dot2c_f32_bf16 v27, s8, v119
    s_nop 2
    s_cmp_ge_u32 s3, 4
    s_cbranch_scc1 .skip2_k3b1_kernel_3
    buffer_load_dwordx4 v[40:43], v10, s[48:51], s61 offen
    buffer_load_dwordx4 v[44:47], v11, s[48:51], s61 offen
    buffer_load_dwordx4 v[48:51], v12, s[48:51], s61 offen
    buffer_load_dwordx4 v[52:55], v13, s[48:51], s61 offen
    s_add_u32 s61, s61, 0x400
    buffer_load_dwordx4 v[56:59], v10, s[48:51], s61 offen
    buffer_load_dwordx4 v[60:63], v11, s[48:51], s61 offen
    buffer_load_dwordx4 v[64:67], v12, s[48:51], s61 offen
    buffer_load_dwordx4 v[68:71], v13, s[48:51], s61 offen
    s_add_u32 s61, s61, 0x400
    buffer_load_dwordx4 v[72:75], v10, s[48:51], s61 offen
    buffer_load_dwordx4 v[76:79], v11, s[48:51], s61 offen
    buffer_load_dwordx4 v[80:83], v12, s[48:51], s61 offen
    buffer_load_dwordx4 v[84:87], v13, s[48:51], s61 offen
    s_add_u32 s61, s61, 0x400
.skip2_k3b1_kernel_3:
    v_add_f32 v24, v24, v25
    v_add_f32 v26, v26, v27
    v_add_f32 v24, v24, v26
    s_nop 1
    v_add_f32_dpp v25, v24, v24 quad_perm:[1,0,3,2] row_mask:0xf bank_mask:0xf
    s_nop 1
    v_add_f32_dpp v24, v25, v25 quad_perm:[2,3,0,1] row_mask:0xf bank_mask:0xf
    s_nop 1
    v_add_f32_dpp v25, v24, v24 row_half_mirror row_mask:0xf bank_mask:0xf
    v_mov_b32 v24, v25
    v_mul_f32 v28, 0x3b000000, v24
    v_sub_f32 v30, 0, v28
    v_sub_f32 v31, 0, v28
    v_mov_b32 v32, 0
    v_mov_b32 v33, 0
    v_mov_b32 v34, 0
    v_mov_b32 v35, 0
    v_lshlrev_b32 v120, 16, v88
    v_and_b32 v121, 0xffff0000, v88
    v_pk_add_f32 v[120:121], v[120:121], v[30:31]
    v_pk_fma_f32 v[32:33], v[120:121], v[120:121], v[32:33]
    v_lshlrev_b32 v122, 16, v89
    v_and_b32 v123, 0xffff0000, v89
    v_pk_add_f32 v[122:123], v[122:123], v[30:31]
    v_pk_fma_f32 v[34:35], v[122:123], v[122:123], v[34:35]
    v_lshlrev_b32 v124, 16, v90
    v_and_b32 v125, 0xffff0000, v90
    v_pk_add_f32 v[124:125], v[124:125], v[30:31]
    v_pk_fma_f32 v[32:33], v[124:125], v[124:125], v[32:33]
    v_lshlrev_b32 v126, 16, v91
    v_and_b32 v127, 0xffff0000, v91
    v_pk_add_f32 v[126:127], v[126:127], v[30:31]
    v_pk_fma_f32 v[34:35], v[126:127], v[126:127], v[34:35]
    v_lshlrev_b32 v128, 16, v92
    v_and_b32 v129, 0xffff0000, v92
    v_pk_add_f32 v[128:129], v[128:129], v[30:31]
    v_pk_fma_f32 v[32:33], v[128:129], v[128:129], v[32:33]
    v_lshlrev_b32 v130, 16, v93
    v_and_b32 v131, 0xffff0000, v93
    v_pk_add_f32 v[130:131], v[130:131], v[30:31]
    v_pk_fma_f32 v[34:35], v[130:131], v[130:131], v[34:35]
    v_lshlrev_b32 v132, 16, v94
    v_and_b32 v133, 0xffff0000, v94
    v_pk_add_f32 v[132:133], v[132:133], v[30:31]
    v_pk_fma_f32 v[32:33], v[132:133], v[132:133], v[32:33]
    v_lshlrev_b32 v134, 16, v95
    v_and_b32 v135, 0xffff0000, v95
    v_pk_add_f32 v[134:135], v[134:135], v[30:31]
    v_pk_fma_f32 v[34:35], v[134:135], v[134:135], v[34:35]
    v_lshlrev_b32 v136, 16, v96
    v_and_b32 v137, 0xffff0000, v96
    v_pk_add_f32 v[136:137], v[136:137], v[30:31]
    v_pk_fma_f32 v[32:33], v[136:137], v[136:137], v[32:33]
    v_lshlrev_b32 v138, 16, v97
    v_and_b32 v139, 0xffff0000, v97
    v_pk_add_f32 v[138:139], v[138:139], v[30:31]
    v_pk_fma_f32 v[34:35], v[138:139], v[138:139], v[34:35]
    v_lshlrev_b32 v140, 16, v98
    v_and_b32 v141, 0xffff0000, v98
    v_pk_add_f32 v[140:141], v[140:141], v[30:31]
    v_pk_fma_f32 v[32:33], v[140:141], v[140:141], v[32:33]
    v_lshlrev_b32 v142, 16, v99
    v_and_b32 v143, 0xffff0000, v99
    v_pk_add_f32 v[142:143], v[142:143], v[30:31]
    v_pk_fma_f32 v[34:35], v[142:143], v[142:143], v[34:35]
    v_lshlrev_b32 v144, 16, v100
    v_and_b32 v145, 0xffff0000, v100
    v_pk_add_f32 v[144:145], v[144:145], v[30:31]
    v_pk_fma_f32 v[32:33], v[144:145], v[144:145], v[32:33]
    v_lshlrev_b32 v146, 16, v101
    v_and_b32 v147, 0xffff0000, v101
    v_pk_add_f32 v[146:147], v[146:147], v[30:31]
    v_pk_fma_f32 v[34:35], v[146:147], v[146:147], v[34:35]
    v_lshlrev_b32 v148, 16, v102
    v_and_b32 v149, 0xffff0000, v102
    v_pk_add_f32 v[148:149], v[148:149], v[30:31]
    v_pk_fma_f32 v[32:33], v[148:149], v[148:149], v[32:33]
    v_lshlrev_b32 v150, 16, v103
    v_and_b32 v151, 0xffff0000, v103
    v_pk_add_f32 v[150:151], v[150:151], v[30:31]
    v_pk_fma_f32 v[34:35], v[150:151], v[150:151], v[34:35]
    v_lshlrev_b32 v152, 16, v104
    v_and_b32 v153, 0xffff0000, v104
    v_pk_add_f32 v[152:153], v[152:153], v[30:31]
    v_pk_fma_f32 v[32:33], v[152:153], v[152:153], v[32:33]
    v_lshlrev_b32 v154, 16, v105
    v_and_b32 v155, 0xffff0000, v105
    v_pk_add_f32 v[154:155], v[154:155], v[30:31]
    v_pk_fma_f32 v[34:35], v[154:155], v[154:155], v[34:35]
    v_lshlrev_b32 v156, 16, v106
    v_and_b32 v157, 0xffff0000, v106
    v_pk_add_f32 v[156:157], v[156:157], v[30:31]
    v_pk_fma_f32 v[32:33], v[156:157], v[156:157], v[32:33]
    v_lshlrev_b32 v158, 16, v107
    v_and_b32 v159, 0xffff0000, v107
    v_pk_add_f32 v[158:159], v[158:159], v[30:31]
    v_pk_fma_f32 v[34:35], v[158:159], v[158:159], v[34:35]
    v_lshlrev_b32 v160, 16, v108
    v_and_b32 v161, 0xffff0000, v108
    v_pk_add_f32 v[160:161], v[160:161], v[30:31]
    v_pk_fma_f32 v[32:33], v[160:161], v[160:161], v[32:33]
    v_lshlrev_b32 v162, 16, v109
    v_and_b32 v163, 0xffff0000, v109
    v_pk_add_f32 v[162:163], v[162:163], v[30:31]
    v_pk_fma_f32 v[34:35], v[162:163], v[162:163], v[34:35]
    v_lshlrev_b32 v164, 16, v110
    v_and_b32 v165, 0xffff0000, v110
    v_pk_add_f32 v[164:165], v[164:165], v[30:31]
    v_pk_fma_f32 v[32:33], v[164:165], v[164:165], v[32:33]
    v_lshlrev_b32 v166, 16, v111
    v_and_b32 v167, 0xffff0000, v111
    v_pk_add_f32 v[166:167], v[166:167], v[30:31]
    v_pk_fma_f32 v[34:35], v[166:167], v[166:167], v[34:35]
    v_lshlrev_b32 v168, 16, v112
    v_and_b32 v169, 0xffff0000, v112
    v_pk_add_f32 v[168:169], v[168:169], v[30:31]
    v_pk_fma_f32 v[32:33], v[168:169], v[168:169], v[32:33]
    v_lshlrev_b32 v170, 16, v113
    v_and_b32 v171, 0xffff0000, v113
    v_pk_add_f32 v[170:171], v[170:171], v[30:31]
    v_pk_fma_f32 v[34:35], v[170:171], v[170:171], v[34:35]
    v_lshlrev_b32 v172, 16, v114
    v_and_b32 v173, 0xffff0000, v114
    v_pk_add_f32 v[172:173], v[172:173], v[30:31]
    v_pk_fma_f32 v[32:33], v[172:173], v[172:173], v[32:33]
    v_lshlrev_b32 v174, 16, v115
    v_and_b32 v175, 0xffff0000, v115
    v_pk_add_f32 v[174:175], v[174:175], v[30:31]
    v_pk_fma_f32 v[34:35], v[174:175], v[174:175], v[34:35]
    v_lshlrev_b32 v176, 16, v116
    v_and_b32 v177, 0xffff0000, v116
    v_pk_add_f32 v[176:177], v[176:177], v[30:31]
    v_pk_fma_f32 v[32:33], v[176:177], v[176:177], v[32:33]
    v_lshlrev_b32 v178, 16, v117
    v_and_b32 v179, 0xffff0000, v117
    v_pk_add_f32 v[178:179], v[178:179], v[30:31]
    v_pk_fma_f32 v[34:35], v[178:179], v[178:179], v[34:35]
    v_lshlrev_b32 v180, 16, v118
    v_and_b32 v181, 0xffff0000, v118
    v_pk_add_f32 v[180:181], v[180:181], v[30:31]
    v_pk_fma_f32 v[32:33], v[180:181], v[180:181], v[32:33]
    v_lshlrev_b32 v182, 16, v119
    v_and_b32 v183, 0xffff0000, v119
    v_pk_add_f32 v[182:183], v[182:183], v[30:31]
    v_pk_fma_f32 v[34:35], v[182:183], v[182:183], v[34:35]
    v_add_f32 v32, v32, v33
    v_add_f32 v34, v34, v35
    v_add_f32 v32, v32, v34
    s_nop 1
    v_add_f32_dpp v33, v32, v32 quad_perm:[1,0,3,2] row_mask:0xf bank_mask:0xf
    s_nop 1
    v_add_f32_dpp v32, v33, v33 quad_perm:[2,3,0,1] row_mask:0xf bank_mask:0xf
    s_nop 1
    v_add_f32_dpp v33, v32, v32 row_half_mirror row_mask:0xf bank_mask:0xf
    v_mov_b32 v32, v33
    v_mul_f32 v32, 0x3b000000, v32
    v_cvt_pk_bf16_f32 v33, v32, v28
    v_lshlrev_b32 v34, 16, v33
    v_and_b32 v35, 0xffff0000, v33
    v_add_f32 v34, 0x3727c5ac, v34
    v_cvt_pk_bf16_f32 v33, v34, v34
    v_lshlrev_b32 v34, 16, v33
    v_sqrt_f32 v34, v34
    s_nop 0
    v_cvt_pk_bf16_f32 v33, v34, v34
    v_lshlrev_b32 v34, 16, v33
    v_rcp_f32 v30, v34
    s_nop 0
    v_mov_b32 v31, v30
    v_sub_f32 v36, v28, v35
    v_mul_f32 v36, v36, v30
    v_mov_b32 v37, v36
    v_pk_fma_f32 v[120:121], v[120:121], v[30:31], v[36:37]
    v_cvt_pk_bf16_f32 v88, v120, v121
    v_pk_fma_f32 v[122:123], v[122:123], v[30:31], v[36:37]
    v_cvt_pk_bf16_f32 v89, v122, v123
    v_pk_fma_f32 v[124:125], v[124:125], v[30:31], v[36:37]
    v_cvt_pk_bf16_f32 v90, v124, v125
    v_pk_fma_f32 v[126:127], v[126:127], v[30:31], v[36:37]
    v_cvt_pk_bf16_f32 v91, v126, v127
    s_nop 0
    ds_write_b128 v20, v[88:91] offset:0
    v_pk_fma_f32 v[128:129], v[128:129], v[30:31], v[36:37]
    v_cvt_pk_bf16_f32 v92, v128, v129
    v_pk_fma_f32 v[130:131], v[130:131], v[30:31], v[36:37]
    v_cvt_pk_bf16_f32 v93, v130, v131
    v_pk_fma_f32 v[132:133], v[132:133], v[30:31], v[36:37]
    v_cvt_pk_bf16_f32 v94, v132, v133
    v_pk_fma_f32 v[134:135], v[134:135], v[30:31], v[36:37]
    v_cvt_pk_bf16_f32 v95, v134, v135
    s_nop 0
    ds_write_b128 v21, v[92:95] offset:128
    v_pk_fma_f32 v[136:137], v[136:137], v[30:31], v[36:37]
    v_cvt_pk_bf16_f32 v96, v136, v137
    v_pk_fma_f32 v[138:139], v[138:139], v[30:31], v[36:37]
    v_cvt_pk_bf16_f32 v97, v138, v139
    v_pk_fma_f32 v[140:141], v[140:141], v[30:31], v[36:37]
    v_cvt_pk_bf16_f32 v98, v140, v141
    v_pk_fma_f32 v[142:143], v[142:143], v[30:31], v[36:37]
    v_cvt_pk_bf16_f32 v99, v142, v143
    s_nop 0
    ds_write_b128 v20, v[96:99] offset:256
    v_pk_fma_f32 v[144:145], v[144:145], v[30:31], v[36:37]
    v_cvt_pk_bf16_f32 v100, v144, v145
    v_pk_fma_f32 v[146:147], v[146:147], v[30:31], v[36:37]
    v_cvt_pk_bf16_f32 v101, v146, v147
    v_pk_fma_f32 v[148:149], v[148:149], v[30:31], v[36:37]
    v_cvt_pk_bf16_f32 v102, v148, v149
    v_pk_fma_f32 v[150:151], v[150:151], v[30:31], v[36:37]
    v_cvt_pk_bf16_f32 v103, v150, v151
    s_nop 0
    ds_write_b128 v21, v[100:103] offset:384
    v_pk_fma_f32 v[152:153], v[152:153], v[30:31], v[36:37]
    v_cvt_pk_bf16_f32 v104, v152, v153
    v_pk_fma_f32 v[154:155], v[154:155], v[30:31], v[36:37]
    v_cvt_pk_bf16_f32 v105, v154, v155
    v_pk_fma_f32 v[156:157], v[156:157], v[30:31], v[36:37]
    v_cvt_pk_bf16_f32 v106, v156, v157
    v_pk_fma_f32 v[158:159], v[158:159], v[30:31], v[36:37]
    v_cvt_pk_bf16_f32 v107, v158, v159
    s_nop 0
    ds_write_b128 v20, v[104:107] offset:512
    v_pk_fma_f32 v[160:161], v[160:161], v[30:31], v[36:37]
    v_cvt_pk_bf16_f32 v108, v160, v161
    v_pk_fma_f32 v[162:163], v[162:163], v[30:31], v[36:37]
    v_cvt_pk_bf16_f32 v109, v162, v163
    v_pk_fma_f32 v[164:165], v[164:165], v[30:31], v[36:37]
    v_cvt_pk_bf16_f32 v110, v164, v165
    v_pk_fma_f32 v[166:167], v[166:167], v[30:31], v[36:37]
    v_cvt_pk_bf16_f32 v111, v166, v167
    s_nop 0
    ds_write_b128 v21, v[108:111] offset:640
    v_pk_fma_f32 v[168:169], v[168:169], v[30:31], v[36:37]
    v_cvt_pk_bf16_f32 v112, v168, v169
    v_pk_fma_f32 v[170:171], v[170:171], v[30:31], v[36:37]
    v_cvt_pk_bf16_f32 v113, v170, v171
    v_pk_fma_f32 v[172:173], v[172:173], v[30:31], v[36:37]
    v_cvt_pk_bf16_f32 v114, v172, v173
    v_pk_fma_f32 v[174:175], v[174:175], v[30:31], v[36:37]
    v_cvt_pk_bf16_f32 v115, v174, v175
    s_nop 0
    ds_write_b128 v20, v[112:115] offset:768
    v_pk_fma_f32 v[176:177], v[176:177], v[30:31], v[36:37]
    v_cvt_pk_bf16_f32 v116, v176, v177
    v_pk_fma_f32 v[178:179], v[178:179], v[30:31], v[36:37]
    v_cvt_pk_bf16_f32 v117, v178, v179
    v_pk_fma_f32 v[180:181], v[180:181], v[30:31], v[36:37]
    v_cvt_pk_bf16_f32 v118, v180, v181
    v_pk_fma_f32 v[182:183], v[182:183], v[30:31], v[36:37]
    v_cvt_pk_bf16_f32 v119, v182, v183
    s_nop 0
    ds_write_b128 v21, v[116:119] offset:896
    s_waitcnt lgkmcnt(0)
    s_barrier
    s_cmp_ge_u32 s3, 4
    s_cbranch_scc1 .end_k3b1_kernel_1
    ds_read_b128 v[88:91], v16 offset:0
    ds_read_b128 v[92:95], v16 offset:16384
    ds_read_b128 v[96:99], v16 offset:32768
    ds_read_b128 v[100:103], v16 offset:49152
    ds_read_b128 v[104:107], v17 offset:0
    ds_read_b128 v[108:111], v17 offset:16384
    ds_read_b128 v[112:115], v17 offset:32768
    ds_read_b128 v[116:119], v17 offset:49152
    s_waitcnt lgkmcnt(4)
    s_waitcnt vmcnt(8)
    v_mfma_f32_16x16x32_bf16 a[0:3], v[40:43], v[88:91], 0
    v_mfma_f32_16x16x32_bf16 a[4:7], v[40:43], v[92:95], 0
    v_mfma_f32_16x16x32_bf16 a[8:11], v[40:43], v[96:99], 0
    v_mfma_f32_16x16x32_bf16 a[12:15], v[40:43], v[100:103], 0
    v_mfma_f32_16x16x32_bf16 a[16:19], v[44:47], v[88:91], 0
    v_mfma_f32_16x16x32_bf16 a[20:23], v[44:47], v[92:95], 0
    v_mfma_f32_16x16x32_bf16 a[24:27], v[44:47], v[96:99], 0
    v_mfma_f32_16x16x32_bf16 a[28:31], v[44:47], v[100:103], 0
    v_mfma_f32_16x16x32_bf16 a[32:35], v[48:51], v[88:91], 0
    v_mfma_f32_16x16x32_bf16 a[36:39], v[48:51], v[92:95], 0
    v_mfma_f32_16x16x32_bf16 a[40:43], v[48:51], v[96:99], 0
    v_mfma_f32_16x16x32_bf16 a[44:47], v[48:51], v[100:103], 0
    v_mfma_f32_16x16x32_bf16 a[48:51], v[52:55], v[88:91], 0
    v_mfma_f32_16x16x32_bf16 a[52:55], v[52:55], v[92:95], 0
    v_mfma_f32_16x16x32_bf16 a[56:59], v[52:55], v[96:99], 0
    v_mfma_f32_16x16x32_bf16 a[60:63], v[52:55], v[100:103], 0
    buffer_load_dwordx4 v[40:43], v10, s[48:51], s61 offen
    buffer_load_dwordx4 v[44:47], v11, s[48:51], s61 offen
    buffer_load_dwordx4 v[48:51], v12, s[48:51], s61 offen
    buffer_load_dwordx4 v[52:55], v13, s[48:51], s61 offen
    s_add_u32 s61, s61, 0x400
    ds_read_b128 v[88:91], v18 offset:0
    ds_read_b128 v[92:95], v18 offset:16384
    ds_read_b128 v[96:99], v18 offset:32768
    ds_read_b128 v[100:103], v18 offset:49152
    s_waitcnt lgkmcnt(4)
    s_waitcnt vmcnt(8)
    v_mfma_f32_16x16x32_bf16 a[0:3], v[56:59], v[104:107], a[0:3]
    v_mfma_f32_16x16x32_bf16 a[4:7], v[56:59], v[108:111], a[4:7]
    v_mfma_f32_16x16x32_bf16 a[8:11], v[56:59], v[112:115], a[8:11]
    v_mfma_f32_16x16x32_bf16 a[12:15], v[56:59], v[116:119], a[12:15]
    v_mfma_f32_16x16x32_bf16 a[16:19], v[60:63], v[104:107], a[16:19]
    v_mfma_f32_16x16x32_bf16 a[20:23], v[60:63], v[108:111], a[20:23]
    v_mfma_f32_16x16x32_bf16 a[24:27], v[60:63], v[112:115], a[24:27]
    v_mfma_f32_16x16x32_bf16 a[28:31], v[60:63], v[116:119], a[28:31]
    v_mfma_f32_16x16x32_bf16 a[32:35], v[64:67], v[104:107], a[32:35]
    v_mfma_f32_16x16x32_bf16 a[36:39], v[64:67], v[108:111], a[36:39]
    v_mfma_f32_16x16x32_bf16 a[40:43], v[64:67], v[112:115], a[40:43]
    v_mfma_f32_16x16x32_bf16 a[44:47], v[64:67], v[116:119], a[44:47]
    v_mfma_f32_16x16x32_bf16 a[48:51], v[68:71], v[104:107], a[48:51]
    v_mfma_f32_16x16x32_bf16 a[52:55], v[68:71], v[108:111], a[52:55]
    v_mfma_f32_16x16x32_bf16 a[56:59], v[68:71], v[112:115], a[56:59]
    v_mfma_f32_16x16x32_bf16 a[60:63], v[68:71], v[116:119], a[60:63]
    buffer_load_dwordx4 v[56:59], v10, s[48:51], s61 offen
    buffer_load_dwordx4 v[60:63], v11, s[48:51], s61 offen
    buffer_load_dwordx4 v[64:67], v12, s[48:51], s61 offen
    buffer_load_dwordx4 v[68:71], v13, s[48:51], s61 offen
    s_add_u32 s61, s61, 0x400
    ds_read_b128 v[104:107], v19 offset:0
    ds_read_b128 v[108:111], v19 offset:16384
    ds_read_b128 v[112:115], v19 offset:32768
    ds_read_b128 v[116:119], v19 offset:49152
    s_waitcnt lgkmcnt(4)
    s_waitcnt vmcnt(8)
    v_mfma_f32_16x16x32_bf16 a[0:3], v[72:75], v[88:91], a[0:3]
    v_mfma_f32_16x16x32_bf16 a[4:7], v[72:75], v[92:95], a[4:7]
    v_mfma_f32_16x16x32_bf16 a[8:11], v[72:75], v[96:99], a[8:11]
    v_mfma_f32_16x16x32_bf16 a[12:15], v[72:75], v[100:103], a[12:15]
    v_mfma_f32_16x16x32_bf16 a[16:19], v[76:79], v[88:91], a[16:19]
    v_mfma_f32_16x16x32_bf16 a[20:23], v[76:79], v[92:95], a[20:23]
    v_mfma_f32_16x16x32_bf16 a[24:27], v[76:79], v[96:99], a[24:27]
    v_mfma_f32_16x16x32_bf16 a[28:31], v[76:79], v[100:103], a[28:31]
    v_mfma_f32_16x16x32_bf16 a[32:35], v[80:83], v[88:91], a[32:35]
    v_mfma_f32_16x16x32_bf16 a[36:39], v[80:83], v[92:95], a[36:39]
    v_mfma_f32_16x16x32_bf16 a[40:43], v[80:83], v[96:99], a[40:43]
    v_mfma_f32_16x16x32_bf16 a[44:47], v[80:83], v[100:103], a[44:47]
    v_mfma_f32_16x16x32_bf16 a[48:51], v[84:87], v[88:91], a[48:51]
    v_mfma_f32_16x16x32_bf16 a[52:55], v[84:87], v[92:95], a[52:55]
    v_mfma_f32_16x16x32_bf16 a[56:59], v[84:87], v[96:99], a[56:59]
    v_mfma_f32_16x16x32_bf16 a[60:63], v[84:87], v[100:103], a[60:63]
    buffer_load_dwordx4 v[72:75], v10, s[48:51], s61 offen
    buffer_load_dwordx4 v[76:79], v11, s[48:51], s61 offen
    buffer_load_dwordx4 v[80:83], v12, s[48:51], s61 offen
    buffer_load_dwordx4 v[84:87], v13, s[48:51], s61 offen
    s_add_u32 s61, s61, 0x400
    ds_read_b128 v[88:91], v16 offset:256
    ds_read_b128 v[92:95], v16 offset:16640
    ds_read_b128 v[96:99], v16 offset:33024
    ds_read_b128 v[100:103], v16 offset:49408
    s_waitcnt lgkmcnt(4)
    s_waitcnt vmcnt(8)
    v_mfma_f32_16x16x32_bf16 a[0:3], v[40:43], v[104:107], a[0:3]
    v_mfma_f32_16x16x32_bf16 a[4:7], v[40:43], v[108:111], a[4:7]
    v_mfma_f32_16x16x32_bf16 a[8:11], v[40:43], v[112:115], a[8:11]
    v_mfma_f32_16x16x32_bf16 a[12:15], v[40:43], v[116:119], a[12:15]
    v_mfma_f32_16x16x32_bf16 a[16:19], v[44:47], v[104:107], a[16:19]
    v_mfma_f32_16x16x32_bf16 a[20:23], v[44:47], v[108:111], a[20:23]
    v_mfma_f32_16x16x32_bf16 a[24:27], v[44:47], v[112:115], a[24:27]
    v_mfma_f32_16x16x32_bf16 a[28:31], v[44:47], v[116:119], a[28:31]
    v_mfma_f32_16x16x32_bf16 a[32:35], v[48:51], v[104:107], a[32:35]
    v_mfma_f32_16x16x32_bf16 a[36:39], v[48:51], v[108:111], a[36:39]
    v_mfma_f32_16x16x32_bf16 a[40:43], v[48:51], v[112:115], a[40:43]
    v_mfma_f32_16x16x32_bf16 a[44:47], v[48:51], v[116:119], a[44:47]
    v_mfma_f32_16x16x32_bf16 a[48:51], v[52:55], v[104:107], a[48:51]
    v_mfma_f32_16x16x32_bf16 a[52:55], v[52:55], v[108:111], a[52:55]
    v_mfma_f32_16x16x32_bf16 a[56:59], v[52:55], v[112:115], a[56:59]
    v_mfma_f32_16x16x32_bf16 a[60:63], v[52:55], v[116:119], a[60:63]
    buffer_load_dwordx4 v[40:43], v10, s[48:51], s61 offen
    buffer_load_dwordx4 v[44:47], v11, s[48:51], s61 offen
    buffer_load_dwordx4 v[48:51], v12, s[48:51], s61 offen
    buffer_load_dwordx4 v[52:55], v13, s[48:51], s61 offen
    s_add_u32 s61, s61, 0x400
    ds_read_b128 v[104:107], v17 offset:256
    ds_read_b128 v[108:111], v17 offset:16640
    ds_read_b128 v[112:115], v17 offset:33024
    ds_read_b128 v[116:119], v17 offset:49408
    s_waitcnt lgkmcnt(4)
    s_waitcnt vmcnt(8)
    v_mfma_f32_16x16x32_bf16 a[0:3], v[56:59], v[88:91], a[0:3]
    v_mfma_f32_16x16x32_bf16 a[4:7], v[56:59], v[92:95], a[4:7]
    v_mfma_f32_16x16x32_bf16 a[8:11], v[56:59], v[96:99], a[8:11]
    v_mfma_f32_16x16x32_bf16 a[12:15], v[56:59], v[100:103], a[12:15]
    v_mfma_f32_16x16x32_bf16 a[16:19], v[60:63], v[88:91], a[16:19]
    v_mfma_f32_16x16x32_bf16 a[20:23], v[60:63], v[92:95], a[20:23]
    v_mfma_f32_16x16x32_bf16 a[24:27], v[60:63], v[96:99], a[24:27]
    v_mfma_f32_16x16x32_bf16 a[28:31], v[60:63], v[100:103], a[28:31]
    v_mfma_f32_16x16x32_bf16 a[32:35], v[64:67], v[88:91], a[32:35]
    v_mfma_f32_16x16x32_bf16 a[36:39], v[64:67], v[92:95], a[36:39]
    v_mfma_f32_16x16x32_bf16 a[40:43], v[64:67], v[96:99], a[40:43]
    v_mfma_f32_16x16x32_bf16 a[44:47], v[64:67], v[100:103], a[44:47]
    v_mfma_f32_16x16x32_bf16 a[48:51], v[68:71], v[88:91], a[48:51]
    v_mfma_f32_16x16x32_bf16 a[52:55], v[68:71], v[92:95], a[52:55]
    v_mfma_f32_16x16x32_bf16 a[56:59], v[68:71], v[96:99], a[56:59]
    v_mfma_f32_16x16x32_bf16 a[60:63], v[68:71], v[100:103], a[60:63]
    buffer_load_dwordx4 v[56:59], v10, s[48:51], s61 offen
    buffer_load_dwordx4 v[60:63], v11, s[48:51], s61 offen
    buffer_load_dwordx4 v[64:67], v12, s[48:51], s61 offen
    buffer_load_dwordx4 v[68:71], v13, s[48:51], s61 offen
    s_add_u32 s61, s61, 0x400
    ds_read_b128 v[88:91], v18 offset:256
    ds_read_b128 v[92:95], v18 offset:16640
    ds_read_b128 v[96:99], v18 offset:33024
    ds_read_b128 v[100:103], v18 offset:49408
    s_waitcnt lgkmcnt(4)
    s_waitcnt vmcnt(8)
    v_mfma_f32_16x16x32_bf16 a[0:3], v[72:75], v[104:107], a[0:3]
    v_mfma_f32_16x16x32_bf16 a[4:7], v[72:75], v[108:111], a[4:7]
    v_mfma_f32_16x16x32_bf16 a[8:11], v[72:75], v[112:115], a[8:11]
    v_mfma_f32_16x16x32_bf16 a[12:15], v[72:75], v[116:119], a[12:15]
    v_mfma_f32_16x16x32_bf16 a[16:19], v[76:79], v[104:107], a[16:19]
    v_mfma_f32_16x16x32_bf16 a[20:23], v[76:79], v[108:111], a[20:23]
    v_mfma_f32_16x16x32_bf16 a[24:27], v[76:79], v[112:115], a[24:27]
    v_mfma_f32_16x16x32_bf16 a[28:31], v[76:79], v[116:119], a[28:31]
    v_mfma_f32_16x16x32_bf16 a[32:35], v[80:83], v[104:107], a[32:35]
    v_mfma_f32_16x16x32_bf16 a[36:39], v[80:83], v[108:111], a[36:39]
    v_mfma_f32_16x16x32_bf16 a[40:43], v[80:83], v[112:115], a[40:43]
    v_mfma_f32_16x16x32_bf16 a[44:47], v[80:83], v[116:119], a[44:47]
    v_mfma_f32_16x16x32_bf16 a[48:51], v[84:87], v[104:107], a[48:51]
    v_mfma_f32_16x16x32_bf16 a[52:55], v[84:87], v[108:111], a[52:55]
    v_mfma_f32_16x16x32_bf16 a[56:59], v[84:87], v[112:115], a[56:59]
    v_mfma_f32_16x16x32_bf16 a[60:63], v[84:87], v[116:119], a[60:63]
    buffer_load_dwordx4 v[72:75], v10, s[48:51], s61 offen
    buffer_load_dwordx4 v[76:79], v11, s[48:51], s61 offen
    buffer_load_dwordx4 v[80:83], v12, s[48:51], s61 offen
    buffer_load_dwordx4 v[84:87], v13, s[48:51], s61 offen
    s_add_u32 s61, s61, 0x400
    ds_read_b128 v[104:107], v19 offset:256
    ds_read_b128 v[108:111], v19 offset:16640
    ds_read_b128 v[112:115], v19 offset:33024
    ds_read_b128 v[116:119], v19 offset:49408
    s_waitcnt lgkmcnt(4)
    s_waitcnt vmcnt(8)
    v_mfma_f32_16x16x32_bf16 a[0:3], v[40:43], v[88:91], a[0:3]
    v_mfma_f32_16x16x32_bf16 a[4:7], v[40:43], v[92:95], a[4:7]
    v_mfma_f32_16x16x32_bf16 a[8:11], v[40:43], v[96:99], a[8:11]
    v_mfma_f32_16x16x32_bf16 a[12:15], v[40:43], v[100:103], a[12:15]
    v_mfma_f32_16x16x32_bf16 a[16:19], v[44:47], v[88:91], a[16:19]
    v_mfma_f32_16x16x32_bf16 a[20:23], v[44:47], v[92:95], a[20:23]
    v_mfma_f32_16x16x32_bf16 a[24:27], v[44:47], v[96:99], a[24:27]
    v_mfma_f32_16x16x32_bf16 a[28:31], v[44:47], v[100:103], a[28:31]
    v_mfma_f32_16x16x32_bf16 a[32:35], v[48:51], v[88:91], a[32:35]
    v_mfma_f32_16x16x32_bf16 a[36:39], v[48:51], v[92:95], a[36:39]
    v_mfma_f32_16x16x32_bf16 a[40:43], v[48:51], v[96:99], a[40:43]
    v_mfma_f32_16x16x32_bf16 a[44:47], v[48:51], v[100:103], a[44:47]
    v_mfma_f32_16x16x32_bf16 a[48:51], v[52:55], v[88:91], a[48:51]
    v_mfma_f32_16x16x32_bf16 a[52:55], v[52:55], v[92:95], a[52:55]
    v_mfma_f32_16x16x32_bf16 a[56:59], v[52:55], v[96:99], a[56:59]
    v_mfma_f32_16x16x32_bf16 a[60:63], v[52:55], v[100:103], a[60:63]
    buffer_load_dwordx4 v[40:43], v10, s[48:51], s61 offen
    buffer_load_dwordx4 v[44:47], v11, s[48:51], s61 offen
    buffer_load_dwordx4 v[48:51], v12, s[48:51], s61 offen
    buffer_load_dwordx4 v[52:55], v13, s[48:51], s61 offen
    s_add_u32 s61, s61, 0x400
    ds_read_b128 v[88:91], v16 offset:512
    ds_read_b128 v[92:95], v16 offset:16896
    ds_read_b128 v[96:99], v16 offset:33280
    ds_read_b128 v[100:103], v16 offset:49664
    s_waitcnt lgkmcnt(4)
    s_waitcnt vmcnt(8)
    v_mfma_f32_16x16x32_bf16 a[0:3], v[56:59], v[104:107], a[0:3]
    v_mfma_f32_16x16x32_bf16 a[4:7], v[56:59], v[108:111], a[4:7]
    v_mfma_f32_16x16x32_bf16 a[8:11], v[56:59], v[112:115], a[8:11]
    v_mfma_f32_16x16x32_bf16 a[12:15], v[56:59], v[116:119], a[12:15]
    v_mfma_f32_16x16x32_bf16 a[16:19], v[60:63], v[104:107], a[16:19]
    v_mfma_f32_16x16x32_bf16 a[20:23], v[60:63], v[108:111], a[20:23]
    v_mfma_f32_16x16x32_bf16 a[24:27], v[60:63], v[112:115], a[24:27]
    v_mfma_f32_16x16x32_bf16 a[28:31], v[60:63], v[116:119], a[28:31]
    v_mfma_f32_16x16x32_bf16 a[32:35], v[64:67], v[104:107], a[32:35]
    v_mfma_f32_16x16x32_bf16 a[36:39], v[64:67], v[108:111], a[36:39]
    v_mfma_f32_16x16x32_bf16 a[40:43], v[64:67], v[112:115], a[40:43]
    v_mfma_f32_16x16x32_bf16 a[44:47], v[64:67], v[116:119], a[44:47]
    v_mfma_f32_16x16x32_bf16 a[48:51], v[68:71], v[104:107], a[48:51]
    v_mfma_f32_16x16x32_bf16 a[52:55], v[68:71], v[108:111], a[52:55]
    v_mfma_f32_16x16x32_bf16 a[56:59], v[68:71], v[112:115], a[56:59]
    v_mfma_f32_16x16x32_bf16 a[60:63], v[68:71], v[116:119], a[60:63]
    buffer_load_dwordx4 v[56:59], v10, s[48:51], s61 offen
    buffer_load_dwordx4 v[60:63], v11, s[48:51], s61 offen
    buffer_load_dwordx4 v[64:67], v12, s[48:51], s61 offen
    buffer_load_dwordx4 v[68:71], v13, s[48:51], s61 offen
    s_add_u32 s61, s61, 0x400
    ds_read_b128 v[104:107], v17 offset:512
    ds_read_b128 v[108:111], v17 offset:16896
    ds_read_b128 v[112:115], v17 offset:33280
    ds_read_b128 v[116:119], v17 offset:49664
    s_waitcnt lgkmcnt(4)
    s_waitcnt vmcnt(8)
    v_mfma_f32_16x16x32_bf16 a[0:3], v[72:75], v[88:91], a[0:3]
    v_mfma_f32_16x16x32_bf16 a[4:7], v[72:75], v[92:95], a[4:7]
    v_mfma_f32_16x16x32_bf16 a[8:11], v[72:75], v[96:99], a[8:11]
    v_mfma_f32_16x16x32_bf16 a[12:15], v[72:75], v[100:103], a[12:15]
    v_mfma_f32_16x16x32_bf16 a[16:19], v[76:79], v[88:91], a[16:19]
    v_mfma_f32_16x16x32_bf16 a[20:23], v[76:79], v[92:95], a[20:23]
    v_mfma_f32_16x16x32_bf16 a[24:27], v[76:79], v[96:99], a[24:27]
    v_mfma_f32_16x16x32_bf16 a[28:31], v[76:79], v[100:103], a[28:31]
    v_mfma_f32_16x16x32_bf16 a[32:35], v[80:83], v[88:91], a[32:35]
    v_mfma_f32_16x16x32_bf16 a[36:39], v[80:83], v[92:95], a[36:39]
    v_mfma_f32_16x16x32_bf16 a[40:43], v[80:83], v[96:99], a[40:43]
    v_mfma_f32_16x16x32_bf16 a[44:47], v[80:83], v[100:103], a[44:47]
    v_mfma_f32_16x16x32_bf16 a[48:51], v[84:87], v[88:91], a[48:51]
    v_mfma_f32_16x16x32_bf16 a[52:55], v[84:87], v[92:95], a[52:55]
    v_mfma_f32_16x16x32_bf16 a[56:59], v[84:87], v[96:99], a[56:59]
    v_mfma_f32_16x16x32_bf16 a[60:63], v[84:87], v[100:103], a[60:63]
    buffer_load_dwordx4 v[72:75], v10, s[48:51], s61 offen
    buffer_load_dwordx4 v[76:79], v11, s[48:51], s61 offen
    buffer_load_dwordx4 v[80:83], v12, s[48:51], s61 offen
    buffer_load_dwordx4 v[84:87], v13, s[48:51], s61 offen
    s_add_u32 s61, s61, 0x400
    ds_read_b128 v[88:91], v18 offset:512
    ds_read_b128 v[92:95], v18 offset:16896
    ds_read_b128 v[96:99], v18 offset:33280
    ds_read_b128 v[100:103], v18 offset:49664
    s_waitcnt lgkmcnt(4)
    s_waitcnt vmcnt(8)
    v_mfma_f32_16x16x32_bf16 a[0:3], v[40:43], v[104:107], a[0:3]
    v_mfma_f32_16x16x32_bf16 a[4:7], v[40:43], v[108:111], a[4:7]
    v_mfma_f32_16x16x32_bf16 a[8:11], v[40:43], v[112:115], a[8:11]
    v_mfma_f32_16x16x32_bf16 a[12:15], v[40:43], v[116:119], a[12:15]
    v_mfma_f32_16x16x32_bf16 a[16:19], v[44:47], v[104:107], a[16:19]
    v_mfma_f32_16x16x32_bf16 a[20:23], v[44:47], v[108:111], a[20:23]
    v_mfma_f32_16x16x32_bf16 a[24:27], v[44:47], v[112:115], a[24:27]
    v_mfma_f32_16x16x32_bf16 a[28:31], v[44:47], v[116:119], a[28:31]
    v_mfma_f32_16x16x32_bf16 a[32:35], v[48:51], v[104:107], a[32:35]
    v_mfma_f32_16x16x32_bf16 a[36:39], v[48:51], v[108:111], a[36:39]
    v_mfma_f32_16x16x32_bf16 a[40:43], v[48:51], v[112:115], a[40:43]
    v_mfma_f32_16x16x32_bf16 a[44:47], v[48:51], v[116:119], a[44:47]
    v_mfma_f32_16x16x32_bf16 a[48:51], v[52:55], v[104:107], a[48:51]
    v_mfma_f32_16x16x32_bf16 a[52:55], v[52:55], v[108:111], a[52:55]
    v_mfma_f32_16x16x32_bf16 a[56:59], v[52:55], v[112:115], a[56:59]
    v_mfma_f32_16x16x32_bf16 a[60:63], v[52:55], v[116:119], a[60:63]
    buffer_load_dwordx4 v[40:43], v10, s[48:51], s61 offen
    buffer_load_dwordx4 v[44:47], v11, s[48:51], s61 offen
    buffer_load_dwordx4 v[48:51], v12, s[48:51], s61 offen
    buffer_load_dwordx4 v[52:55], v13, s[48:51], s61 offen
    s_add_u32 s61, s61, 0x400
    ds_read_b128 v[104:107], v19 offset:512
    ds_read_b128 v[108:111], v19 offset:16896
    ds_read_b128 v[112:115], v19 offset:33280
    ds_read_b128 v[116:119], v19 offset:49664
    s_waitcnt lgkmcnt(4)
    s_waitcnt vmcnt(8)
    v_mfma_f32_16x16x32_bf16 a[0:3], v[56:59], v[88:91], a[0:3]
    v_mfma_f32_16x16x32_bf16 a[4:7], v[56:59], v[92:95], a[4:7]
    v_mfma_f32_16x16x32_bf16 a[8:11], v[56:59], v[96:99], a[8:11]
    v_mfma_f32_16x16x32_bf16 a[12:15], v[56:59], v[100:103], a[12:15]
    v_mfma_f32_16x16x32_bf16 a[16:19], v[60:63], v[88:91], a[16:19]
    v_mfma_f32_16x16x32_bf16 a[20:23], v[60:63], v[92:95], a[20:23]
    v_mfma_f32_16x16x32_bf16 a[24:27], v[60:63], v[96:99], a[24:27]
    v_mfma_f32_16x16x32_bf16 a[28:31], v[60:63], v[100:103], a[28:31]
    v_mfma_f32_16x16x32_bf16 a[32:35], v[64:67], v[88:91], a[32:35]
    v_mfma_f32_16x16x32_bf16 a[36:39], v[64:67], v[92:95], a[36:39]
    v_mfma_f32_16x16x32_bf16 a[40:43], v[64:67], v[96:99], a[40:43]
    v_mfma_f32_16x16x32_bf16 a[44:47], v[64:67], v[100:103], a[44:47]
    v_mfma_f32_16x16x32_bf16 a[48:51], v[68:71], v[88:91], a[48:51]
    v_mfma_f32_16x16x32_bf16 a[52:55], v[68:71], v[92:95], a[52:55]
    v_mfma_f32_16x16x32_bf16 a[56:59], v[68:71], v[96:99], a[56:59]
    v_mfma_f32_16x16x32_bf16 a[60:63], v[68:71], v[100:103], a[60:63]
    buffer_load_dwordx4 v[56:59], v10, s[48:51], s61 offen
    buffer_load_dwordx4 v[60:63], v11, s[48:51], s61 offen
    buffer_load_dwordx4 v[64:67], v12, s[48:51], s61 offen
    buffer_load_dwordx4 v[68:71], v13, s[48:51], s61 offen
    s_add_u32 s61, s61, 0x400
    ds_read_b128 v[88:91], v16 offset:768
    ds_read_b128 v[92:95], v16 offset:17152
    ds_read_b128 v[96:99], v16 offset:33536
    ds_read_b128 v[100:103], v16 offset:49920
    s_waitcnt lgkmcnt(4)
    s_waitcnt vmcnt(8)
    v_mfma_f32_16x16x32_bf16 a[0:3], v[72:75], v[104:107], a[0:3]
    v_mfma_f32_16x16x32_bf16 a[4:7], v[72:75], v[108:111], a[4:7]
    v_mfma_f32_16x16x32_bf16 a[8:11], v[72:75], v[112:115], a[8:11]
    v_mfma_f32_16x16x32_bf16 a[12:15], v[72:75], v[116:119], a[12:15]
    v_mfma_f32_16x16x32_bf16 a[16:19], v[76:79], v[104:107], a[16:19]
    v_mfma_f32_16x16x32_bf16 a[20:23], v[76:79], v[108:111], a[20:23]
    v_mfma_f32_16x16x32_bf16 a[24:27], v[76:79], v[112:115], a[24:27]
    v_mfma_f32_16x16x32_bf16 a[28:31], v[76:79], v[116:119], a[28:31]
    v_mfma_f32_16x16x32_bf16 a[32:35], v[80:83], v[104:107], a[32:35]
    v_mfma_f32_16x16x32_bf16 a[36:39], v[80:83], v[108:111], a[36:39]
    v_mfma_f32_16x16x32_bf16 a[40:43], v[80:83], v[112:115], a[40:43]
    v_mfma_f32_16x16x32_bf16 a[44:47], v[80:83], v[116:119], a[44:47]
    v_mfma_f32_16x16x32_bf16 a[48:51], v[84:87], v[104:107], a[48:51]
    v_mfma_f32_16x16x32_bf16 a[52:55], v[84:87], v[108:111], a[52:55]
    v_mfma_f32_16x16x32_bf16 a[56:59], v[84:87], v[112:115], a[56:59]
    v_mfma_f32_16x16x32_bf16 a[60:63], v[84:87], v[116:119], a[60:63]
    buffer_load_dwordx4 v[72:75], v10, s[48:51], s61 offen
    buffer_load_dwordx4 v[76:79], v11, s[48:51], s61 offen
    buffer_load_dwordx4 v[80:83], v12, s[48:51], s61 offen
    buffer_load_dwordx4 v[84:87], v13, s[48:51], s61 offen
    s_add_u32 s61, s61, 0x400
    ds_read_b128 v[104:107], v17 offset:768
    ds_read_b128 v[108:111], v17 offset:17152
    ds_read_b128 v[112:115], v17 offset:33536
    ds_read_b128 v[116:119], v17 offset:49920
    s_waitcnt lgkmcnt(4)
    s_waitcnt vmcnt(8)
    v_mfma_f32_16x16x32_bf16 a[0:3], v[40:43], v[88:91], a[0:3]
    v_mfma_f32_16x16x32_bf16 a[4:7], v[40:43], v[92:95], a[4:7]
    v_mfma_f32_16x16x32_bf16 a[8:11], v[40:43], v[96:99], a[8:11]
    v_mfma_f32_16x16x32_bf16 a[12:15], v[40:43], v[100:103], a[12:15]
    v_mfma_f32_16x16x32_bf16 a[16:19], v[44:47], v[88:91], a[16:19]
    v_mfma_f32_16x16x32_bf16 a[20:23], v[44:47], v[92:95], a[20:23]
    v_mfma_f32_16x16x32_bf16 a[24:27], v[44:47], v[96:99], a[24:27]
    v_mfma_f32_16x16x32_bf16 a[28:31], v[44:47], v[100:103], a[28:31]
    v_mfma_f32_16x16x32_bf16 a[32:35], v[48:51], v[88:91], a[32:35]
    v_mfma_f32_16x16x32_bf16 a[36:39], v[48:51], v[92:95], a[36:39]
    v_mfma_f32_16x16x32_bf16 a[40:43], v[48:51], v[96:99], a[40:43]
    v_mfma_f32_16x16x32_bf16 a[44:47], v[48:51], v[100:103], a[44:47]
    v_mfma_f32_16x16x32_bf16 a[48:51], v[52:55], v[88:91], a[48:51]
    v_mfma_f32_16x16x32_bf16 a[52:55], v[52:55], v[92:95], a[52:55]
    v_mfma_f32_16x16x32_bf16 a[56:59], v[52:55], v[96:99], a[56:59]
    v_mfma_f32_16x16x32_bf16 a[60:63], v[52:55], v[100:103], a[60:63]
    buffer_load_dwordx4 v[40:43], v10, s[48:51], s61 offen
    buffer_load_dwordx4 v[44:47], v11, s[48:51], s61 offen
    buffer_load_dwordx4 v[48:51], v12, s[48:51], s61 offen
    buffer_load_dwordx4 v[52:55], v13, s[48:51], s61 offen
    s_add_u32 s61, s61, 0x400
    ds_read_b128 v[88:91], v18 offset:768
    ds_read_b128 v[92:95], v18 offset:17152
    ds_read_b128 v[96:99], v18 offset:33536
    ds_read_b128 v[100:103], v18 offset:49920
    s_waitcnt lgkmcnt(4)
    s_waitcnt vmcnt(8)
    v_mfma_f32_16x16x32_bf16 a[0:3], v[56:59], v[104:107], a[0:3]
    v_mfma_f32_16x16x32_bf16 a[4:7], v[56:59], v[108:111], a[4:7]
    v_mfma_f32_16x16x32_bf16 a[8:11], v[56:59], v[112:115], a[8:11]
    v_mfma_f32_16x16x32_bf16 a[12:15], v[56:59], v[116:119], a[12:15]
    v_mfma_f32_16x16x32_bf16 a[16:19], v[60:63], v[104:107], a[16:19]
    v_mfma_f32_16x16x32_bf16 a[20:23], v[60:63], v[108:111], a[20:23]
    v_mfma_f32_16x16x32_bf16 a[24:27], v[60:63], v[112:115], a[24:27]
    v_mfma_f32_16x16x32_bf16 a[28:31], v[60:63], v[116:119], a[28:31]
    v_mfma_f32_16x16x32_bf16 a[32:35], v[64:67], v[104:107], a[32:35]
    v_mfma_f32_16x16x32_bf16 a[36:39], v[64:67], v[108:111], a[36:39]
    v_mfma_f32_16x16x32_bf16 a[40:43], v[64:67], v[112:115], a[40:43]
    v_mfma_f32_16x16x32_bf16 a[44:47], v[64:67], v[116:119], a[44:47]
    v_mfma_f32_16x16x32_bf16 a[48:51], v[68:71], v[104:107], a[48:51]
    v_mfma_f32_16x16x32_bf16 a[52:55], v[68:71], v[108:111], a[52:55]
    v_mfma_f32_16x16x32_bf16 a[56:59], v[68:71], v[112:115], a[56:59]
    v_mfma_f32_16x16x32_bf16 a[60:63], v[68:71], v[116:119], a[60:63]
    ds_read_b128 v[104:107], v19 offset:768
    ds_read_b128 v[108:111], v19 offset:17152
    ds_read_b128 v[112:115], v19 offset:33536
    ds_read_b128 v[116:119], v19 offset:49920
    s_waitcnt lgkmcnt(4)
    s_waitcnt vmcnt(4)
    v_mfma_f32_16x16x32_bf16 a[0:3], v[72:75], v[88:91], a[0:3]
    v_mfma_f32_16x16x32_bf16 a[4:7], v[72:75], v[92:95], a[4:7]
    v_mfma_f32_16x16x32_bf16 a[8:11], v[72:75], v[96:99], a[8:11]
    v_mfma_f32_16x16x32_bf16 a[12:15], v[72:75], v[100:103], a[12:15]
    v_mfma_f32_16x16x32_bf16 a[16:19], v[76:79], v[88:91], a[16:19]
    v_mfma_f32_16x16x32_bf16 a[20:23], v[76:79], v[92:95], a[20:23]
    v_mfma_f32_16x16x32_bf16 a[24:27], v[76:79], v[96:99], a[24:27]
    v_mfma_f32_16x16x32_bf16 a[28:31], v[76:79], v[100:103], a[28:31]
    v_mfma_f32_16x16x32_bf16 a[32:35], v[80:83], v[88:91], a[32:35]
    v_mfma_f32_16x16x32_bf16 a[36:39], v[80:83], v[92:95], a[36:39]
    v_mfma_f32_16x16x32_bf16 a[40:43], v[80:83], v[96:99], a[40:43]
    v_mfma_f32_16x16x32_bf16 a[44:47], v[80:83], v[100:103], a[44:47]
    v_mfma_f32_16x16x32_bf16 a[48:51], v[84:87], v[88:91], a[48:51]
    v_mfma_f32_16x16x32_bf16 a[52:55], v[84:87], v[92:95], a[52:55]
    v_mfma_f32_16x16x32_bf16 a[56:59], v[84:87], v[96:99], a[56:59]
    v_mfma_f32_16x16x32_bf16 a[60:63], v[84:87], v[100:103], a[60:63]
    s_waitcnt lgkmcnt(0)
    s_waitcnt vmcnt(0)
    v_mfma_f32_16x16x32_bf16 a[0:3], v[40:43], v[104:107], a[0:3]
    v_mfma_f32_16x16x32_bf16 a[4:7], v[40:43], v[108:111], a[4:7]
    v_mfma_f32_16x16x32_bf16 a[8:11], v[40:43], v[112:115], a[8:11]
    v_mfma_f32_16x16x32_bf16 a[12:15], v[40:43], v[116:119], a[12:15]
    v_mfma_f32_16x16x32_bf16 a[16:19], v[44:47], v[104:107], a[16:19]
    v_mfma_f32_16x16x32_bf16 a[20:23], v[44:47], v[108:111], a[20:23]
    v_mfma_f32_16x16x32_bf16 a[24:27], v[44:47], v[112:115], a[24:27]
    v_mfma_f32_16x16x32_bf16 a[28:31], v[44:47], v[116:119], a[28:31]
    v_mfma_f32_16x16x32_bf16 a[32:35], v[48:51], v[104:107], a[32:35]
    v_mfma_f32_16x16x32_bf16 a[36:39], v[48:51], v[108:111], a[36:39]
    v_mfma_f32_16x16x32_bf16 a[40:43], v[48:51], v[112:115], a[40:43]
    v_mfma_f32_16x16x32_bf16 a[44:47], v[48:51], v[116:119], a[44:47]
    v_mfma_f32_16x16x32_bf16 a[48:51], v[52:55], v[104:107], a[48:51]
    v_mfma_f32_16x16x32_bf16 a[52:55], v[52:55], v[108:111], a[52:55]
    v_mfma_f32_16x16x32_bf16 a[56:59], v[52:55], v[112:115], a[56:59]
    v_mfma_f32_16x16x32_bf16 a[60:63], v[52:55], v[116:119], a[60:63]
    v_and_b32 v2, 15, v1
    v_lshrrev_b32 v3, 4, v1
    v_lshlrev_b32 v4, 4, v2
    v_lshrrev_b32 v5, 1, v3
    v_lshl_add_u32 v4, v5, 8, v4
    v_and_b32 v5, 1, v3
    v_lshl_add_u32 v4, v5, 3, v4
    v_lshlrev_b32 v5, 3, v3
    buffer_load_dwordx2 v[136:137], v5, s[56:59], s63 offen offset:0
    buffer_load_dwordx2 v[138:139], v5, s[56:59], s63 offen offset:32
    buffer_load_dwordx2 v[140:141], v5, s[56:59], s63 offen offset:64
    buffer_load_dwordx2 v[142:143], v5, s[56:59], s63 offen offset:96
    s_mul_i32 s6, s4, 0x38000
    s_lshl_b32 s7, s63, 4
    s_add_u32 s64, s6, s7
    s_add_u32 s65, s64, 0xe000
    s_add_u32 s66, s64, 0x1c000
    s_add_u32 s67, s64, 0x2a000
    s_waitcnt vmcnt(0)
    v_lshlrev_b32 v144, 16, v136
    v_and_b32 v145, 0xffff0000, v136
    v_lshlrev_b32 v146, 16, v137
    v_and_b32 v147, 0xffff0000, v137
    v_lshlrev_b32 v148, 16, v138
    v_and_b32 v149, 0xffff0000, v138
    v_lshlrev_b32 v150, 16, v139
    v_and_b32 v151, 0xffff0000, v139
    v_lshlrev_b32 v152, 16, v140
    v_and_b32 v153, 0xffff0000, v140
    v_lshlrev_b32 v154, 16, v141
    v_and_b32 v155, 0xffff0000, v141
    v_lshlrev_b32 v156, 16, v142
    v_and_b32 v157, 0xffff0000, v142
    v_lshlrev_b32 v158, 16, v143
    v_and_b32 v159, 0xffff0000, v143
    s_nop 7
    v_accvgpr_read_b32 v120, a0
    v_accvgpr_read_b32 v121, a1
    v_accvgpr_read_b32 v122, a2
    v_accvgpr_read_b32 v123, a3
    v_cvt_pk_bf16_f32 v124, v120, v121
    v_cvt_pk_bf16_f32 v125, v122, v123
    v_lshlrev_b32 v120, 16, v124
    v_and_b32 v121, 0xffff0000, v124
    v_lshlrev_b32 v122, 16, v125
    v_and_b32 v123, 0xffff0000, v125
    v_pk_add_f32 v[120:121], v[120:121], v[144:145]
    v_pk_add_f32 v[122:123], v[122:123], v[146:147]
    v_cvt_pk_bf16_f32 v124, v120, v121
    v_cvt_pk_bf16_f32 v125, v122, v123
    v_pk_max_i16 v124, v124, 0
    v_pk_max_i16 v125, v125, 0
    v_lshlrev_b32 v120, 16, v124
    v_and_b32 v121, 0xffff0000, v124
    v_lshlrev_b32 v122, 16, v125
    v_and_b32 v123, 0xffff0000, v125
    v_pk_mul_f32 v[120:121], v[120:121], v[120:121]
    v_pk_mul_f32 v[122:123], v[122:123], v[122:123]
    v_cvt_pk_bf16_f32 v124, v120, v121
    v_cvt_pk_bf16_f32 v125, v122, v123
    buffer_store_dwordx2 v[124:125], v4, s[52:55], s64 offen offset:0
    v_accvgpr_read_b32 v128, a4
    v_accvgpr_read_b32 v129, a5
    v_accvgpr_read_b32 v130, a6
    v_accvgpr_read_b32 v131, a7
    v_cvt_pk_bf16_f32 v132, v128, v129
    v_cvt_pk_bf16_f32 v133, v130, v131
    v_lshlrev_b32 v128, 16, v132
    v_and_b32 v129, 0xffff0000, v132
    v_lshlrev_b32 v130, 16, v133
    v_and_b32 v131, 0xffff0000, v133
    v_pk_add_f32 v[128:129], v[128:129], v[144:145]
    v_pk_add_f32 v[130:131], v[130:131], v[146:147]
    v_cvt_pk_bf16_f32 v132, v128, v129
    v_cvt_pk_bf16_f32 v133, v130, v131
    v_pk_max_i16 v132, v132, 0
    v_pk_max_i16 v133, v133, 0
    v_lshlrev_b32 v128, 16, v132
    v_and_b32 v129, 0xffff0000, v132
    v_lshlrev_b32 v130, 16, v133
    v_and_b32 v131, 0xffff0000, v133
    v_pk_mul_f32 v[128:129], v[128:129], v[128:129]
    v_pk_mul_f32 v[130:131], v[130:131], v[130:131]
    v_cvt_pk_bf16_f32 v132, v128, v129
    v_cvt_pk_bf16_f32 v133, v130, v131
    buffer_store_dwordx2 v[132:133], v4, s[52:55], s65 offen offset:0
    v_accvgpr_read_b32 v120, a8
    v_accvgpr_read_b32 v121, a9
    v_accvgpr_read_b32 v122, a10
    v_accvgpr_read_b32 v123, a11
    v_cvt_pk_bf16_f32 v124, v120, v121
    v_cvt_pk_bf16_f32 v125, v122, v123
    v_lshlrev_b32 v120, 16, v124
    v_and_b32 v121, 0xffff0000, v124
    v_lshlrev_b32 v122, 16, v125
    v_and_b32 v123, 0xffff0000, v125
    v_pk_add_f32 v[120:121], v[120:121], v[144:145]
    v_pk_add_f32 v[122:123], v[122:123], v[146:147]
    v_cvt_pk_bf16_f32 v124, v120, v121
    v_cvt_pk_bf16_f32 v125, v122, v123
    v_pk_max_i16 v124, v124, 0
    v_pk_max_i16 v125, v125, 0
    v_lshlrev_b32 v120, 16, v124
    v_and_b32 v121, 0xffff0000, v124
    v_lshlrev_b32 v122, 16, v125
    v_and_b32 v123, 0xffff0000, v125
    v_pk_mul_f32 v[120:121], v[120:121], v[120:121]
    v_pk_mul_f32 v[122:123], v[122:123], v[122:123]
    v_cvt_pk_bf16_f32 v124, v120, v121
    v_cvt_pk_bf16_f32 v125, v122, v123
    buffer_store_dwordx2 v[124:125], v4, s[52:55], s66 offen offset:0
    v_accvgpr_read_b32 v128, a12
    v_accvgpr_read_b32 v129, a13
    v_accvgpr_read_b32 v130, a14
    v_accvgpr_read_b32 v131, a15
    v_cvt_pk_bf16_f32 v132, v128, v129
    v_cvt_pk_bf16_f32 v133, v130, v131
    v_lshlrev_b32 v128, 16, v132
    v_and_b32 v129, 0xffff0000, v132
    v_lshlrev_b32 v130, 16, v133
    v_and_b32 v131, 0xffff0000, v133
    v_pk_add_f32 v[128:129], v[128:129], v[144:145]
    v_pk_add_f32 v[130:131], v[130:131], v[146:147]
    v_cvt_pk_bf16_f32 v132, v128, v129
    v_cvt_pk_bf16_f32 v133, v130, v131
    v_pk_max_i16 v132, v132, 0
    v_pk_max_i16 v133, v133, 0
    v_lshlrev_b32 v128, 16, v132
    v_and_b32 v129, 0xffff0000, v132
    v_lshlrev_b32 v130, 16, v133
    v_and_b32 v131, 0xffff0000, v133
    v_pk_mul_f32 v[128:129], v[128:129], v[128:129]
    v_pk_mul_f32 v[130:131], v[130:131], v[130:131]
    v_cvt_pk_bf16_f32 v132, v128, v129
    v_cvt_pk_bf16_f32 v133, v130, v131
    buffer_store_dwordx2 v[132:133], v4, s[52:55], s67 offen offset:0
    v_accvgpr_read_b32 v120, a16
    v_accvgpr_read_b32 v121, a17
    v_accvgpr_read_b32 v122, a18
    v_accvgpr_read_b32 v123, a19
    v_cvt_pk_bf16_f32 v124, v120, v121
    v_cvt_pk_bf16_f32 v125, v122, v123
    v_lshlrev_b32 v120, 16, v124
    v_and_b32 v121, 0xffff0000, v124
    v_lshlrev_b32 v122, 16, v125
    v_and_b32 v123, 0xffff0000, v125
    v_pk_add_f32 v[120:121], v[120:121], v[148:149]
    v_pk_add_f32 v[122:123], v[122:123], v[150:151]
    v_cvt_pk_bf16_f32 v124, v120, v121
    v_cvt_pk_bf16_f32 v125, v122, v123
    v_pk_max_i16 v124, v124, 0
    v_pk_max_i16 v125, v125, 0
    v_lshlrev_b32 v120, 16, v124
    v_and_b32 v121, 0xffff0000, v124
    v_lshlrev_b32 v122, 16, v125
    v_and_b32 v123, 0xffff0000, v125
    v_pk_mul_f32 v[120:121], v[120:121], v[120:121]
    v_pk_mul_f32 v[122:123], v[122:123], v[122:123]
    v_cvt_pk_bf16_f32 v124, v120, v121
    v_cvt_pk_bf16_f32 v125, v122, v123
    buffer_store_dwordx2 v[124:125], v4, s[52:55], s64 offen offset:512
    v_accvgpr_read_b32 v128, a20
    v_accvgpr_read_b32 v129, a21
    v_accvgpr_read_b32 v130, a22
    v_accvgpr_read_b32 v131, a23
    v_cvt_pk_bf16_f32 v132, v128, v129
    v_cvt_pk_bf16_f32 v133, v130, v131
    v_lshlrev_b32 v128, 16, v132
    v_and_b32 v129, 0xffff0000, v132
    v_lshlrev_b32 v130, 16, v133
    v_and_b32 v131, 0xffff0000, v133
    v_pk_add_f32 v[128:129], v[128:129], v[148:149]
    v_pk_add_f32 v[130:131], v[130:131], v[150:151]
    v_cvt_pk_bf16_f32 v132, v128, v129
    v_cvt_pk_bf16_f32 v133, v130, v131
    v_pk_max_i16 v132, v132, 0
    v_pk_max_i16 v133, v133, 0
    v_lshlrev_b32 v128, 16, v132
    v_and_b32 v129, 0xffff0000, v132
    v_lshlrev_b32 v130, 16, v133
    v_and_b32 v131, 0xffff0000, v133
    v_pk_mul_f32 v[128:129], v[128:129], v[128:129]
    v_pk_mul_f32 v[130:131], v[130:131], v[130:131]
    v_cvt_pk_bf16_f32 v132, v128, v129
    v_cvt_pk_bf16_f32 v133, v130, v131
    buffer_store_dwordx2 v[132:133], v4, s[52:55], s65 offen offset:512
    v_accvgpr_read_b32 v120, a24
    v_accvgpr_read_b32 v121, a25
    v_accvgpr_read_b32 v122, a26
    v_accvgpr_read_b32 v123, a27
    v_cvt_pk_bf16_f32 v124, v120, v121
    v_cvt_pk_bf16_f32 v125, v122, v123
    v_lshlrev_b32 v120, 16, v124
    v_and_b32 v121, 0xffff0000, v124
    v_lshlrev_b32 v122, 16, v125
    v_and_b32 v123, 0xffff0000, v125
    v_pk_add_f32 v[120:121], v[120:121], v[148:149]
    v_pk_add_f32 v[122:123], v[122:123], v[150:151]
    v_cvt_pk_bf16_f32 v124, v120, v121
    v_cvt_pk_bf16_f32 v125, v122, v123
    v_pk_max_i16 v124, v124, 0
    v_pk_max_i16 v125, v125, 0
    v_lshlrev_b32 v120, 16, v124
    v_and_b32 v121, 0xffff0000, v124
    v_lshlrev_b32 v122, 16, v125
    v_and_b32 v123, 0xffff0000, v125
    v_pk_mul_f32 v[120:121], v[120:121], v[120:121]
    v_pk_mul_f32 v[122:123], v[122:123], v[122:123]
    v_cvt_pk_bf16_f32 v124, v120, v121
    v_cvt_pk_bf16_f32 v125, v122, v123
    buffer_store_dwordx2 v[124:125], v4, s[52:55], s66 offen offset:512
    v_accvgpr_read_b32 v128, a28
    v_accvgpr_read_b32 v129, a29
    v_accvgpr_read_b32 v130, a30
    v_accvgpr_read_b32 v131, a31
    v_cvt_pk_bf16_f32 v132, v128, v129
    v_cvt_pk_bf16_f32 v133, v130, v131
    v_lshlrev_b32 v128, 16, v132
    v_and_b32 v129, 0xffff0000, v132
    v_lshlrev_b32 v130, 16, v133
    v_and_b32 v131, 0xffff0000, v133
    v_pk_add_f32 v[128:129], v[128:129], v[148:149]
    v_pk_add_f32 v[130:131], v[130:131], v[150:151]
    v_cvt_pk_bf16_f32 v132, v128, v129
    v_cvt_pk_bf16_f32 v133, v130, v131
    v_pk_max_i16 v132, v132, 0
    v_pk_max_i16 v133, v133, 0
    v_lshlrev_b32 v128, 16, v132
    v_and_b32 v129, 0xffff0000, v132
    v_lshlrev_b32 v130, 16, v133
    v_and_b32 v131, 0xffff0000, v133
    v_pk_mul_f32 v[128:129], v[128:129], v[128:129]
    v_pk_mul_f32 v[130:131], v[130:131], v[130:131]
    v_cvt_pk_bf16_f32 v132, v128, v129
    v_cvt_pk_bf16_f32 v133, v130, v131
    buffer_store_dwordx2 v[132:133], v4, s[52:55], s67 offen offset:512
    v_accvgpr_read_b32 v120, a32
    v_accvgpr_read_b32 v121, a33
    v_accvgpr_read_b32 v122, a34
    v_accvgpr_read_b32 v123, a35
    v_cvt_pk_bf16_f32 v124, v120, v121
    v_cvt_pk_bf16_f32 v125, v122, v123
    v_lshlrev_b32 v120, 16, v124
    v_and_b32 v121, 0xffff0000, v124
    v_lshlrev_b32 v122, 16, v125
    v_and_b32 v123, 0xffff0000, v125
    v_pk_add_f32 v[120:121], v[120:121], v[152:153]
    v_pk_add_f32 v[122:123], v[122:123], v[154:155]
    v_cvt_pk_bf16_f32 v124, v120, v121
    v_cvt_pk_bf16_f32 v125, v122, v123
    v_pk_max_i16 v124, v124, 0
    v_pk_max_i16 v125, v125, 0
    v_lshlrev_b32 v120, 16, v124
    v_and_b32 v121, 0xffff0000, v124
    v_lshlrev_b32 v122, 16, v125
    v_and_b32 v123, 0xffff0000, v125
    v_pk_mul_f32 v[120:121], v[120:121], v[120:121]
    v_pk_mul_f32 v[122:123], v[122:123], v[122:123]
    v_cvt_pk_bf16_f32 v124, v120, v121
    v_cvt_pk_bf16_f32 v125, v122, v123
    buffer_store_dwordx2 v[124:125], v4, s[52:55], s64 offen offset:1024
    v_accvgpr_read_b32 v128, a36
    v_accvgpr_read_b32 v129, a37
    v_accvgpr_read_b32 v130, a38
    v_accvgpr_read_b32 v131, a39
    v_cvt_pk_bf16_f32 v132, v128, v129
    v_cvt_pk_bf16_f32 v133, v130, v131
    v_lshlrev_b32 v128, 16, v132
    v_and_b32 v129, 0xffff0000, v132
    v_lshlrev_b32 v130, 16, v133
    v_and_b32 v131, 0xffff0000, v133
    v_pk_add_f32 v[128:129], v[128:129], v[152:153]
    v_pk_add_f32 v[130:131], v[130:131], v[154:155]
    v_cvt_pk_bf16_f32 v132, v128, v129
    v_cvt_pk_bf16_f32 v133, v130, v131
    v_pk_max_i16 v132, v132, 0
    v_pk_max_i16 v133, v133, 0
    v_lshlrev_b32 v128, 16, v132
    v_and_b32 v129, 0xffff0000, v132
    v_lshlrev_b32 v130, 16, v133
    v_and_b32 v131, 0xffff0000, v133
    v_pk_mul_f32 v[128:129], v[128:129], v[128:129]
    v_pk_mul_f32 v[130:131], v[130:131], v[130:131]
    v_cvt_pk_bf16_f32 v132, v128, v129
    v_cvt_pk_bf16_f32 v133, v130, v131
    buffer_store_dwordx2 v[132:133], v4, s[52:55], s65 offen offset:1024
    v_accvgpr_read_b32 v120, a40
    v_accvgpr_read_b32 v121, a41
    v_accvgpr_read_b32 v122, a42
    v_accvgpr_read_b32 v123, a43
    v_cvt_pk_bf16_f32 v124, v120, v121
    v_cvt_pk_bf16_f32 v125, v122, v123
    v_lshlrev_b32 v120, 16, v124
    v_and_b32 v121, 0xffff0000, v124
    v_lshlrev_b32 v122, 16, v125
    v_and_b32 v123, 0xffff0000, v125
    v_pk_add_f32 v[120:121], v[120:121], v[152:153]
    v_pk_add_f32 v[122:123], v[122:123], v[154:155]
    v_cvt_pk_bf16_f32 v124, v120, v121
    v_cvt_pk_bf16_f32 v125, v122, v123
    v_pk_max_i16 v124, v124, 0
    v_pk_max_i16 v125, v125, 0
    v_lshlrev_b32 v120, 16, v124
    v_and_b32 v121, 0xffff0000, v124
    v_lshlrev_b32 v122, 16, v125
    v_and_b32 v123, 0xffff0000, v125
    v_pk_mul_f32 v[120:121], v[120:121], v[120:121]
    v_pk_mul_f32 v[122:123], v[122:123], v[122:123]
    v_cvt_pk_bf16_f32 v124, v120, v121
    v_cvt_pk_bf16_f32 v125, v122, v123
    buffer_store_dwordx2 v[124:125], v4, s[52:55], s66 offen offset:1024
    v_accvgpr_read_b32 v128, a44
    v_accvgpr_read_b32 v129, a45
    v_accvgpr_read_b32 v130, a46
    v_accvgpr_read_b32 v131, a47
    v_cvt_pk_bf16_f32 v132, v128, v129
    v_cvt_pk_bf16_f32 v133, v130, v131
    v_lshlrev_b32 v128, 16, v132
    v_and_b32 v129, 0xffff0000, v132
    v_lshlrev_b32 v130, 16, v133
    v_and_b32 v131, 0xffff0000, v133
    v_pk_add_f32 v[128:129], v[128:129], v[152:153]
    v_pk_add_f32 v[130:131], v[130:131], v[154:155]
    v_cvt_pk_bf16_f32 v132, v128, v129
    v_cvt_pk_bf16_f32 v133, v130, v131
    v_pk_max_i16 v132, v132, 0
    v_pk_max_i16 v133, v133, 0
    v_lshlrev_b32 v128, 16, v132
    v_and_b32 v129, 0xffff0000, v132
    v_lshlrev_b32 v130, 16, v133
    v_and_b32 v131, 0xffff0000, v133
    v_pk_mul_f32 v[128:129], v[128:129], v[128:129]
    v_pk_mul_f32 v[130:131], v[130:131], v[130:131]
    v_cvt_pk_bf16_f32 v132, v128, v129
    v_cvt_pk_bf16_f32 v133, v130, v131
    buffer_store_dwordx2 v[132:133], v4, s[52:55], s67 offen offset:1024
    v_accvgpr_read_b32 v120, a48
    v_accvgpr_read_b32 v121, a49
    v_accvgpr_read_b32 v122, a50
    v_accvgpr_read_b32 v123, a51
    v_cvt_pk_bf16_f32 v124, v120, v121
    v_cvt_pk_bf16_f32 v125, v122, v123
    v_lshlrev_b32 v120, 16, v124
    v_and_b32 v121, 0xffff0000, v124
    v_lshlrev_b32 v122, 16, v125
    v_and_b32 v123, 0xffff0000, v125
    v_pk_add_f32 v[120:121], v[120:121], v[156:157]
    v_pk_add_f32 v[122:123], v[122:123], v[158:159]
    v_cvt_pk_bf16_f32 v124, v120, v121
    v_cvt_pk_bf16_f32 v125, v122, v123
    v_pk_max_i16 v124, v124, 0
    v_pk_max_i16 v125, v125, 0
    v_lshlrev_b32 v120, 16, v124
    v_and_b32 v121, 0xffff0000, v124
    v_lshlrev_b32 v122, 16, v125
    v_and_b32 v123, 0xffff0000, v125
    v_pk_mul_f32 v[120:121], v[120:121], v[120:121]
    v_pk_mul_f32 v[122:123], v[122:123], v[122:123]
    v_cvt_pk_bf16_f32 v124, v120, v121
    v_cvt_pk_bf16_f32 v125, v122, v123
    buffer_store_dwordx2 v[124:125], v4, s[52:55], s64 offen offset:1536
    v_accvgpr_read_b32 v128, a52
    v_accvgpr_read_b32 v129, a53
    v_accvgpr_read_b32 v130, a54
    v_accvgpr_read_b32 v131, a55
    v_cvt_pk_bf16_f32 v132, v128, v129
    v_cvt_pk_bf16_f32 v133, v130, v131
    v_lshlrev_b32 v128, 16, v132
    v_and_b32 v129, 0xffff0000, v132
    v_lshlrev_b32 v130, 16, v133
    v_and_b32 v131, 0xffff0000, v133
    v_pk_add_f32 v[128:129], v[128:129], v[156:157]
    v_pk_add_f32 v[130:131], v[130:131], v[158:159]
    v_cvt_pk_bf16_f32 v132, v128, v129
    v_cvt_pk_bf16_f32 v133, v130, v131
    v_pk_max_i16 v132, v132, 0
    v_pk_max_i16 v133, v133, 0
    v_lshlrev_b32 v128, 16, v132
    v_and_b32 v129, 0xffff0000, v132
    v_lshlrev_b32 v130, 16, v133
    v_and_b32 v131, 0xffff0000, v133
    v_pk_mul_f32 v[128:129], v[128:129], v[128:129]
    v_pk_mul_f32 v[130:131], v[130:131], v[130:131]
    v_cvt_pk_bf16_f32 v132, v128, v129
    v_cvt_pk_bf16_f32 v133, v130, v131
    buffer_store_dwordx2 v[132:133], v4, s[52:55], s65 offen offset:1536
    v_accvgpr_read_b32 v120, a56
    v_accvgpr_read_b32 v121, a57
    v_accvgpr_read_b32 v122, a58
    v_accvgpr_read_b32 v123, a59
    v_cvt_pk_bf16_f32 v124, v120, v121
    v_cvt_pk_bf16_f32 v125, v122, v123
    v_lshlrev_b32 v120, 16, v124
    v_and_b32 v121, 0xffff0000, v124
    v_lshlrev_b32 v122, 16, v125
    v_and_b32 v123, 0xffff0000, v125
    v_pk_add_f32 v[120:121], v[120:121], v[156:157]
    v_pk_add_f32 v[122:123], v[122:123], v[158:159]
    v_cvt_pk_bf16_f32 v124, v120, v121
    v_cvt_pk_bf16_f32 v125, v122, v123
    v_pk_max_i16 v124, v124, 0
    v_pk_max_i16 v125, v125, 0
    v_lshlrev_b32 v120, 16, v124
    v_and_b32 v121, 0xffff0000, v124
    v_lshlrev_b32 v122, 16, v125
    v_and_b32 v123, 0xffff0000, v125
    v_pk_mul_f32 v[120:121], v[120:121], v[120:121]
    v_pk_mul_f32 v[122:123], v[122:123], v[122:123]
    v_cvt_pk_bf16_f32 v124, v120, v121
    v_cvt_pk_bf16_f32 v125, v122, v123
    buffer_store_dwordx2 v[124:125], v4, s[52:55], s66 offen offset:1536
    v_accvgpr_read_b32 v128, a60
    v_accvgpr_read_b32 v129, a61
    v_accvgpr_read_b32 v130, a62
    v_accvgpr_read_b32 v131, a63
    v_cvt_pk_bf16_f32 v132, v128, v129
    v_cvt_pk_bf16_f32 v133, v130, v131
    v_lshlrev_b32 v128, 16, v132
    v_and_b32 v129, 0xffff0000, v132
    v_lshlrev_b32 v130, 16, v133
    v_and_b32 v131, 0xffff0000, v133
    v_pk_add_f32 v[128:129], v[128:129], v[156:157]
    v_pk_add_f32 v[130:131], v[130:131], v[158:159]
    v_cvt_pk_bf16_f32 v132, v128, v129
    v_cvt_pk_bf16_f32 v133, v130, v131
    v_pk_max_i16 v132, v132, 0
    v_pk_max_i16 v133, v133, 0
    v_lshlrev_b32 v128, 16, v132
    v_and_b32 v129, 0xffff0000, v132
    v_lshlrev_b32 v130, 16, v133
    v_and_b32 v131, 0xffff0000, v133
    v_pk_mul_f32 v[128:129], v[128:129], v[128:129]
    v_pk_mul_f32 v[130:131], v[130:131], v[130:131]
    v_cvt_pk_bf16_f32 v132, v128, v129
    v_cvt_pk_bf16_f32 v133, v130, v131
    buffer_store_dwordx2 v[132:133], v4, s[52:55], s67 offen offset:1536
    s_branch .end_k3b1_kernel_1
.end_k3b1_kernel_1:
    s_endpgm
.section .rodata,"a"
.p2align 6
.amdhsa_kernel k3b1_kernel
  .amdhsa_next_free_vgpr 248
  .amdhsa_next_free_sgpr 100
  .amdhsa_accum_offset 184
  .amdhsa_group_segment_fixed_size 0
  .amdhsa_kernarg_size 104
  .amdhsa_user_sgpr_count 2
  .amdhsa_user_sgpr_kernarg_segment_ptr 1
  .amdhsa_system_sgpr_workgroup_id_x 1
  .amdhsa_float_denorm_mode_32 3
.end_amdhsa_kernel
.text

.globl k4b2_kernel
.p2align 8
.type k4b2_kernel,@function
k4b2_kernel:
    s_load_dwordx16 s[16:31], s[0:1], 0
    s_load_dwordx8 s[32:39], s[0:1], 64
    s_load_dwordx2 s[40:41], s[0:1], 96
    s_cmp_ge_u32 s2, 256
    s_cbranch_scc1 .end_k4b2_kernel_1
    v_lshrrev_b32 v2, 6, v0
    v_and_b32 v1, 63, v0
    v_readfirstlane_b32 s3, v2
    s_and_b32 s6, s2, 7
    s_lshr_b32 s7, s2, 3
    s_lshr_b32 s4, s7, 3
    s_lshl_b32 s6, s6, 2
    s_add_u32 s4, s4, s6
    s_and_b32 s5, s7, 7
    s_waitcnt lgkmcnt(0)
    s_add_u32 s44, s40, 0x400000
    s_addc_u32 s45, s41, 0
    s_mov_b32 s46, 0x700000
    s_mov_b32 s47, 0x00020000
    s_add_u32 s48, s40, 0x1300000
    s_addc_u32 s49, s41, 0
    s_mov_b32 s50, 0x1c0000
    s_mov_b32 s51, 0x00020000
    s_mov_b32 s56, s34
    s_mov_b32 s57, s35
    s_mov_b32 s58, 0x400
    s_mov_b32 s59, 0x00020000
    s_mul_i32 s6, s3, 0x3800
    s_mul_i32 s7, s4, 0x38000
    s_add_u32 s60, s6, s7
    s_mul_i32 s7, s5, 0x38000
    s_add_u32 s61, s6, s7
    s_add_u32 s64, s40, 0xb00000
    s_addc_u32 s65, s41, 0
    s_mov_b32 s66, 0x200000
    s_mov_b32 s67, 0x00020000
    s_add_u32 s68, s40, 0xd00000
    s_addc_u32 s69, s41, 0
    s_mov_b32 s70, 0x200000
    s_mov_b32 s71, 0x00020000
    v_and_b32 v10, 15, v1
    v_lshrrev_b32 v11, 4, v1
    v_lshlrev_b32 v12, 12, v10
    v_lshl_add_u32 v12, v11, 4, v12
    v_lshlrev_b32 v17, 4, v1
    v_add_u32 v2, 0x0, v17
    v_add_u32 v6, 0x0, v17
    v_add_u32 v3, 0xe000, v17
    v_add_u32 v7, 0xe000, v17
    v_add_u32 v4, 0x1c000, v17
    v_add_u32 v8, 0x1c000, v17
    v_add_u32 v5, 0x2a000, v17
    v_add_u32 v9, 0x2a000, v17
    buffer_load_dwordx4 v[40:43], v2, s[44:47], s60 offen
    buffer_load_dwordx4 v[44:47], v3, s[44:47], s60 offen
    buffer_load_dwordx4 v[48:51], v4, s[44:47], s60 offen
    buffer_load_dwordx4 v[52:55], v5, s[44:47], s60 offen
    buffer_load_dwordx4 v[56:59], v6, s[48:51], s61 offen
    buffer_load_dwordx4 v[60:63], v7, s[48:51], s61 offen
    buffer_load_dwordx4 v[64:67], v8, s[48:51], s61 offen
    buffer_load_dwordx4 v[68:71], v9, s[48:51], s61 offen
    s_add_u32 s60, s60, 0x400
    s_add_u32 s61, s61, 0x400
    buffer_load_dwordx4 v[72:75], v2, s[44:47], s60 offen
    buffer_load_dwordx4 v[76:79], v3, s[44:47], s60 offen
    buffer_load_dwordx4 v[80:83], v4, s[44:47], s60 offen
    buffer_load_dwordx4 v[84:87], v5, s[44:47], s60 offen
    buffer_load_dwordx4 v[88:91], v6, s[48:51], s61 offen
    buffer_load_dwordx4 v[92:95], v7, s[48:51], s61 offen
    buffer_load_dwordx4 v[96:99], v8, s[48:51], s61 offen
    buffer_load_dwordx4 v[100:103], v9, s[48:51], s61 offen
    s_add_u32 s60, s60, 0x400
    s_add_u32 s61, s61, 0x400
    buffer_load_dwordx4 v[104:107], v2, s[44:47], s60 offen
    buffer_load_dwordx4 v[108:111], v3, s[44:47], s60 offen
    buffer_load_dwordx4 v[112:115], v4, s[44:47], s60 offen
    buffer_load_dwordx4 v[116:119], v5, s[44:47], s60 offen
    buffer_load_dwordx4 v[120:123], v6, s[48:51], s61 offen
    buffer_load_dwordx4 v[124:127], v7, s[48:51], s61 offen
    buffer_load_dwordx4 v[128:131], v8, s[48:51], s61 offen
    buffer_load_dwordx4 v[132:135], v9, s[48:51], s61 offen
    s_add_u32 s60, s60, 0x400
    s_add_u32 s61, s61, 0x400
    buffer_load_dwordx4 v[136:139], v2, s[44:47], s60 offen
    buffer_load_dwordx4 v[140:143], v3, s[44:47], s60 offen
    buffer_load_dwordx4 v[144:147], v4, s[44:47], s60 offen
    buffer_load_dwordx4 v[148:151], v5, s[44:47], s60 offen
    buffer_load_dwordx4 v[152:155], v6, s[48:51], s61 offen
    buffer_load_dwordx4 v[156:159], v7, s[48:51], s61 offen
    buffer_load_dwordx4 v[160:163], v8, s[48:51], s61 offen
    buffer_load_dwordx4 v[164:167], v9, s[48:51], s61 offen
    s_add_u32 s60, s60, 0x400
    s_add_u32 s61, s61, 0x400
    buffer_load_dwordx4 v[168:171], v2, s[44:47], s60 offen
    buffer_load_dwordx4 v[172:175], v3, s[44:47], s60 offen
    buffer_load_dwordx4 v[176:179], v4, s[44:47], s60 offen
    buffer_load_dwordx4 v[180:183], v5, s[44:47], s60 offen
    buffer_load_dwordx4 v[184:187], v6, s[48:51], s61 offen
    buffer_load_dwordx4 v[188:191], v7, s[48:51], s61 offen
    buffer_load_dwordx4 v[192:195], v8, s[48:51], s61 offen
    buffer_load_dwordx4 v[196:199], v9, s[48:51], s61 offen
    s_add_u32 s60, s60, 0x400
    s_add_u32 s61, s61, 0x400
    v_lshlrev_b32 v13, 10, v10
    v_lshl_add_u32 v13, v11, 3, v13
    v_mov_b32 v16, v13
    s_lshl_b32 s6, s4, 16
    s_lshl_b32 s7, s3, 14
    s_add_u32 s6, s6, s7
    s_lshl_b32 s7, s5, 7
    s_add_u32 s62, s6, s7
    buffer_load_dwordx2 v[24:25], v16, s[64:67], s62 offen offset:0
    buffer_load_dwordx2 v[26:27], v16, s[64:67], s62 offen offset:32
    buffer_load_dwordx2 v[28:29], v16, s[64:67], s62 offen offset:64
    buffer_load_dwordx2 v[30:31], v16, s[64:67], s62 offen offset:96
    v_lshlrev_b32 v14, 3, v11
    s_lshl_b32 s63, s5, 7
    buffer_load_dwordx2 v[32:33], v14, s[56:59], s63 offen offset:0
    buffer_load_dwordx2 v[34:35], v14, s[56:59], s63 offen offset:32
    buffer_load_dwordx2 v[36:37], v14, s[56:59], s63 offen offset:64
    buffer_load_dwordx2 v[38:39], v14, s[56:59], s63 offen offset:96
    s_waitcnt vmcnt(40)
    v_mfma_f32_16x16x32_bf16 a[0:3], v[56:59], v[40:43], 0
    v_mfma_f32_16x16x32_bf16 a[4:7], v[56:59], v[44:47], 0
    v_mfma_f32_16x16x32_bf16 a[8:11], v[56:59], v[48:51], 0
    v_mfma_f32_16x16x32_bf16 a[12:15], v[56:59], v[52:55], 0
    v_mfma_f32_16x16x32_bf16 a[16:19], v[60:63], v[40:43], 0
    v_mfma_f32_16x16x32_bf16 a[20:23], v[60:63], v[44:47], 0
    v_mfma_f32_16x16x32_bf16 a[24:27], v[60:63], v[48:51], 0
    v_mfma_f32_16x16x32_bf16 a[28:31], v[60:63], v[52:55], 0
    v_mfma_f32_16x16x32_bf16 a[32:35], v[64:67], v[40:43], 0
    v_mfma_f32_16x16x32_bf16 a[36:39], v[64:67], v[44:47], 0
    v_mfma_f32_16x16x32_bf16 a[40:43], v[64:67], v[48:51], 0
    v_mfma_f32_16x16x32_bf16 a[44:47], v[64:67], v[52:55], 0
    v_mfma_f32_16x16x32_bf16 a[48:51], v[68:71], v[40:43], 0
    v_mfma_f32_16x16x32_bf16 a[52:55], v[68:71], v[44:47], 0
    v_mfma_f32_16x16x32_bf16 a[56:59], v[68:71], v[48:51], 0
    v_mfma_f32_16x16x32_bf16 a[60:63], v[68:71], v[52:55], 0
    buffer_load_dwordx4 v[40:43], v2, s[44:47], s60 offen
    buffer_load_dwordx4 v[44:47], v3, s[44:47], s60 offen
    buffer_load_dwordx4 v[48:51], v4, s[44:47], s60 offen
    buffer_load_dwordx4 v[52:55], v5, s[44:47], s60 offen
    buffer_load_dwordx4 v[56:59], v6, s[48:51], s61 offen
    buffer_load_dwordx4 v[60:63], v7, s[48:51], s61 offen
    buffer_load_dwordx4 v[64:67], v8, s[48:51], s61 offen
    buffer_load_dwordx4 v[68:71], v9, s[48:51], s61 offen
    s_add_u32 s60, s60, 0x400
    s_add_u32 s61, s61, 0x400
    s_waitcnt vmcnt(40)
    v_mfma_f32_16x16x32_bf16 a[0:3], v[88:91], v[72:75], a[0:3]
    v_mfma_f32_16x16x32_bf16 a[4:7], v[88:91], v[76:79], a[4:7]
    v_mfma_f32_16x16x32_bf16 a[8:11], v[88:91], v[80:83], a[8:11]
    v_mfma_f32_16x16x32_bf16 a[12:15], v[88:91], v[84:87], a[12:15]
    v_mfma_f32_16x16x32_bf16 a[16:19], v[92:95], v[72:75], a[16:19]
    v_mfma_f32_16x16x32_bf16 a[20:23], v[92:95], v[76:79], a[20:23]
    v_mfma_f32_16x16x32_bf16 a[24:27], v[92:95], v[80:83], a[24:27]
    v_mfma_f32_16x16x32_bf16 a[28:31], v[92:95], v[84:87], a[28:31]
    v_mfma_f32_16x16x32_bf16 a[32:35], v[96:99], v[72:75], a[32:35]
    v_mfma_f32_16x16x32_bf16 a[36:39], v[96:99], v[76:79], a[36:39]
    v_mfma_f32_16x16x32_bf16 a[40:43], v[96:99], v[80:83], a[40:43]
    v_mfma_f32_16x16x32_bf16 a[44:47], v[96:99], v[84:87], a[44:47]
    v_mfma_f32_16x16x32_bf16 a[48:51], v[100:103], v[72:75], a[48:51]
    v_mfma_f32_16x16x32_bf16 a[52:55], v[100:103], v[76:79], a[52:55]
    v_mfma_f32_16x16x32_bf16 a[56:59], v[100:103], v[80:83], a[56:59]
    v_mfma_f32_16x16x32_bf16 a[60:63], v[100:103], v[84:87], a[60:63]
    buffer_load_dwordx4 v[72:75], v2, s[44:47], s60 offen
    buffer_load_dwordx4 v[76:79], v3, s[44:47], s60 offen
    buffer_load_dwordx4 v[80:83], v4, s[44:47], s60 offen
    buffer_load_dwordx4 v[84:87], v5, s[44:47], s60 offen
    buffer_load_dwordx4 v[88:91], v6, s[48:51], s61 offen
    buffer_load_dwordx4 v[92:95], v7, s[48:51], s61 offen
    buffer_load_dwordx4 v[96:99], v8, s[48:51], s61 offen
    buffer_load_dwordx4 v[100:103], v9, s[48:51], s61 offen
    s_add_u32 s60, s60, 0x400
    s_add_u32 s61, s61, 0x400
    s_waitcnt vmcnt(40)
    v_mfma_f32_16x16x32_bf16 a[0:3], v[120:123], v[104:107], a[0:3]
    v_mfma_f32_16x16x32_bf16 a[4:7], v[120:123], v[108:111], a[4:7]
    v_mfma_f32_16x16x32_bf16 a[8:11], v[120:123], v[112:115], a[8:11]
    v_mfma_f32_16x16x32_bf16 a[12:15], v[120:123], v[116:119], a[12:15]
    v_mfma_f32_16x16x32_bf16 a[16:19], v[124:127], v[104:107], a[16:19]
    v_mfma_f32_16x16x32_bf16 a[20:23], v[124:127], v[108:111], a[20:23]
    v_mfma_f32_16x16x32_bf16 a[24:27], v[124:127], v[112:115], a[24:27]
    v_mfma_f32_16x16x32_bf16 a[28:31], v[124:127], v[116:119], a[28:31]
    v_mfma_f32_16x16x32_bf16 a[32:35], v[128:131], v[104:107], a[32:35]
    v_mfma_f32_16x16x32_bf16 a[36:39], v[128:131], v[108:111], a[36:39]
    v_mfma_f32_16x16x32_bf16 a[40:43], v[128:131], v[112:115], a[40:43]
    v_mfma_f32_16x16x32_bf16 a[44:47], v[128:131], v[116:119], a[44:47]
    v_mfma_f32_16x16x32_bf16 a[48:51], v[132:135], v[104:107], a[48:51]
    v_mfma_f32_16x16x32_bf16 a[52:55], v[132:135], v[108:111], a[52:55]
    v_mfma_f32_16x16x32_bf16 a[56:59], v[132:135], v[112:115], a[56:59]
    v_mfma_f32_16x16x32_bf16 a[60:63], v[132:135], v[116:119], a[60:63]
    buffer_load_dwordx4 v[104:107], v2, s[44:47], s60 offen
    buffer_load_dwordx4 v[108:111], v3, s[44:47], s60 offen
    buffer_load_dwordx4 v[112:115], v4, s[44:47], s60 offen
    buffer_load_dwordx4 v[116:119], v5, s[44:47], s60 offen
    buffer_load_dwordx4 v[120:123], v6, s[48:51], s61 offen
    buffer_load_dwordx4 v[124:127], v7, s[48:51], s61 offen
    buffer_load_dwordx4 v[128:131], v8, s[48:51], s61 offen
    buffer_load_dwordx4 v[132:135], v9, s[48:51], s61 offen
    s_add_u32 s60, s60, 0x400
    s_add_u32 s61, s61, 0x400
    s_waitcnt vmcnt(40)
    v_mfma_f32_16x16x32_bf16 a[0:3], v[152:155], v[136:139], a[0:3]
    v_mfma_f32_16x16x32_bf16 a[4:7], v[152:155], v[140:143], a[4:7]
    v_mfma_f32_16x16x32_bf16 a[8:11], v[152:155], v[144:147], a[8:11]
    v_mfma_f32_16x16x32_bf16 a[12:15], v[152:155], v[148:151], a[12:15]
    v_mfma_f32_16x16x32_bf16 a[16:19], v[156:159], v[136:139], a[16:19]
    v_mfma_f32_16x16x32_bf16 a[20:23], v[156:159], v[140:143], a[20:23]
    v_mfma_f32_16x16x32_bf16 a[24:27], v[156:159], v[144:147], a[24:27]
    v_mfma_f32_16x16x32_bf16 a[28:31], v[156:159], v[148:151], a[28:31]
    v_mfma_f32_16x16x32_bf16 a[32:35], v[160:163], v[136:139], a[32:35]
    v_mfma_f32_16x16x32_bf16 a[36:39], v[160:163], v[140:143], a[36:39]
    v_mfma_f32_16x16x32_bf16 a[40:43], v[160:163], v[144:147], a[40:43]
    v_mfma_f32_16x16x32_bf16 a[44:47], v[160:163], v[148:151], a[44:47]
    v_mfma_f32_16x16x32_bf16 a[48:51], v[164:167], v[136:139], a[48:51]
    v_mfma_f32_16x16x32_bf16 a[52:55], v[164:167], v[140:143], a[52:55]
    v_mfma_f32_16x16x32_bf16 a[56:59], v[164:167], v[144:147], a[56:59]
    v_mfma_f32_16x16x32_bf16 a[60:63], v[164:167], v[148:151], a[60:63]
    buffer_load_dwordx4 v[136:139], v2, s[44:47], s60 offen
    buffer_load_dwordx4 v[140:143], v3, s[44:47], s60 offen
    buffer_load_dwordx4 v[144:147], v4, s[44:47], s60 offen
    buffer_load_dwordx4 v[148:151], v5, s[44:47], s60 offen
    buffer_load_dwordx4 v[152:155], v6, s[48:51], s61 offen
    buffer_load_dwordx4 v[156:159], v7, s[48:51], s61 offen
    buffer_load_dwordx4 v[160:163], v8, s[48:51], s61 offen
    buffer_load_dwordx4 v[164:167], v9, s[48:51], s61 offen
    s_add_u32 s60, s60, 0x400
    s_add_u32 s61, s61, 0x400
    s_waitcnt vmcnt(40)
    v_mfma_f32_16x16x32_bf16 a[0:3], v[184:187], v[168:171], a[0:3]
    v_mfma_f32_16x16x32_bf16 a[4:7], v[184:187], v[172:175], a[4:7]
    v_mfma_f32_16x16x32_bf16 a[8:11], v[184:187], v[176:179], a[8:11]
    v_mfma_f32_16x16x32_bf16 a[12:15], v[184:187], v[180:183], a[12:15]
    v_mfma_f32_16x16x32_bf16 a[16:19], v[188:191], v[168:171], a[16:19]
    v_mfma_f32_16x16x32_bf16 a[20:23], v[188:191], v[172:175], a[20:23]
    v_mfma_f32_16x16x32_bf16 a[24:27], v[188:191], v[176:179], a[24:27]
    v_mfma_f32_16x16x32_bf16 a[28:31], v[188:191], v[180:183], a[28:31]
    v_mfma_f32_16x16x32_bf16 a[32:35], v[192:195], v[168:171], a[32:35]
    v_mfma_f32_16x16x32_bf16 a[36:39], v[192:195], v[172:175], a[36:39]
    v_mfma_f32_16x16x32_bf16 a[40:43], v[192:195], v[176:179], a[40:43]
    v_mfma_f32_16x16x32_bf16 a[44:47], v[192:195], v[180:183], a[44:47]
    v_mfma_f32_16x16x32_bf16 a[48:51], v[196:199], v[168:171], a[48:51]
    v_mfma_f32_16x16x32_bf16 a[52:55], v[196:199], v[172:175], a[52:55]
    v_mfma_f32_16x16x32_bf16 a[56:59], v[196:199], v[176:179], a[56:59]
    v_mfma_f32_16x16x32_bf16 a[60:63], v[196:199], v[180:183], a[60:63]
    buffer_load_dwordx4 v[168:171], v2, s[44:47], s60 offen
    buffer_load_dwordx4 v[172:175], v3, s[44:47], s60 offen
    buffer_load_dwordx4 v[176:179], v4, s[44:47], s60 offen
    buffer_load_dwordx4 v[180:183], v5, s[44:47], s60 offen
    buffer_load_dwordx4 v[184:187], v6, s[48:51], s61 offen
    buffer_load_dwordx4 v[188:191], v7, s[48:51], s61 offen
    buffer_load_dwordx4 v[192:195], v8, s[48:51], s61 offen
    buffer_load_dwordx4 v[196:199], v9, s[48:51], s61 offen
    s_add_u32 s60, s60, 0x400
    s_add_u32 s61, s61, 0x400
    s_waitcnt vmcnt(32)
    v_mfma_f32_16x16x32_bf16 a[0:3], v[56:59], v[40:43], a[0:3]
    v_mfma_f32_16x16x32_bf16 a[4:7], v[56:59], v[44:47], a[4:7]
    v_mfma_f32_16x16x32_bf16 a[8:11], v[56:59], v[48:51], a[8:11]
    v_mfma_f32_16x16x32_bf16 a[12:15], v[56:59], v[52:55], a[12:15]
    v_mfma_f32_16x16x32_bf16 a[16:19], v[60:63], v[40:43], a[16:19]
    v_mfma_f32_16x16x32_bf16 a[20:23], v[60:63], v[44:47], a[20:23]
    v_mfma_f32_16x16x32_bf16 a[24:27], v[60:63], v[48:51], a[24:27]
    v_mfma_f32_16x16x32_bf16 a[28:31], v[60:63], v[52:55], a[28:31]
    v_mfma_f32_16x16x32_bf16 a[32:35], v[64:67], v[40:43], a[32:35]
    v_mfma_f32_16x16x32_bf16 a[36:39], v[64:67], v[44:47], a[36:39]
    v_mfma_f32_16x16x32_bf16 a[40:43], v[64:67], v[48:51], a[40:43]
    v_mfma_f32_16x16x32_bf16 a[44:47], v[64:67], v[52:55], a[44:47]
    v_mfma_f32_16x16x32_bf16 a[48:51], v[68:71], v[40:43], a[48:51]
    v_mfma_f32_16x16x32_bf16 a[52:55], v[68:71], v[44:47], a[52:55]
    v_mfma_f32_16x16x32_bf16 a[56:59], v[68:71], v[48:51], a[56:59]
    v_mfma_f32_16x16x32_bf16 a[60:63], v[68:71], v[52:55], a[60:63]
    buffer_load_dwordx4 v[40:43], v2, s[44:47], s60 offen
    buffer_load_dwordx4 v[44:47], v3, s[44:47], s60 offen
    buffer_load_dwordx4 v[48:51], v4, s[44:47], s60 offen
    buffer_load_dwordx4 v[52:55], v5, s[44:47], s60 offen
    buffer_load_dwordx4 v[56:59], v6, s[48:51], s61 offen
    buffer_load_dwordx4 v[60:63], v7, s[48:51], s61 offen
    buffer_load_dwordx4 v[64:67], v8, s[48:51], s61 offen
    buffer_load_dwordx4 v[68:71], v9, s[48:51], s61 offen
    s_add_u32 s60, s60, 0x400
    s_add_u32 s61, s61, 0x400
    s_waitcnt vmcnt(32)
    v_mfma_f32_16x16x32_bf16 a[0:3], v[88:91], v[72:75], a[0:3]
    v_mfma_f32_16x16x32_bf16 a[4:7], v[88:91], v[76:79], a[4:7]
    v_mfma_f32_16x16x32_bf16 a[8:11], v[88:91], v[80:83], a[8:11]
    v_mfma_f32_16x16x32_bf16 a[12:15], v[88:91], v[84:87], a[12:15]
    v_mfma_f32_16x16x32_bf16 a[16:19], v[92:95], v[72:75], a[16:19]
    v_mfma_f32_16x16x32_bf16 a[20:23], v[92:95], v[76:79], a[20:23]
    v_mfma_f32_16x16x32_bf16 a[24:27], v[92:95], v[80:83], a[24:27]
    v_mfma_f32_16x16x32_bf16 a[28:31], v[92:95], v[84:87], a[28:31]
    v_mfma_f32_16x16x32_bf16 a[32:35], v[96:99], v[72:75], a[32:35]
    v_mfma_f32_16x16x32_bf16 a[36:39], v[96:99], v[76:79], a[36:39]
    v_mfma_f32_16x16x32_bf16 a[40:43], v[96:99], v[80:83], a[40:43]
    v_mfma_f32_16x16x32_bf16 a[44:47], v[96:99], v[84:87], a[44:47]
    v_mfma_f32_16x16x32_bf16 a[48:51], v[100:103], v[72:75], a[48:51]
    v_mfma_f32_16x16x32_bf16 a[52:55], v[100:103], v[76:79], a[52:55]
    v_mfma_f32_16x16x32_bf16 a[56:59], v[100:103], v[80:83], a[56:59]
    v_mfma_f32_16x16x32_bf16 a[60:63], v[100:103], v[84:87], a[60:63]
    buffer_load_dwordx4 v[72:75], v2, s[44:47], s60 offen
    buffer_load_dwordx4 v[76:79], v3, s[44:47], s60 offen
    buffer_load_dwordx4 v[80:83], v4, s[44:47], s60 offen
    buffer_load_dwordx4 v[84:87], v5, s[44:47], s60 offen
    buffer_load_dwordx4 v[88:91], v6, s[48:51], s61 offen
    buffer_load_dwordx4 v[92:95], v7, s[48:51], s61 offen
    buffer_load_dwordx4 v[96:99], v8, s[48:51], s61 offen
    buffer_load_dwordx4 v[100:103], v9, s[48:51], s61 offen
    s_add_u32 s60, s60, 0x400
    s_add_u32 s61, s61, 0x400
    s_waitcnt vmcnt(32)
    v_mfma_f32_16x16x32_bf16 a[0:3], v[120:123], v[104:107], a[0:3]
    v_mfma_f32_16x16x32_bf16 a[4:7], v[120:123], v[108:111], a[4:7]
    v_mfma_f32_16x16x32_bf16 a[8:11], v[120:123], v[112:115], a[8:11]
    v_mfma_f32_16x16x32_bf16 a[12:15], v[120:123], v[116:119], a[12:15]
    v_mfma_f32_16x16x32_bf16 a[16:19], v[124:127], v[104:107], a[16:19]
    v_mfma_f32_16x16x32_bf16 a[20:23], v[124:127], v[108:111], a[20:23]
    v_mfma_f32_16x16x32_bf16 a[24:27], v[124:127], v[112:115], a[24:27]
    v_mfma_f32_16x16x32_bf16 a[28:31], v[124:127], v[116:119], a[28:31]
    v_mfma_f32_16x16x32_bf16 a[32:35], v[128:131], v[104:107], a[32:35]
    v_mfma_f32_16x16x32_bf16 a[36:39], v[128:131], v[108:111], a[36:39]
    v_mfma_f32_16x16x32_bf16 a[40:43], v[128:131], v[112:115], a[40:43]
    v_mfma_f32_16x16x32_bf16 a[44:47], v[128:131], v[116:119], a[44:47]
    v_mfma_f32_16x16x32_bf16 a[48:51], v[132:135], v[104:107], a[48:51]
    v_mfma_f32_16x16x32_bf16 a[52:55], v[132:135], v[108:111], a[52:55]
    v_mfma_f32_16x16x32_bf16 a[56:59], v[132:135], v[112:115], a[56:59]
    v_mfma_f32_16x16x32_bf16 a[60:63], v[132:135], v[116:119], a[60:63]
    buffer_load_dwordx4 v[104:107], v2, s[44:47], s60 offen
    buffer_load_dwordx4 v[108:111], v3, s[44:47], s60 offen
    buffer_load_dwordx4 v[112:115], v4, s[44:47], s60 offen
    buffer_load_dwordx4 v[116:119], v5, s[44:47], s60 offen
    buffer_load_dwordx4 v[120:123], v6, s[48:51], s61 offen
    buffer_load_dwordx4 v[124:127], v7, s[48:51], s61 offen
    buffer_load_dwordx4 v[128:131], v8, s[48:51], s61 offen
    buffer_load_dwordx4 v[132:135], v9, s[48:51], s61 offen
    s_add_u32 s60, s60, 0x400
    s_add_u32 s61, s61, 0x400
    s_waitcnt vmcnt(32)
    v_mfma_f32_16x16x32_bf16 a[0:3], v[152:155], v[136:139], a[0:3]
    v_mfma_f32_16x16x32_bf16 a[4:7], v[152:155], v[140:143], a[4:7]
    v_mfma_f32_16x16x32_bf16 a[8:11], v[152:155], v[144:147], a[8:11]
    v_mfma_f32_16x16x32_bf16 a[12:15], v[152:155], v[148:151], a[12:15]
    v_mfma_f32_16x16x32_bf16 a[16:19], v[156:159], v[136:139], a[16:19]
    v_mfma_f32_16x16x32_bf16 a[20:23], v[156:159], v[140:143], a[20:23]
    v_mfma_f32_16x16x32_bf16 a[24:27], v[156:159], v[144:147], a[24:27]
    v_mfma_f32_16x16x32_bf16 a[28:31], v[156:159], v[148:151], a[28:31]
    v_mfma_f32_16x16x32_bf16 a[32:35], v[160:163], v[136:139], a[32:35]
    v_mfma_f32_16x16x32_bf16 a[36:39], v[160:163], v[140:143], a[36:39]
    v_mfma_f32_16x16x32_bf16 a[40:43], v[160:163], v[144:147], a[40:43]
    v_mfma_f32_16x16x32_bf16 a[44:47], v[160:163], v[148:151], a[44:47]
    v_mfma_f32_16x16x32_bf16 a[48:51], v[164:167], v[136:139], a[48:51]
    v_mfma_f32_16x16x32_bf16 a[52:55], v[164:167], v[140:143], a[52:55]
    v_mfma_f32_16x16x32_bf16 a[56:59], v[164:167], v[144:147], a[56:59]
    v_mfma_f32_16x16x32_bf16 a[60:63], v[164:167], v[148:151], a[60:63]
    buffer_load_dwordx4 v[136:139], v2, s[44:47], s60 offen
    buffer_load_dwordx4 v[140:143], v3, s[44:47], s60 offen
    buffer_load_dwordx4 v[144:147], v4, s[44:47], s60 offen
    buffer_load_dwordx4 v[148:151], v5, s[44:47], s60 offen
    buffer_load_dwordx4 v[152:155], v6, s[48:51], s61 offen
    buffer_load_dwordx4 v[156:159], v7, s[48:51], s61 offen
    buffer_load_dwordx4 v[160:163], v8, s[48:51], s61 offen
    buffer_load_dwordx4 v[164:167], v9, s[48:51], s61 offen
    s_add_u32 s60, s60, 0x400
    s_add_u32 s61, s61, 0x400
    s_waitcnt vmcnt(32)
    v_mfma_f32_16x16x32_bf16 a[0:3], v[184:187], v[168:171], a[0:3]
    v_mfma_f32_16x16x32_bf16 a[4:7], v[184:187], v[172:175], a[4:7]
    v_mfma_f32_16x16x32_bf16 a[8:11], v[184:187], v[176:179], a[8:11]
    v_mfma_f32_16x16x32_bf16 a[12:15], v[184:187], v[180:183], a[12:15]
    v_mfma_f32_16x16x32_bf16 a[16:19], v[188:191], v[168:171], a[16:19]
    v_mfma_f32_16x16x32_bf16 a[20:23], v[188:191], v[172:175], a[20:23]
    v_mfma_f32_16x16x32_bf16 a[24:27], v[188:191], v[176:179], a[24:27]
    v_mfma_f32_16x16x32_bf16 a[28:31], v[188:191], v[180:183], a[28:31]
    v_mfma_f32_16x16x32_bf16 a[32:35], v[192:195], v[168:171], a[32:35]
    v_mfma_f32_16x16x32_bf16 a[36:39], v[192:195], v[172:175], a[36:39]
    v_mfma_f32_16x16x32_bf16 a[40:43], v[192:195], v[176:179], a[40:43]
    v_mfma_f32_16x16x32_bf16 a[44:47], v[192:195], v[180:183], a[44:47]
    v_mfma_f32_16x16x32_bf16 a[48:51], v[196:199], v[168:171], a[48:51]
    v_mfma_f32_16x16x32_bf16 a[52:55], v[196:199], v[172:175], a[52:55]
    v_mfma_f32_16x16x32_bf16 a[56:59], v[196:199], v[176:179], a[56:59]
    v_mfma_f32_16x16x32_bf16 a[60:63], v[196:199], v[180:183], a[60:63]
    s_waitcnt vmcnt(24)
    v_mfma_f32_16x16x32_bf16 a[0:3], v[56:59], v[40:43], a[0:3]
    v_mfma_f32_16x16x32_bf16 a[4:7], v[56:59], v[44:47], a[4:7]
    v_mfma_f32_16x16x32_bf16 a[8:11], v[56:59], v[48:51], a[8:11]
    v_mfma_f32_16x16x32_bf16 a[12:15], v[56:59], v[52:55], a[12:15]
    v_mfma_f32_16x16x32_bf16 a[16:19], v[60:63], v[40:43], a[16:19]
    v_mfma_f32_16x16x32_bf16 a[20:23], v[60:63], v[44:47], a[20:23]
    v_mfma_f32_16x16x32_bf16 a[24:27], v[60:63], v[48:51], a[24:27]
    v_mfma_f32_16x16x32_bf16 a[28:31], v[60:63], v[52:55], a[28:31]
    v_mfma_f32_16x16x32_bf16 a[32:35], v[64:67], v[40:43], a[32:35]
    v_mfma_f32_16x16x32_bf16 a[36:39], v[64:67], v[44:47], a[36:39]
    v_mfma_f32_16x16x32_bf16 a[40:43], v[64:67], v[48:51], a[40:43]
    v_mfma_f32_16x16x32_bf16 a[44:47], v[64:67], v[52:55], a[44:47]
    v_mfma_f32_16x16x32_bf16 a[48:51], v[68:71], v[40:43], a[48:51]
    v_mfma_f32_16x16x32_bf16 a[52:55], v[68:71], v[44:47], a[52:55]
    v_mfma_f32_16x16x32_bf16 a[56:59], v[68:71], v[48:51], a[56:59]
    v_mfma_f32_16x16x32_bf16 a[60:63], v[68:71], v[52:55], a[60:63]
    s_waitcnt vmcnt(16)
    v_mfma_f32_16x16x32_bf16 a[0:3], v[88:91], v[72:75], a[0:3]
    v_mfma_f32_16x16x32_bf16 a[4:7], v[88:91], v[76:79], a[4:7]
    v_mfma_f32_16x16x32_bf16 a[8:11], v[88:91], v[80:83], a[8:11]
    v_mfma_f32_16x16x32_bf16 a[12:15], v[88:91], v[84:87], a[12:15]
    v_mfma_f32_16x16x32_bf16 a[16:19], v[92:95], v[72:75], a[16:19]
    v_mfma_f32_16x16x32_bf16 a[20:23], v[92:95], v[76:79], a[20:23]
    v_mfma_f32_16x16x32_bf16 a[24:27], v[92:95], v[80:83], a[24:27]
    v_mfma_f32_16x16x32_bf16 a[28:31], v[92:95], v[84:87], a[28:31]
    v_mfma_f32_16x16x32_bf16 a[32:35], v[96:99], v[72:75], a[32:35]
    v_mfma_f32_16x16x32_bf16 a[36:39], v[96:99], v[76:79], a[36:39]
    v_mfma_f32_16x16x32_bf16 a[40:43], v[96:99], v[80:83], a[40:43]
    v_mfma_f32_16x16x32_bf16 a[44:47], v[96:99], v[84:87], a[44:47]
    v_mfma_f32_16x16x32_bf16 a[48:51], v[100:103], v[72:75], a[48:51]
    v_mfma_f32_16x16x32_bf16 a[52:55], v[100:103], v[76:79], a[52:55]
    v_mfma_f32_16x16x32_bf16 a[56:59], v[100:103], v[80:83], a[56:59]
    v_mfma_f32_16x16x32_bf16 a[60:63], v[100:103], v[84:87], a[60:63]
    s_waitcnt vmcnt(8)
    v_mfma_f32_16x16x32_bf16 a[0:3], v[120:123], v[104:107], a[0:3]
    v_mfma_f32_16x16x32_bf16 a[4:7], v[120:123], v[108:111], a[4:7]
    v_mfma_f32_16x16x32_bf16 a[8:11], v[120:123], v[112:115], a[8:11]
    v_mfma_f32_16x16x32_bf16 a[12:15], v[120:123], v[116:119], a[12:15]
    v_mfma_f32_16x16x32_bf16 a[16:19], v[124:127], v[104:107], a[16:19]
    v_mfma_f32_16x16x32_bf16 a[20:23], v[124:127], v[108:111], a[20:23]
    v_mfma_f32_16x16x32_bf16 a[24:27], v[124:127], v[112:115], a[24:27]
    v_mfma_f32_16x16x32_bf16 a[28:31], v[124:127], v[116:119], a[28:31]
    v_mfma_f32_16x16x32_bf16 a[32:35], v[128:131], v[104:107], a[32:35]
    v_mfma_f32_16x16x32_bf16 a[36:39], v[128:131], v[108:111], a[36:39]
    v_mfma_f32_16x16x32_bf16 a[40:43], v[128:131], v[112:115], a[40:43]
    v_mfma_f32_16x16x32_bf16 a[44:47], v[128:131], v[116:119], a[44:47]
    v_mfma_f32_16x16x32_bf16 a[48:51], v[132:135], v[104:107], a[48:51]
    v_mfma_f32_16x16x32_bf16 a[52:55], v[132:135], v[108:111], a[52:55]
    v_mfma_f32_16x16x32_bf16 a[56:59], v[132:135], v[112:115], a[56:59]
    v_mfma_f32_16x16x32_bf16 a[60:63], v[132:135], v[116:119], a[60:63]
    s_waitcnt vmcnt(0)
    v_mfma_f32_16x16x32_bf16 a[0:3], v[152:155], v[136:139], a[0:3]
    v_mfma_f32_16x16x32_bf16 a[4:7], v[152:155], v[140:143], a[4:7]
    v_mfma_f32_16x16x32_bf16 a[8:11], v[152:155], v[144:147], a[8:11]
    v_mfma_f32_16x16x32_bf16 a[12:15], v[152:155], v[148:151], a[12:15]
    v_mfma_f32_16x16x32_bf16 a[16:19], v[156:159], v[136:139], a[16:19]
    v_mfma_f32_16x16x32_bf16 a[20:23], v[156:159], v[140:143], a[20:23]
    v_mfma_f32_16x16x32_bf16 a[24:27], v[156:159], v[144:147], a[24:27]
    v_mfma_f32_16x16x32_bf16 a[28:31], v[156:159], v[148:151], a[28:31]
    v_mfma_f32_16x16x32_bf16 a[32:35], v[160:163], v[136:139], a[32:35]
    v_mfma_f32_16x16x32_bf16 a[36:39], v[160:163], v[140:143], a[36:39]
    v_mfma_f32_16x16x32_bf16 a[40:43], v[160:163], v[144:147], a[40:43]
    v_mfma_f32_16x16x32_bf16 a[44:47], v[160:163], v[148:151], a[44:47]
    v_mfma_f32_16x16x32_bf16 a[48:51], v[164:167], v[136:139], a[48:51]
    v_mfma_f32_16x16x32_bf16 a[52:55], v[164:167], v[140:143], a[52:55]
    v_mfma_f32_16x16x32_bf16 a[56:59], v[164:167], v[144:147], a[56:59]
    v_mfma_f32_16x16x32_bf16 a[60:63], v[164:167], v[148:151], a[60:63]
    v_lshlrev_b32 v13, 4, v1
    s_lshl_b32 s6, s3, 12
    v_add_u32 v14, s6, v13
    s_lshl_b32 s7, s3, 14
    v_add_u32 v15, s7, v13
    s_nop 7
    s_nop 3
    ds_write_b128 v14, a[0:3] offset:0
    ds_write_b128 v14, a[16:19] offset:1024
    ds_write_b128 v14, a[32:35] offset:2048
    ds_write_b128 v14, a[48:51] offset:3072
    ds_write_b128 v14, a[4:7] offset:16384
    ds_write_b128 v14, a[20:23] offset:17408
    ds_write_b128 v14, a[36:39] offset:18432
    ds_write_b128 v14, a[52:55] offset:19456
    ds_write_b128 v14, a[8:11] offset:32768
    ds_write_b128 v14, a[24:27] offset:33792
    ds_write_b128 v14, a[40:43] offset:34816
    ds_write_b128 v14, a[56:59] offset:35840
    ds_write_b128 v14, a[12:15] offset:49152
    ds_write_b128 v14, a[28:31] offset:50176
    ds_write_b128 v14, a[44:47] offset:51200
    ds_write_b128 v14, a[60:63] offset:52224
    s_waitcnt lgkmcnt(0)
    s_barrier
    ds_read_b128 v[40:43], v15 offset:0
    ds_read_b128 v[44:47], v15 offset:1024
    ds_read_b128 v[48:51], v15 offset:2048
    ds_read_b128 v[52:55], v15 offset:3072
    ds_read_b128 v[56:59], v15 offset:4096
    ds_read_b128 v[60:63], v15 offset:5120
    ds_read_b128 v[64:67], v15 offset:6144
    ds_read_b128 v[68:71], v15 offset:7168
    ds_read_b128 v[72:75], v15 offset:8192
    ds_read_b128 v[76:79], v15 offset:9216
    ds_read_b128 v[80:83], v15 offset:10240
    ds_read_b128 v[84:87], v15 offset:11264
    ds_read_b128 v[88:91], v15 offset:12288
    ds_read_b128 v[92:95], v15 offset:13312
    ds_read_b128 v[96:99], v15 offset:14336
    ds_read_b128 v[100:103], v15 offset:15360
    s_waitcnt lgkmcnt(3)
    v_add_f32 v40, v40, v56
    v_add_f32 v72, v72, v88
    v_add_f32 v41, v41, v57
    v_add_f32 v73, v73, v89
    v_add_f32 v42, v42, v58
    v_add_f32 v74, v74, v90
    v_add_f32 v43, v43, v59
    v_add_f32 v75, v75, v91
    v_add_f32 v40, v40, v72
    v_add_f32 v41, v41, v73
    v_add_f32 v42, v42, v74
    v_add_f32 v43, v43, v75
    v_cvt_pk_bf16_f32 v104, v40, v41
    v_cvt_pk_bf16_f32 v105, v42, v43
    v_lshlrev_b32 v40, 16, v104
    v_and_b32 v41, 0xffff0000, v104
    v_lshlrev_b32 v42, 16, v105
    v_and_b32 v43, 0xffff0000, v105
    v_lshlrev_b32 v72, 16, v32
    v_and_b32 v73, 0xffff0000, v32
    v_lshlrev_b32 v74, 16, v33
    v_and_b32 v75, 0xffff0000, v33
    v_add_f32 v40, v40, v72
    v_add_f32 v41, v41, v73
    v_add_f32 v42, v42, v74
    v_add_f32 v43, v43, v75
    v_cvt_pk_bf16_f32 v104, v40, v41
    v_cvt_pk_bf16_f32 v105, v42, v43
    v_lshlrev_b32 v40, 16, v104
    v_and_b32 v41, 0xffff0000, v104
    v_lshlrev_b32 v42, 16, v105
    v_and_b32 v43, 0xffff0000, v105
    v_lshlrev_b32 v72, 16, v24
    v_and_b32 v73, 0xffff0000, v24
    v_lshlrev_b32 v74, 16, v25
    v_and_b32 v75, 0xffff0000, v25
    v_add_f32 v40, v40, v72
    v_add_f32 v41, v41, v73
    v_add_f32 v42, v42, v74
    v_add_f32 v43, v43, v75
    v_cvt_pk_bf16_f32 v108, v40, v41
    v_cvt_pk_bf16_f32 v109, v42, v43
    buffer_store_dwordx2 v[108:109], v16, s[68:71], s62 offen offset:0
    s_waitcnt lgkmcnt(2)
    v_add_f32 v44, v44, v60
    v_add_f32 v76, v76, v92
    v_add_f32 v45, v45, v61
    v_add_f32 v77, v77, v93
    v_add_f32 v46, v46, v62
    v_add_f32 v78, v78, v94
    v_add_f32 v47, v47, v63
    v_add_f32 v79, v79, v95
    v_add_f32 v44, v44, v76
    v_add_f32 v45, v45, v77
    v_add_f32 v46, v46, v78
    v_add_f32 v47, v47, v79
    v_cvt_pk_bf16_f32 v104, v44, v45
    v_cvt_pk_bf16_f32 v105, v46, v47
    v_lshlrev_b32 v44, 16, v104
    v_and_b32 v45, 0xffff0000, v104
    v_lshlrev_b32 v46, 16, v105
    v_and_b32 v47, 0xffff0000, v105
    v_lshlrev_b32 v76, 16, v34
    v_and_b32 v77, 0xffff0000, v34
    v_lshlrev_b32 v78, 16, v35
    v_and_b32 v79, 0xffff0000, v35
    v_add_f32 v44, v44, v76
    v_add_f32 v45, v45, v77
    v_add_f32 v46, v46, v78
    v_add_f32 v47, v47, v79
    v_cvt_pk_bf16_f32 v104, v44, v45
    v_cvt_pk_bf16_f32 v105, v46, v47
    v_lshlrev_b32 v44, 16, v104
    v_and_b32 v45, 0xffff0000, v104
    v_lshlrev_b32 v46, 16, v105
    v_and_b32 v47, 0xffff0000, v105
    v_lshlrev_b32 v76, 16, v26
    v_and_b32 v77, 0xffff0000, v26
    v_lshlrev_b32 v78, 16, v27
    v_and_b32 v79, 0xffff0000, v27
    v_add_f32 v44, v44, v76
    v_add_f32 v45, v45, v77
    v_add_f32 v46, v46, v78
    v_add_f32 v47, v47, v79
    v_cvt_pk_bf16_f32 v110, v44, v45
    v_cvt_pk_bf16_f32 v111, v46, v47
    buffer_store_dwordx2 v[110:111], v16, s[68:71], s62 offen offset:32
    s_waitcnt lgkmcnt(1)
    v_add_f32 v48, v48, v64
    v_add_f32 v80, v80, v96
    v_add_f32 v49, v49, v65
    v_add_f32 v81, v81, v97
    v_add_f32 v50, v50, v66
    v_add_f32 v82, v82, v98
    v_add_f32 v51, v51, v67
    v_add_f32 v83, v83, v99
    v_add_f32 v48, v48, v80
    v_add_f32 v49, v49, v81
    v_add_f32 v50, v50, v82
    v_add_f32 v51, v51, v83
    v_cvt_pk_bf16_f32 v104, v48, v49
    v_cvt_pk_bf16_f32 v105, v50, v51
    v_lshlrev_b32 v48, 16, v104
    v_and_b32 v49, 0xffff0000, v104
    v_lshlrev_b32 v50, 16, v105
    v_and_b32 v51, 0xffff0000, v105
    v_lshlrev_b32 v80, 16, v36
    v_and_b32 v81, 0xffff0000, v36
    v_lshlrev_b32 v82, 16, v37
    v_and_b32 v83, 0xffff0000, v37
    v_add_f32 v48, v48, v80
    v_add_f32 v49, v49, v81
    v_add_f32 v50, v50, v82
    v_add_f32 v51, v51, v83
    v_cvt_pk_bf16_f32 v104, v48, v49
    v_cvt_pk_bf16_f32 v105, v50, v51
    v_lshlrev_b32 v48, 16, v104
    v_and_b32 v49, 0xffff0000, v104
    v_lshlrev_b32 v50, 16, v105
    v_and_b32 v51, 0xffff0000, v105
    v_lshlrev_b32 v80, 16, v28
    v_and_b32 v81, 0xffff0000, v28
    v_lshlrev_b32 v82, 16, v29
    v_and_b32 v83, 0xffff0000, v29
    v_add_f32 v48, v48, v80
    v_add_f32 v49, v49, v81
    v_add_f32 v50, v50, v82
    v_add_f32 v51, v51, v83
    v_cvt_pk_bf16_f32 v108, v48, v49
    v_cvt_pk_bf16_f32 v109, v50, v51
    buffer_store_dwordx2 v[108:109], v16, s[68:71], s62 offen offset:64
    s_waitcnt lgkmcnt(0)
    v_add_f32 v52, v52, v68
    v_add_f32 v84, v84, v100
    v_add_f32 v53, v53, v69
    v_add_f32 v85, v85, v101
    v_add_f32 v54, v54, v70
    v_add_f32 v86, v86, v102
    v_add_f32 v55, v55, v71
    v_add_f32 v87, v87, v103
    v_add_f32 v52, v52, v84
    v_add_f32 v53, v53, v85
    v_add_f32 v54, v54, v86
    v_add_f32 v55, v55, v87
    v_cvt_pk_bf16_f32 v104, v52, v53
    v_cvt_pk_bf16_f32 v105, v54, v55
    v_lshlrev_b32 v52, 16, v104
    v_and_b32 v53, 0xffff0000, v104
    v_lshlrev_b32 v54, 16, v105
    v_and_b32 v55, 0xffff0000, v105
    v_lshlrev_b32 v84, 16, v38
    v_and_b32 v85, 0xffff0000, v38
    v_lshlrev_b32 v86, 16, v39
    v_and_b32 v87, 0xffff0000, v39
    v_add_f32 v52, v52, v84
    v_add_f32 v53, v53, v85
    v_add_f32 v54, v54, v86
    v_add_f32 v55, v55, v87
    v_cvt_pk_bf16_f32 v104, v52, v53
    v_cvt_pk_bf16_f32 v105, v54, v55
    v_lshlrev_b32 v52, 16, v104
    v_and_b32 v53, 0xffff0000, v104
    v_lshlrev_b32 v54, 16, v105
    v_and_b32 v55, 0xffff0000, v105
    v_lshlrev_b32 v84, 16, v30
    v_and_b32 v85, 0xffff0000, v30
    v_lshlrev_b32 v86, 16, v31
    v_and_b32 v87, 0xffff0000, v31
    v_add_f32 v52, v52, v84
    v_add_f32 v53, v53, v85
    v_add_f32 v54, v54, v86
    v_add_f32 v55, v55, v87
    v_cvt_pk_bf16_f32 v110, v52, v53
    v_cvt_pk_bf16_f32 v111, v54, v55
    buffer_store_dwordx2 v[110:111], v16, s[68:71], s62 offen offset:96
.end_k4b2_kernel_1:
    s_endpgm
.section .rodata,"a"
.p2align 6
.amdhsa_kernel k4b2_kernel
  .amdhsa_next_free_vgpr 264
  .amdhsa_next_free_sgpr 100
  .amdhsa_accum_offset 200
  .amdhsa_group_segment_fixed_size 0
  .amdhsa_kernarg_size 104
  .amdhsa_user_sgpr_count 2
  .amdhsa_user_sgpr_kernarg_segment_ptr 1
  .amdhsa_system_sgpr_workgroup_id_x 1
  .amdhsa_float_denorm_mode_32 3
.end_amdhsa_kernel
.text

.globl k5a1_kernel
.p2align 8
.type k5a1_kernel,@function
k5a1_kernel:
    s_load_dwordx16 s[16:31], s[0:1], 0
    s_load_dwordx8 s[32:39], s[0:1], 64
    s_load_dwordx2 s[40:41], s[0:1], 96
    s_cmp_ge_u32 s2, 256
    s_cbranch_scc1 .end_k5a1_kernel_1
    v_lshrrev_b32 v2, 6, v0
    v_and_b32 v1, 63, v0
    v_readfirstlane_b32 s3, v2
    s_and_b32 s5, s2, 7
    s_lshr_b32 s4, s2, 3
    v_lshrrev_b32 v2, 3, v1
    v_and_b32 v3, 7, v1
    v_lshlrev_b32 v4, 10, v2
    v_lshl_add_u32 v4, v3, 4, v4
    s_lshl_b32 s6, s3, 13
    v_add_u32 v22, s6, v4
    s_lshl_b32 s60, s4, 16
    s_waitcnt lgkmcnt(0)
    s_add_u32 s44, s40, 0xd00000
    s_addc_u32 s45, s41, 0
    s_mov_b32 s46, 0x200000
    s_mov_b32 s47, 0x00020000
    buffer_load_dwordx4 v[88:91], v22, s[44:47], s60 offen offset:0
    buffer_load_dwordx4 v[92:95], v22, s[44:47], s60 offen offset:128
    buffer_load_dwordx4 v[96:99], v22, s[44:47], s60 offen offset:256
    buffer_load_dwordx4 v[100:103], v22, s[44:47], s60 offen offset:384
    buffer_load_dwordx4 v[104:107], v22, s[44:47], s60 offen offset:512
    buffer_load_dwordx4 v[108:111], v22, s[44:47], s60 offen offset:640
    buffer_load_dwordx4 v[112:115], v22, s[44:47], s60 offen offset:768
    buffer_load_dwordx4 v[116:119], v22, s[44:47], s60 offen offset:896
    s_cmp_ge_u32 s3, 4
    s_cbranch_scc1 .skipb_k5a1_kernel_2
    v_and_b32 v5, 15, v1
    v_lshrrev_b32 v6, 4, v1
    s_cmp_lt_u32 s5, 4
    s_cselect_b32 s48, s22, s24
    s_cselect_b32 s49, s23, s25
    s_mov_b32 s50, 0x80000
    s_mov_b32 s51, 0x00020000
    s_mov_b32 s52, s40
    s_mov_b32 s53, s41
    s_mov_b32 s54, 0x400000
    s_mov_b32 s55, 0x00020000
    s_and_b32 s6, s5, 3
    s_lshl_b32 s6, s6, 7
    s_lshl_b32 s7, s3, 5
    s_add_u32 s6, s6, s7
    s_lshl_b32 s61, s6, 10
    v_xor_b32 v7, v3, v6
    v_lshl_add_u32 v8, v7, 4, v4
    v_lshlrev_b32 v8, 10, v2
    v_lshl_add_u32 v9, v7, 4, v8
    v_xor_b32 v7, 4, v7
    v_lshl_add_u32 v8, v7, 4, v8
    v_add_u32 v10, 0x0, v9
    v_add_u32 v11, 0x2000, v8
    v_add_u32 v12, 0x4000, v9
    v_add_u32 v13, 0x6000, v8
    s_lshl_b32 s72, s3, 14
    s_add_u32 s72, s72, 0x10000
    v_lshrrev_b32 v7, 1, v5
    v_xor_b32 v7, v7, v6
    v_lshlrev_b32 v7, 4, v7
    v_and_b32 v8, 7, v5
    v_lshl_add_u32 v7, v8, 7, v7
    v_lshrrev_b32 v8, 3, v5
    v_lshl_add_u32 v7, v8, 10, v7
    v_add_u32 v14, s72, v7
    v_xor_b32 v15, 64, v14
    v_add_u32 v7, 0, v6
    v_xor_b32 v7, v7, v5
    v_lshlrev_b32 v7, 4, v7
    v_lshl_add_u32 v16, v5, 10, v7
    v_add_u32 v7, 4, v6
    v_xor_b32 v7, v7, v5
    v_lshlrev_b32 v7, 4, v7
    v_lshl_add_u32 v17, v5, 10, v7
    v_add_u32 v7, 8, v6
    v_xor_b32 v7, v7, v5
    v_lshlrev_b32 v7, 4, v7
    v_lshl_add_u32 v18, v5, 10, v7
    v_add_u32 v7, 12, v6
    v_xor_b32 v7, v7, v5
    v_lshlrev_b32 v7, 4, v7
    v_lshl_add_u32 v19, v5, 10, v7
.skipb_k5a1_kernel_2:
    v_xor_b32 v7, v3, v2
    v_lshlrev_b32 v7, 4, v7
    v_lshl_add_u32 v7, v2, 10, v7
    s_and_b32 s7, s3, 1
    s_lshl_b32 s7, s7, 7
    s_lshl_b32 s6, s3, 13
    s_add_u32 s8, s6, s7
    s_sub_u32 s9, s6, s7
    v_add_u32 v20, s8, v7
    v_add_u32 v21, s9, v7
    s_mov_b32 s8, 0x3f803f80
    v_mov_b32 v24, 0
    v_mov_b32 v25, 0
    v_mov_b32 v26, 0
    v_mov_b32 v27, 0
    s_waitcnt vmcnt(7)
    v_dot2c_f32_bf16 v24, s8, v88
    v_dot2c_f32_bf16 v25, s8, v89
    v_dot2c_f32_bf16 v26, s8, v90
    v_dot2c_f32_bf16 v27, s8, v91
    s_waitcnt vmcnt(6)
    v_dot2c_f32_bf16 v24, s8, v92
    v_dot2c_f32_bf16 v25, s8, v93
    v_dot2c_f32_bf16 v26, s8, v94
    v_dot2c_f32_bf16 v27, s8, v95
    s_waitcnt vmcnt(5)
    v_dot2c_f32_bf16 v24, s8, v96
    v_dot2c_f32_bf16 v25, s8, v97
    v_dot2c_f32_bf16 v26, s8, v98
    v_dot2c_f32_bf16 v27, s8, v99
    s_waitcnt vmcnt(4)
    v_dot2c_f32_bf16 v24, s8, v100
    v_dot2c_f32_bf16 v25, s8, v101
    v_dot2c_f32_bf16 v26, s8, v102
    v_dot2c_f32_bf16 v27, s8, v103
    s_waitcnt vmcnt(3)
    v_dot2c_f32_bf16 v24, s8, v104
    v_dot2c_f32_bf16 v25, s8, v105
    v_dot2c_f32_bf16 v26, s8, v106
    v_dot2c_f32_bf16 v27, s8, v107
    s_waitcnt vmcnt(2)
    v_dot2c_f32_bf16 v24, s8, v108
    v_dot2c_f32_bf16 v25, s8, v109
    v_dot2c_f32_bf16 v26, s8, v110
    v_dot2c_f32_bf16 v27, s8, v111
    s_waitcnt vmcnt(1)
    v_dot2c_f32_bf16 v24, s8, v112
    v_dot2c_f32_bf16 v25, s8, v113
    v_dot2c_f32_bf16 v26, s8, v114
    v_dot2c_f32_bf16 v27, s8, v115
    s_waitcnt vmcnt(0)
    v_dot2c_f32_bf16 v24, s8, v116
    v_dot2c_f32_bf16 v25, s8, v117
    v_dot2c_f32_bf16 v26, s8, v118
    v_dot2c_f32_bf16 v27, s8, v119
    s_nop 2
    s_cmp_ge_u32 s3, 4
    s_cbranch_scc1 .skip2_k5a1_kernel_3
    s_add_u32 m0, s72, 0x0
    s_nop 0
    buffer_load_dwordx4 v10, s[48:51], s61 offen lds
    s_add_u32 m0, s72, 0x400
    s_nop 0
    buffer_load_dwordx4 v11, s[48:51], s61 offen lds
    s_add_u32 m0, s72, 0x800
    s_nop 0
    buffer_load_dwordx4 v12, s[48:51], s61 offen lds
    s_add_u32 m0, s72, 0xc00
    s_nop 0
    buffer_load_dwordx4 v13, s[48:51], s61 offen lds
    s_add_u32 s61, s61, 0x80
    s_add_u32 m0, s72, 0x1000
    s_nop 0
    buffer_load_dwordx4 v10, s[48:51], s61 offen lds
    s_add_u32 m0, s72, 0x1400
    s_nop 0
    buffer_load_dwordx4 v11, s[48:51], s61 offen lds
    s_add_u32 m0, s72, 0x1800
    s_nop 0
    buffer_load_dwordx4 v12, s[48:51], s61 offen lds
    s_add_u32 m0, s72, 0x1c00
    s_nop 0
    buffer_load_dwordx4 v13, s[48:51], s61 offen lds
    s_add_u32 s61, s61, 0x80
    s_add_u32 m0, s72, 0x2000
    s_nop 0
    buffer_load_dwordx4 v10, s[48:51], s61 offen lds
    s_add_u32 m0, s72, 0x2400
    s_nop 0
    buffer_load_dwordx4 v11, s[48:51], s61 offen lds
    s_add_u32 m0, s72, 0x2800
    s_nop 0
    buffer_load_dwordx4 v12, s[48:51], s61 offen lds
    s_add_u32 m0, s72, 0x2c00
    s_nop 0
    buffer_load_dwordx4 v13, s[48:51], s61 offen lds
    s_add_u32 s61, s61, 0x80
    s_add_u32 m0, s72, 0x3000
    s_nop 0
    buffer_load_dwordx4 v10, s[48:51], s61 offen lds
    s_add_u32 m0, s72, 0x3400
    s_nop 0
    buffer_load_dwordx4 v11, s[48:51], s61 offen lds
    s_add_u32 m0, s72, 0x3800
    s_nop 0
    buffer_load_dwordx4 v12, s[48:51], s61 offen lds
    s_add_u32 m0, s72, 0x3c00
    s_nop 0
    buffer_load_dwordx4 v13, s[48:51], s61 offen lds
    s_add_u32 s61, s61, 0x80
.skip2_k5a1_kernel_3:
    v_add_f32 v24, v24, v25
    v_add_f32 v26, v26, v27
    v_add_f32 v24, v24, v26
    s_nop 1
    v_add_f32_dpp v25, v24, v24 quad_perm:[1,0,3,2] row_mask:0xf bank_mask:0xf
    s_nop 1
    v_add_f32_dpp v24, v25, v25 quad_perm:[2,3,0,1] row_mask:0xf bank_mask:0xf
    s_nop 1
    v_add_f32_dpp v25, v24, v24 row_half_mirror row_mask:0xf bank_mask:0xf
    v_mov_b32 v24, v25
    v_mul_f32 v28, 0x3b000000, v24
    v_sub_f32 v30, 0, v28
    v_sub_f32 v31, 0, v28
    v_mov_b32 v32, 0
    v_mov_b32 v33, 0
    v_mov_b32 v34, 0
    v_mov_b32 v35, 0
    v_lshlrev_b32 v120, 16, v88
    v_and_b32 v121, 0xffff0000, v88
    v_pk_add_f32 v[120:121], v[120:121], v[30:31]
    v_pk_fma_f32 v[32:33], v[120:121], v[120:121], v[32:33]
    v_lshlrev_b32 v122, 16, v89
    v_and_b32 v123, 0xffff0000, v89
    v_pk_add_f32 v[122:123], v[122:123], v[30:31]
    v_pk_fma_f32 v[34:35], v[122:123], v[122:123], v[34:35]
    v_lshlrev_b32 v124, 16, v90
    v_and_b32 v125, 0xffff0000, v90
    v_pk_add_f32 v[124:125], v[124:125], v[30:31]
    v_pk_fma_f32 v[32:33], v[124:125], v[124:125], v[32:33]
    v_lshlrev_b32 v126, 16, v91
    v_and_b32 v127, 0xffff0000, v91
    v_pk_add_f32 v[126:127], v[126:127], v[30:31]
    v_pk_fma_f32 v[34:35], v[126:127], v[126:127], v[34:35]
    v_lshlrev_b32 v128, 16, v92
    v_and_b32 v129, 0xffff0000, v92
    v_pk_add_f32 v[128:129], v[128:129], v[30:31]
    v_pk_fma_f32 v[32:33], v[128:129], v[128:129], v[32:33]
    v_lshlrev_b32 v130, 16, v93
    v_and_b32 v131, 0xffff0000, v93
    v_pk_add_f32 v[130:131], v[130:131], v[30:31]
    v_pk_fma_f32 v[34:35], v[130:131], v[130:131], v[34:35]
    v_lshlrev_b32 v132, 16, v94
    v_and_b32 v133, 0xffff0000, v94
    v_pk_add_f32 v[132:133], v[132:133], v[30:31]
    v_pk_fma_f32 v[32:33], v[132:133], v[132:133], v[32:33]
    v_lshlrev_b32 v134, 16, v95
    v_and_b32 v135, 0xffff0000, v95
    v_pk_add_f32 v[134:135], v[134:135], v[30:31]
    v_pk_fma_f32 v[34:35], v[134:135], v[134:135], v[34:35]
    v_lshlrev_b32 v136, 16, v96
    v_and_b32 v137, 0xffff0000, v96
    v_pk_add_f32 v[136:137], v[136:137], v[30:31]
    v_pk_fma_f32 v[32:33], v[136:137], v[136:137], v[32:33]
    v_lshlrev_b32 v138, 16, v97
    v_and_b32 v139, 0xffff0000, v97
    v_pk_add_f32 v[138:139], v[138:139], v[30:31]
    v_pk_fma_f32 v[34:35], v[138:139], v[138:139], v[34:35]
    v_lshlrev_b32 v140, 16, v98
    v_and_b32 v141, 0xffff0000, v98
    v_pk_add_f32 v[140:141], v[140:141], v[30:31]
    v_pk_fma_f32 v[32:33], v[140:141], v[140:141], v[32:33]
    v_lshlrev_b32 v142, 16, v99
    v_and_b32 v143, 0xffff0000, v99
    v_pk_add_f32 v[142:143], v[142:143], v[30:31]
    v_pk_fma_f32 v[34:35], v[142:143], v[142:143], v[34:35]
    v_lshlrev_b32 v144, 16, v100
    v_and_b32 v145, 0xffff0000, v100
    v_pk_add_f32 v[144:145], v[144:145], v[30:31]
    v_pk_fma_f32 v[32:33], v[144:145], v[144:145], v[32:33]
    v_lshlrev_b32 v146, 16, v101
    v_and_b32 v147, 0xffff0000, v101
    v_pk_add_f32 v[146:147], v[146:147], v[30:31]
    v_pk_fma_f32 v[34:35], v[146:147], v[146:147], v[34:35]
    v_lshlrev_b32 v148, 16, v102
    v_and_b32 v149, 0xffff0000, v102
    v_pk_add_f32 v[148:149], v[148:149], v[30:31]
    v_pk_fma_f32 v[32:33], v[148:149], v[148:149], v[32:33]
    v_lshlrev_b32 v150, 16, v103
    v_and_b32 v151, 0xffff0000, v103
    v_pk_add_f32 v[150:151], v[150:151], v[30:31]
    v_pk_fma_f32 v[34:35], v[150:151], v[150:151], v[34:35]
    v_lshlrev_b32 v152, 16, v104
    v_and_b32 v153, 0xffff0000, v104
    v_pk_add_f32 v[152:153], v[152:153], v[30:31]
    v_pk_fma_f32 v[32:33], v[152:153], v[152:153], v[32:33]
    v_lshlrev_b32 v154, 16, v105
    v_and_b32 v155, 0xffff0000, v105
    v_pk_add_f32 v[154:155], v[154:155], v[30:31]
    v_pk_fma_f32 v[34:35], v[154:155], v[154:155], v[34:35]
    v_lshlrev_b32 v156, 16, v106
    v_and_b32 v157, 0xffff0000, v106
    v_pk_add_f32 v[156:157], v[156:157], v[30:31]
    v_pk_fma_f32 v[32:33], v[156:157], v[156:157], v[32:33]
    v_lshlrev_b32 v158, 16, v107
    v_and_b32 v159, 0xffff0000, v107
    v_pk_add_f32 v[158:159], v[158:159], v[30:31]
    v_pk_fma_f32 v[34:35], v[158:159], v[158:159], v[34:35]
    v_lshlrev_b32 v160, 16, v108
    v_and_b32 v161, 0xffff0000, v108
    v_pk_add_f32 v[160:161], v[160:161], v[30:31]
    v_pk_fma_f32 v[32:33], v[160:161], v[160:161], v[32:33]
    v_lshlrev_b32 v162, 16, v109
    v_and_b32 v163, 0xffff0000, v109
    v_pk_add_f32 v[162:163], v[162:163], v[30:31]
    v_pk_fma_f32 v[34:35], v[162:163], v[162:163], v[34:35]
    v_lshlrev_b32 v164, 16, v110
    v_and_b32 v165, 0xffff0000, v110
    v_pk_add_f32 v[164:165], v[164:165], v[30:31]
    v_pk_fma_f32 v[32:33], v[164:165], v[164:165], v[32:33]
    v_lshlrev_b32 v166, 16, v111
    v_and_b32 v167, 0xffff0000, v111
    v_pk_add_f32 v[166:167], v[166:167], v[30:31]
    v_pk_fma_f32 v[34:35], v[166:167], v[166:167], v[34:35]
    v_lshlrev_b32 v168, 16, v112
    v_and_b32 v169, 0xffff0000, v112
    v_pk_add_f32 v[168:169], v[168:169], v[30:31]
    v_pk_fma_f32 v[32:33], v[168:169], v[168:169], v[32:33]
    v_lshlrev_b32 v170, 16, v113
    v_and_b32 v171, 0xffff0000, v113
    v_pk_add_f32 v[170:171], v[170:171], v[30:31]
    v_pk_fma_f32 v[34:35], v[170:171], v[170:171], v[34:35]
    v_lshlrev_b32 v172, 16, v114
    v_and_b32 v173, 0xffff0000, v114
    v_pk_add_f32 v[172:173], v[172:173], v[30:31]
    v_pk_fma_f32 v[32:33], v[172:173], v[172:173], v[32:33]
    v_lshlrev_b32 v174, 16, v115
    v_and_b32 v175, 0xffff0000, v115
    v_pk_add_f32 v[174:175], v[174:175], v[30:31]
    v_pk_fma_f32 v[34:35], v[174:175], v[174:175], v[34:35]
    v_lshlrev_b32 v176, 16, v116
    v_and_b32 v177, 0xffff0000, v116
    v_pk_add_f32 v[176:177], v[176:177], v[30:31]
    v_pk_fma_f32 v[32:33], v[176:177], v[176:177], v[32:33]
    v_lshlrev_b32 v178, 16, v117
    v_and_b32 v179, 0xffff0000, v117
    v_pk_add_f32 v[178:179], v[178:179], v[30:31]
    v_pk_fma_f32 v[34:35], v[178:179], v[178:179], v[34:35]
    v_lshlrev_b32 v180, 16, v118
    v_and_b32 v181, 0xffff0000, v118
    v_pk_add_f32 v[180:181], v[180:181], v[30:31]
    v_pk_fma_f32 v[32:33], v[180:181], v[180:181], v[32:33]
    v_lshlrev_b32 v182, 16, v119
    v_and_b32 v183, 0xffff0000, v119
    v_pk_add_f32 v[182:183], v[182:183], v[30:31]
    v_pk_fma_f32 v[34:35], v[182:183], v[182:183], v[34:35]
    v_add_f32 v32, v32, v33
    v_add_f32 v34, v34, v35
    v_add_f32 v32, v32, v34
    s_nop 1
    v_add_f32_dpp v33, v32, v32 quad_perm:[1,0,3,2] row_mask:0xf bank_mask:0xf
    s_nop 1
    v_add_f32_dpp v32, v33, v33 quad_perm:[2,3,0,1] row_mask:0xf bank_mask:0xf
    s_nop 1
    v_add_f32_dpp v33, v32, v32 row_half_mirror row_mask:0xf bank_mask:0xf
    v_mov_b32 v32, v33
    v_mul_f32 v32, 0x3b000000, v32
    v_cvt_pk_bf16_f32 v33, v32, v28
    v_lshlrev_b32 v34, 16, v33
    v_and_b32 v35, 0xffff0000, v33
    v_add_f32 v34, 0x3727c5ac, v34
    v_cvt_pk_bf16_f32 v33, v34, v34
    v_lshlrev_b32 v34, 16, v33
    v_sqrt_f32 v34, v34
    s_nop 0
    v_cvt_pk_bf16_f32 v33, v34, v34
    v_lshlrev_b32 v34, 16, v33
    v_rcp_f32 v30, v34
    s_nop 0
    v_mov_b32 v31, v30
    v_sub_f32 v36, v28, v35
    v_mul_f32 v36, v36, v30
    v_mov_b32 v37, v36
    v_pk_fma_f32 v[120:121], v[120:121], v[30:31], v[36:37]
    v_cvt_pk_bf16_f32 v88, v120, v121
    v_pk_fma_f32 v[122:123], v[122:123], v[30:31], v[36:37]
    v_cvt_pk_bf16_f32 v89, v122, v123
    v_pk_fma_f32 v[124:125], v[124:125], v[30:31], v[36:37]
    v_cvt_pk_bf16_f32 v90, v124, v125
    v_pk_fma_f32 v[126:127], v[126:127], v[30:31], v[36:37]
    v_cvt_pk_bf16_f32 v91, v126, v127
    s_nop 0
    ds_write_b128 v20, v[88:91] offset:0
    v_pk_fma_f32 v[128:129], v[128:129], v[30:31], v[36:37]
    v_cvt_pk_bf16_f32 v92, v128, v129
    v_pk_fma_f32 v[130:131], v[130:131], v[30:31], v[36:37]
    v_cvt_pk_bf16_f32 v93, v130, v131
    v_pk_fma_f32 v[132:133], v[132:133], v[30:31], v[36:37]
    v_cvt_pk_bf16_f32 v94, v132, v133
    v_pk_fma_f32 v[134:135], v[134:135], v[30:31], v[36:37]
    v_cvt_pk_bf16_f32 v95, v134, v135
    s_nop 0
    ds_write_b128 v21, v[92:95] offset:128
    v_pk_fma_f32 v[136:137], v[136:137], v[30:31], v[36:37]
    v_cvt_pk_bf16_f32 v96, v136, v137
    v_pk_fma_f32 v[138:139], v[138:139], v[30:31], v[36:37]
    v_cvt_pk_bf16_f32 v97, v138, v139
    v_pk_fma_f32 v[140:141], v[140:141], v[30:31], v[36:37]
    v_cvt_pk_bf16_f32 v98, v140, v141
    v_pk_fma_f32 v[142:143], v[142:143], v[30:31], v[36:37]
    v_cvt_pk_bf16_f32 v99, v142, v143
    s_nop 0
    ds_write_b128 v20, v[96:99] offset:256
    v_pk_fma_f32 v[144:145], v[144:145], v[30:31], v[36:37]
    v_cvt_pk_bf16_f32 v100, v144, v145
    v_pk_fma_f32 v[146:147], v[146:147], v[30:31], v[36:37]
    v_cvt_pk_bf16_f32 v101, v146, v147
    v_pk_fma_f32 v[148:149], v[148:149], v[30:31], v[36:37]
    v_cvt_pk_bf16_f32 v102, v148, v149
    v_pk_fma_f32 v[150:151], v[150:151], v[30:31], v[36:37]
    v_cvt_pk_bf16_f32 v103, v150, v151
    s_nop 0
    ds_write_b128 v21, v[100:103] offset:384
    v_pk_fma_f32 v[152:153], v[152:153], v[30:31], v[36:37]
    v_cvt_pk_bf16_f32 v104, v152, v153
    v_pk_fma_f32 v[154:155], v[154:155], v[30:31], v[36:37]
    v_cvt_pk_bf16_f32 v105, v154, v155
    v_pk_fma_f32 v[156:157], v[156:157], v[30:31], v[36:37]
    v_cvt_pk_bf16_f32 v106, v156, v157
    v_pk_fma_f32 v[158:159], v[158:159], v[30:31], v[36:37]
    v_cvt_pk_bf16_f32 v107, v158, v159
    s_nop 0
    ds_write_b128 v20, v[104:107] offset:512
    v_pk_fma_f32 v[160:161], v[160:161], v[30:31], v[36:37]
    v_cvt_pk_bf16_f32 v108, v160, v161
    v_pk_fma_f32 v[162:163], v[162:163], v[30:31], v[36:37]
    v_cvt_pk_bf16_f32 v109, v162, v163
    v_pk_fma_f32 v[164:165], v[164:165], v[30:31], v[36:37]
    v_cvt_pk_bf16_f32 v110, v164, v165
    v_pk_fma_f32 v[166:167], v[166:167], v[30:31], v[36:37]
    v_cvt_pk_bf16_f32 v111, v166, v167
    s_nop 0
    ds_write_b128 v21, v[108:111] offset:640
    v_pk_fma_f32 v[168:169], v[168:169], v[30:31], v[36:37]
    v_cvt_pk_bf16_f32 v112, v168, v169
    v_pk_fma_f32 v[170:171], v[170:171], v[30:31], v[36:37]
    v_cvt_pk_bf16_f32 v113, v170, v171
    v_pk_fma_f32 v[172:173], v[172:173], v[30:31], v[36:37]
    v_cvt_pk_bf16_f32 v114, v172, v173
    v_pk_fma_f32 v[174:175], v[174:175], v[30:31], v[36:37]
    v_cvt_pk_bf16_f32 v115, v174, v175
    s_nop 0
    ds_write_b128 v20, v[112:115] offset:768
    v_pk_fma_f32 v[176:177], v[176:177], v[30:31], v[36:37]
    v_cvt_pk_bf16_f32 v116, v176, v177
    v_pk_fma_f32 v[178:179], v[178:179], v[30:31], v[36:37]
    v_cvt_pk_bf16_f32 v117, v178, v179
    v_pk_fma_f32 v[180:181], v[180:181], v[30:31], v[36:37]
    v_cvt_pk_bf16_f32 v118, v180, v181
    v_pk_fma_f32 v[182:183], v[182:183], v[30:31], v[36:37]
    v_cvt_pk_bf16_f32 v119, v182, v183
    s_nop 0
    ds_write_b128 v21, v[116:119] offset:896
    s_waitcnt lgkmcnt(0)
    s_barrier
    s_cmp_ge_u32 s3, 4
    s_cbranch_scc1 .end_k5a1_kernel_1
    ds_read_b128 v[88:91], v16 offset:0
    ds_read_b128 v[92:95], v16 offset:16384
    ds_read_b128 v[96:99], v16 offset:32768
    ds_read_b128 v[100:103], v16 offset:49152
    s_waitcnt vmcnt(12)
    ds_read_b128 v[40:43], v14 offset:0
    ds_read_b128 v[44:47], v14 offset:2048
    ds_read_b128 v[104:107], v17 offset:0
    ds_read_b128 v[108:111], v17 offset:16384
    ds_read_b128 v[112:115], v17 offset:32768
    ds_read_b128 v[116:119], v17 offset:49152
    ds_read_b128 v[48:51], v15 offset:0
    ds_read_b128 v[52:55], v15 offset:2048
    s_waitcnt lgkmcnt(6)
    v_mfma_f32_16x16x32_bf16 a[0:3], v[88:91], v[40:43], 0
    v_mfma_f32_16x16x32_bf16 a[4:7], v[92:95], v[40:43], 0
    v_mfma_f32_16x16x32_bf16 a[8:11], v[96:99], v[40:43], 0
    v_mfma_f32_16x16x32_bf16 a[12:15], v[100:103], v[40:43], 0
    v_mfma_f32_16x16x32_bf16 a[16:19], v[88:91], v[44:47], 0
    v_mfma_f32_16x16x32_bf16 a[20:23], v[92:95], v[44:47], 0
    v_mfma_f32_16x16x32_bf16 a[24:27], v[96:99], v[44:47], 0
    v_mfma_f32_16x16x32_bf16 a[28:31], v[100:103], v[44:47], 0
    ds_read_b128 v[88:91], v18 offset:0
    ds_read_b128 v[92:95], v18 offset:16384
    ds_read_b128 v[96:99], v18 offset:32768
    ds_read_b128 v[100:103], v18 offset:49152
    s_waitcnt vmcnt(8)
    ds_read_b128 v[40:43], v14 offset:4096
    ds_read_b128 v[44:47], v14 offset:6144
    s_waitcnt lgkmcnt(6)
    v_mfma_f32_16x16x32_bf16 a[0:3], v[104:107], v[48:51], a[0:3]
    v_mfma_f32_16x16x32_bf16 a[4:7], v[108:111], v[48:51], a[4:7]
    v_mfma_f32_16x16x32_bf16 a[8:11], v[112:115], v[48:51], a[8:11]
    v_mfma_f32_16x16x32_bf16 a[12:15], v[116:119], v[48:51], a[12:15]
    v_mfma_f32_16x16x32_bf16 a[16:19], v[104:107], v[52:55], a[16:19]
    v_mfma_f32_16x16x32_bf16 a[20:23], v[108:111], v[52:55], a[20:23]
    v_mfma_f32_16x16x32_bf16 a[24:27], v[112:115], v[52:55], a[24:27]
    v_mfma_f32_16x16x32_bf16 a[28:31], v[116:119], v[52:55], a[28:31]
    s_add_u32 m0, s72, 0x0
    s_nop 0
    buffer_load_dwordx4 v10, s[48:51], s61 offen lds
    s_add_u32 m0, s72, 0x400
    s_nop 0
    buffer_load_dwordx4 v11, s[48:51], s61 offen lds
    s_add_u32 m0, s72, 0x800
    s_nop 0
    buffer_load_dwordx4 v12, s[48:51], s61 offen lds
    s_add_u32 m0, s72, 0xc00
    s_nop 0
    buffer_load_dwordx4 v13, s[48:51], s61 offen lds
    s_add_u32 s61, s61, 0x80
    ds_read_b128 v[104:107], v19 offset:0
    ds_read_b128 v[108:111], v19 offset:16384
    ds_read_b128 v[112:115], v19 offset:32768
    ds_read_b128 v[116:119], v19 offset:49152
    ds_read_b128 v[48:51], v15 offset:4096
    ds_read_b128 v[52:55], v15 offset:6144
    s_waitcnt lgkmcnt(6)
    v_mfma_f32_16x16x32_bf16 a[0:3], v[88:91], v[40:43], a[0:3]
    v_mfma_f32_16x16x32_bf16 a[4:7], v[92:95], v[40:43], a[4:7]
    v_mfma_f32_16x16x32_bf16 a[8:11], v[96:99], v[40:43], a[8:11]
    v_mfma_f32_16x16x32_bf16 a[12:15], v[100:103], v[40:43], a[12:15]
    v_mfma_f32_16x16x32_bf16 a[16:19], v[88:91], v[44:47], a[16:19]
    v_mfma_f32_16x16x32_bf16 a[20:23], v[92:95], v[44:47], a[20:23]
    v_mfma_f32_16x16x32_bf16 a[24:27], v[96:99], v[44:47], a[24:27]
    v_mfma_f32_16x16x32_bf16 a[28:31], v[100:103], v[44:47], a[28:31]
    ds_read_b128 v[88:91], v16 offset:256
    ds_read_b128 v[92:95], v16 offset:16640
    ds_read_b128 v[96:99], v16 offset:33024
    ds_read_b128 v[100:103], v16 offset:49408
    s_waitcnt vmcnt(8)
    ds_read_b128 v[40:43], v14 offset:8192
    ds_read_b128 v[44:47], v14 offset:10240
    s_waitcnt lgkmcnt(6)
    v_mfma_f32_16x16x32_bf16 a[0:3], v[104:107], v[48:51], a[0:3]
    v_mfma_f32_16x16x32_bf16 a[4:7], v[108:111], v[48:51], a[4:7]
    v_mfma_f32_16x16x32_bf16 a[8:11], v[112:115], v[48:51], a[8:11]
    v_mfma_f32_16x16x32_bf16 a[12:15], v[116:119], v[48:51], a[12:15]
    v_mfma_f32_16x16x32_bf16 a[16:19], v[104:107], v[52:55], a[16:19]
    v_mfma_f32_16x16x32_bf16 a[20:23], v[108:111], v[52:55], a[20:23]
    v_mfma_f32_16x16x32_bf16 a[24:27], v[112:115], v[52:55], a[24:27]
    v_mfma_f32_16x16x32_bf16 a[28:31], v[116:119], v[52:55], a[28:31]
    s_add_u32 m0, s72, 0x1000
    s_nop 0
    buffer_load_dwordx4 v10, s[48:51], s61 offen lds
    s_add_u32 m0, s72, 0x1400
    s_nop 0
    buffer_load_dwordx4 v11, s[48:51], s61 offen lds
    s_add_u32 m0, s72, 0x1800
    s_nop 0
    buffer_load_dwordx4 v12, s[48:51], s61 offen lds
    s_add_u32 m0, s72, 0x1c00
    s_nop 0
    buffer_load_dwordx4 v13, s[48:51], s61 offen lds
    s_add_u32 s61, s61, 0x80
    ds_read_b128 v[104:107], v17 offset:256
    ds_read_b128 v[108:111], v17 offset:16640
    ds_read_b128 v[112:115], v17 offset:33024
    ds_read_b128 v[116:119], v17 offset:49408
    ds_read_b128 v[48:51], v15 offset:8192
    ds_read_b128 v[52:55], v15 offset:10240
    s_waitcnt lgkmcnt(6)
    v_mfma_f32_16x16x32_bf16 a[0:3], v[88:91], v[40:43], a[0:3]
    v_mfma_f32_16x16x32_bf16 a[4:7], v[92:95], v[40:43], a[4:7]
    v_mfma_f32_16x16x32_bf16 a[8:11], v[96:99], v[40:43], a[8:11]
    v_mfma_f32_16x16x32_bf16 a[12:15], v[100:103], v[40:43], a[12:15]
    v_mfma_f32_16x16x32_bf16 a[16:19], v[88:91], v[44:47], a[16:19]
    v_mfma_f32_16x16x32_bf16 a[20:23], v[92:95], v[44:47], a[20:23]
    v_mfma_f32_16x16x32_bf16 a[24:27], v[96:99], v[44:47], a[24:27]
    v_mfma_f32_16x16x32_bf16 a[28:31], v[100:103], v[44:47], a[28:31]
    ds_read_b128 v[88:91], v18 offset:256
    ds_read_b128 v[92:95], v18 offset:16640
    ds_read_b128 v[96:99], v18 offset:33024
    ds_read_b128 v[100:103], v18 offset:49408
    s_waitcnt vmcnt(8)
    ds_read_b128 v[40:43], v14 offset:12288
    ds_read_b128 v[44:47], v14 offset:14336
    s_waitcnt lgkmcnt(6)
    v_mfma_f32_16x16x32_bf16 a[0:3], v[104:107], v[48:51], a[0:3]
    v_mfma_f32_16x16x32_bf16 a[4:7], v[108:111], v[48:51], a[4:7]
    v_mfma_f32_16x16x32_bf16 a[8:11], v[112:115], v[48:51], a[8:11]
    v_mfma_f32_16x16x32_bf16 a[12:15], v[116:119], v[48:51], a[12:15]
    v_mfma_f32_16x16x32_bf16 a[16:19], v[104:107], v[52:55], a[16:19]
    v_mfma_f32_16x16x32_bf16 a[20:23], v[108:111], v[52:55], a[20:23]
    v_mfma_f32_16x16x32_bf16 a[24:27], v[112:115], v[52:55], a[24:27]
    v_mfma_f32_16x16x32_bf16 a[28:31], v[116:119], v[52:55], a[28:31]
    s_add_u32 m0, s72, 0x2000
    s_nop 0
    buffer_load_dwordx4 v10, s[48:51], s61 offen lds
    s_add_u32 m0, s72, 0x2400
    s_nop 0
    buffer_load_dwordx4 v11, s[48:51], s61 offen lds
    s_add_u32 m0, s72, 0x2800
    s_nop 0
    buffer_load_dwordx4 v12, s[48:51], s61 offen lds
    s_add_u32 m0, s72, 0x2c00
    s_nop 0
    buffer_load_dwordx4 v13, s[48:51], s61 offen lds
    s_add_u32 s61, s61, 0x80
    ds_read_b128 v[104:107], v19 offset:256
    ds_read_b128 v[108:111], v19 offset:16640
    ds_read_b128 v[112:115], v19 offset:33024
    ds_read_b128 v[116:119], v19 offset:49408
    ds_read_b128 v[48:51], v15 offset:12288
    ds_read_b128 v[52:55], v15 offset:14336
    s_waitcnt lgkmcnt(6)
    v_mfma_f32_16x16x32_bf16 a[0:3], v[88:91], v[40:43], a[0:3]
    v_mfma_f32_16x16x32_bf16 a[4:7], v[92:95], v[40:43], a[4:7]
    v_mfma_f32_16x16x32_bf16 a[8:11], v[96:99], v[40:43], a[8:11]
    v_mfma_f32_16x16x32_bf16 a[12:15], v[100:103], v[40:43], a[12:15]
    v_mfma_f32_16x16x32_bf16 a[16:19], v[88:91], v[44:47], a[16:19]
    v_mfma_f32_16x16x32_bf16 a[20:23], v[92:95], v[44:47], a[20:23]
    v_mfma_f32_16x16x32_bf16 a[24:27], v[96:99], v[44:47], a[24:27]
    v_mfma_f32_16x16x32_bf16 a[28:31], v[100:103], v[44:47], a[28:31]
    ds_read_b128 v[88:91], v16 offset:512
    ds_read_b128 v[92:95], v16 offset:16896
    ds_read_b128 v[96:99], v16 offset:33280
    ds_read_b128 v[100:103], v16 offset:49664
    s_waitcnt vmcnt(8)
    ds_read_b128 v[40:43], v14 offset:0
    ds_read_b128 v[44:47], v14 offset:2048
    s_waitcnt lgkmcnt(6)
    v_mfma_f32_16x16x32_bf16 a[0:3], v[104:107], v[48:51], a[0:3]
    v_mfma_f32_16x16x32_bf16 a[4:7], v[108:111], v[48:51], a[4:7]
    v_mfma_f32_16x16x32_bf16 a[8:11], v[112:115], v[48:51], a[8:11]
    v_mfma_f32_16x16x32_bf16 a[12:15], v[116:119], v[48:51], a[12:15]
    v_mfma_f32_16x16x32_bf16 a[16:19], v[104:107], v[52:55], a[16:19]
    v_mfma_f32_16x16x32_bf16 a[20:23], v[108:111], v[52:55], a[20:23]
    v_mfma_f32_16x16x32_bf16 a[24:27], v[112:115], v[52:55], a[24:27]
    v_mfma_f32_16x16x32_bf16 a[28:31], v[116:119], v[52:55], a[28:31]
    s_add_u32 m0, s72, 0x3000
    s_nop 0
    buffer_load_dwordx4 v10, s[48:51], s61 offen lds
    s_add_u32 m0, s72, 0x3400
    s_nop 0
    buffer_load_dwordx4 v11, s[48:51], s61 offen lds
    s_add_u32 m0, s72, 0x3800
    s_nop 0
    buffer_load_dwordx4 v12, s[48:51], s61 offen lds
    s_add_u32 m0, s72, 0x3c00
    s_nop 0
    buffer_load_dwordx4 v13, s[48:51], s61 offen lds
    s_add_u32 s61, s61, 0x80
    ds_read_b128 v[104:107], v17 offset:512
    ds_read_b128 v[108:111], v17 offset:16896
    ds_read_b128 v[112:115], v17 offset:33280
    ds_read_b128 v[116:119], v17 offset:49664
    ds_read_b128 v[48:51], v15 offset:0
    ds_read_b128 v[52:55], v15 offset:2048
    s_waitcnt lgkmcnt(6)
    v_mfma_f32_16x16x32_bf16 a[0:3], v[88:91], v[40:43], a[0:3]
    v_mfma_f32_16x16x32_bf16 a[4:7], v[92:95], v[40:43], a[4:7]
    v_mfma_f32_16x16x32_bf16 a[8:11], v[96:99], v[40:43], a[8:11]
    v_mfma_f32_16x16x32_bf16 a[12:15], v[100:103], v[40:43], a[12:15]
    v_mfma_f32_16x16x32_bf16 a[16:19], v[88:91], v[44:47], a[16:19]
    v_mfma_f32_16x16x32_bf16 a[20:23], v[92:95], v[44:47], a[20:23]
    v_mfma_f32_16x16x32_bf16 a[24:27], v[96:99], v[44:47], a[24:27]
    v_mfma_f32_16x16x32_bf16 a[28:31], v[100:103], v[44:47], a[28:31]
    ds_read_b128 v[88:91], v18 offset:512
    ds_read_b128 v[92:95], v18 offset:16896
    ds_read_b128 v[96:99], v18 offset:33280
    ds_read_b128 v[100:103], v18 offset:49664
    s_waitcnt vmcnt(8)
    ds_read_b128 v[40:43], v14 offset:4096
    ds_read_b128 v[44:47], v14 offset:6144
    s_waitcnt lgkmcnt(6)
    v_mfma_f32_16x16x32_bf16 a[0:3], v[104:107], v[48:51], a[0:3]
    v_mfma_f32_16x16x32_bf16 a[4:7], v[108:111], v[48:51], a[4:7]
    v_mfma_f32_16x16x32_bf16 a[8:11], v[112:115], v[48:51], a[8:11]
    v_mfma_f32_16x16x32_bf16 a[12:15], v[116:119], v[48:51], a[12:15]
    v_mfma_f32_16x16x32_bf16 a[16:19], v[104:107], v[52:55], a[16:19]
    v_mfma_f32_16x16x32_bf16 a[20:23], v[108:111], v[52:55], a[20:23]
    v_mfma_f32_16x16x32_bf16 a[24:27], v[112:115], v[52:55], a[24:27]
    v_mfma_f32_16x16x32_bf16 a[28:31], v[116:119], v[52:55], a[28:31]
    ds_read_b128 v[104:107], v19 offset:512
    ds_read_b128 v[108:111], v19 offset:16896
    ds_read_b128 v[112:115], v19 offset:33280
    ds_read_b128 v[116:119], v19 offset:49664
    ds_read_b128 v[48:51], v15 offset:4096
    ds_read_b128 v[52:55], v15 offset:6144
    s_waitcnt lgkmcnt(6)
    v_mfma_f32_16x16x32_bf16 a[0:3], v[88:91], v[40:43], a[0:3]
    v_mfma_f32_16x16x32_bf16 a[4:7], v[92:95], v[40:43], a[4:7]
    v_mfma_f32_16x16x32_bf16 a[8:11], v[96:99], v[40:43], a[8:11]
    v_mfma_f32_16x16x32_bf16 a[12:15], v[100:103], v[40:43], a[12:15]
    v_mfma_f32_16x16x32_bf16 a[16:19], v[88:91], v[44:47], a[16:19]
    v_mfma_f32_16x16x32_bf16 a[20:23], v[92:95], v[44:47], a[20:23]
    v_mfma_f32_16x16x32_bf16 a[24:27], v[96:99], v[44:47], a[24:27]
    v_mfma_f32_16x16x32_bf16 a[28:31], v[100:103], v[44:47], a[28:31]
    ds_read_b128 v[88:91], v16 offset:768
    ds_read_b128 v[92:95], v16 offset:17152
    ds_read_b128 v[96:99], v16 offset:33536
    ds_read_b128 v[100:103], v16 offset:49920
    s_waitcnt vmcnt(4)
    ds_read_b128 v[40:43], v14 offset:8192
    ds_read_b128 v[44:47], v14 offset:10240
    s_waitcnt lgkmcnt(6)
    v_mfma_f32_16x16x32_bf16 a[0:3], v[104:107], v[48:51], a[0:3]
    v_mfma_f32_16x16x32_bf16 a[4:7], v[108:111], v[48:51], a[4:7]
    v_mfma_f32_16x16x32_bf16 a[8:11], v[112:115], v[48:51], a[8:11]
    v_mfma_f32_16x16x32_bf16 a[12:15], v[116:119], v[48:51], a[12:15]
    v_mfma_f32_16x16x32_bf16 a[16:19], v[104:107], v[52:55], a[16:19]
    v_mfma_f32_16x16x32_bf16 a[20:23], v[108:111], v[52:55], a[20:23]
    v_mfma_f32_16x16x32_bf16 a[24:27], v[112:115], v[52:55], a[24:27]
    v_mfma_f32_16x16x32_bf16 a[28:31], v[116:119], v[52:55], a[28:31]
    ds_read_b128 v[104:107], v17 offset:768
    ds_read_b128 v[108:111], v17 offset:17152
    ds_read_b128 v[112:115], v17 offset:33536
    ds_read_b128 v[116:119], v17 offset:49920
    ds_read_b128 v[48:51], v15 offset:8192
    ds_read_b128 v[52:55], v15 offset:10240
    s_waitcnt lgkmcnt(6)
    v_mfma_f32_16x16x32_bf16 a[0:3], v[88:91], v[40:43], a[0:3]
    v_mfma_f32_16x16x32_bf16 a[4:7], v[92:95], v[40:43], a[4:7]
    v_mfma_f32_16x16x32_bf16 a[8:11], v[96:99], v[40:43], a[8:11]
    v_mfma_f32_16x16x32_bf16 a[12:15], v[100:103], v[40:43], a[12:15]
    v_mfma_f32_16x16x32_bf16 a[16:19], v[88:91], v[44:47], a[16:19]
    v_mfma_f32_16x16x32_bf16 a[20:23], v[92:95], v[44:47], a[20:23]
    v_mfma_f32_16x16x32_bf16 a[24:27], v[96:99], v[44:47], a[24:27]
    v_mfma_f32_16x16x32_bf16 a[28:31], v[100:103], v[44:47], a[28:31]
    ds_read_b128 v[88:91], v18 offset:768
    ds_read_b128 v[92:95], v18 offset:17152
    ds_read_b128 v[96:99], v18 offset:33536
    ds_read_b128 v[100:103], v18 offset:49920
    s_waitcnt vmcnt(0)
    ds_read_b128 v[40:43], v14 offset:12288
    ds_read_b128 v[44:47], v14 offset:14336
    s_waitcnt lgkmcnt(6)
    v_mfma_f32_16x16x32_bf16 a[0:3], v[104:107], v[48:51], a[0:3]
    v_mfma_f32_16x16x32_bf16 a[4:7], v[108:111], v[48:51], a[4:7]
    v_mfma_f32_16x16x32_bf16 a[8:11], v[112:115], v[48:51], a[8:11]
    v_mfma_f32_16x16x32_bf16 a[12:15], v[116:119], v[48:51], a[12:15]
    v_mfma_f32_16x16x32_bf16 a[16:19], v[104:107], v[52:55], a[16:19]
    v_mfma_f32_16x16x32_bf16 a[20:23], v[108:111], v[52:55], a[20:23]
    v_mfma_f32_16x16x32_bf16 a[24:27], v[112:115], v[52:55], a[24:27]
    v_mfma_f32_16x16x32_bf16 a[28:31], v[116:119], v[52:55], a[28:31]
    ds_read_b128 v[104:107], v19 offset:768
    ds_read_b128 v[108:111], v19 offset:17152
    ds_read_b128 v[112:115], v19 offset:33536
    ds_read_b128 v[116:119], v19 offset:49920
    ds_read_b128 v[48:51], v15 offset:12288
    ds_read_b128 v[52:55], v15 offset:14336
    s_waitcnt lgkmcnt(6)
    v_mfma_f32_16x16x32_bf16 a[0:3], v[88:91], v[40:43], a[0:3]
    v_mfma_f32_16x16x32_bf16 a[4:7], v[92:95], v[40:43], a[4:7]
    v_mfma_f32_16x16x32_bf16 a[8:11], v[96:99], v[40:43], a[8:11]
    v_mfma_f32_16x16x32_bf16 a[12:15], v[100:103], v[40:43], a[12:15]
    v_mfma_f32_16x16x32_bf16 a[16:19], v[88:91], v[44:47], a[16:19]
    v_mfma_f32_16x16x32_bf16 a[20:23], v[92:95], v[44:47], a[20:23]
    v_mfma_f32_16x16x32_bf16 a[24:27], v[96:99], v[44:47], a[24:27]
    v_mfma_f32_16x16x32_bf16 a[28:31], v[100:103], v[44:47], a[28:31]
    s_waitcnt lgkmcnt(0)
    v_mfma_f32_16x16x32_bf16 a[0:3], v[104:107], v[48:51], a[0:3]
    v_mfma_f32_16x16x32_bf16 a[4:7], v[108:111], v[48:51], a[4:7]
    v_mfma_f32_16x16x32_bf16 a[8:11], v[112:115], v[48:51], a[8:11]
    v_mfma_f32_16x16x32_bf16 a[12:15], v[116:119], v[48:51], a[12:15]
    v_mfma_f32_16x16x32_bf16 a[16:19], v[104:107], v[52:55], a[16:19]
    v_mfma_f32_16x16x32_bf16 a[20:23], v[108:111], v[52:55], a[20:23]
    v_mfma_f32_16x16x32_bf16 a[24:27], v[112:115], v[52:55], a[24:27]
    v_mfma_f32_16x16x32_bf16 a[28:31], v[116:119], v[52:55], a[28:31]
    v_and_b32 v2, 15, v1
    v_lshrrev_b32 v3, 4, v1
    v_lshlrev_b32 v4, 4, v2
    v_lshrrev_b32 v5, 1, v3
    v_lshl_add_u32 v4, v5, 8, v4
    v_and_b32 v5, 1, v3
    v_lshl_add_u32 v4, v5, 3, v4
    s_lshl_b32 s6, s5, 3
    s_lshl_b32 s7, s3, 1
    s_add_u32 s6, s6, s7
    s_lshl_b32 s6, s6, 16
    s_lshl_b32 s7, s4, 11
    s_add_u32 s64, s6, s7
    s_add_u32 s65, s64, 0x10000
    s_nop 7
    s_nop 7
    v_accvgpr_read_b32 v120, a0
    v_accvgpr_read_b32 v121, a1
    v_accvgpr_read_b32 v122, a2
    v_accvgpr_read_b32 v123, a3
    v_cvt_pk_bf16_f32 v124, v120, v121
    v_cvt_pk_bf16_f32 v125, v122, v123
    buffer_store_dwordx2 v[124:125], v4, s[52:55], s64 offen offset:0
    v_accvgpr_read_b32 v128, a4
    v_accvgpr_read_b32 v129, a5
    v_accvgpr_read_b32 v130, a6
    v_accvgpr_read_b32 v131, a7
    v_cvt_pk_bf16_f32 v132, v128, v129
    v_cvt_pk_bf16_f32 v133, v130, v131
    buffer_store_dwordx2 v[132:133], v4, s[52:55], s64 offen offset:512
    v_accvgpr_read_b32 v120, a8
    v_accvgpr_read_b32 v121, a9
    v_accvgpr_read_b32 v122, a10
    v_accvgpr_read_b32 v123, a11
    v_cvt_pk_bf16_f32 v124, v120, v121
    v_cvt_pk_bf16_f32 v125, v122, v123
    buffer_store_dwordx2 v[124:125], v4, s[52:55], s64 offen offset:1024
    v_accvgpr_read_b32 v128, a12
    v_accvgpr_read_b32 v129, a13
    v_accvgpr_read_b32 v130, a14
    v_accvgpr_read_b32 v131, a15
    v_cvt_pk_bf16_f32 v132, v128, v129
    v_cvt_pk_bf16_f32 v133, v130, v131
    buffer_store_dwordx2 v[132:133], v4, s[52:55], s64 offen offset:1536
    v_accvgpr_read_b32 v120, a16
    v_accvgpr_read_b32 v121, a17
    v_accvgpr_read_b32 v122, a18
    v_accvgpr_read_b32 v123, a19
    v_cvt_pk_bf16_f32 v124, v120, v121
    v_cvt_pk_bf16_f32 v125, v122, v123
    buffer_store_dwordx2 v[124:125], v4, s[52:55], s65 offen offset:0
    v_accvgpr_read_b32 v128, a20
    v_accvgpr_read_b32 v129, a21
    v_accvgpr_read_b32 v130, a22
    v_accvgpr_read_b32 v131, a23
    v_cvt_pk_bf16_f32 v132, v128, v129
    v_cvt_pk_bf16_f32 v133, v130, v131
    buffer_store_dwordx2 v[132:133], v4, s[52:55], s65 offen offset:512
    v_accvgpr_read_b32 v120, a24
    v_accvgpr_read_b32 v121, a25
    v_accvgpr_read_b32 v122, a26
    v_accvgpr_read_b32 v123, a27
    v_cvt_pk_bf16_f32 v124, v120, v121
    v_cvt_pk_bf16_f32 v125, v122, v123
    buffer_store_dwordx2 v[124:125], v4, s[52:55], s65 offen offset:1024
    v_accvgpr_read_b32 v128, a28
    v_accvgpr_read_b32 v129, a29
    v_accvgpr_read_b32 v130, a30
    v_accvgpr_read_b32 v131, a31
    v_cvt_pk_bf16_f32 v132, v128, v129
    v_cvt_pk_bf16_f32 v133, v130, v131
    buffer_store_dwordx2 v[132:133], v4, s[52:55], s65 offen offset:1536
    s_branch .end_k5a1_kernel_1
.end_k5a1_kernel_1:
    s_endpgm
.section .rodata,"a"
.p2align 6
.amdhsa_kernel k5a1_kernel
  .amdhsa_next_free_vgpr 216
  .amdhsa_next_free_sgpr 100
  .amdhsa_accum_offset 184
  .amdhsa_group_segment_fixed_size 0
  .amdhsa_kernarg_size 104
  .amdhsa_user_sgpr_count 2
  .amdhsa_user_sgpr_kernarg_segment_ptr 1
  .amdhsa_system_sgpr_workgroup_id_x 1
  .amdhsa_float_denorm_mode_32 3
.end_amdhsa_kernel
.text

.globl k6a2_kernel
.p2align 8
.type k6a2_kernel,@function
k6a2_kernel:
    s_load_dwordx16 s[16:31], s[0:1], 0
    s_load_dwordx8 s[32:39], s[0:1], 64
    s_load_dwordx2 s[40:41], s[0:1], 96
    s_cmp_ge_u32 s2, 256
    s_cbranch_scc1 .end_k6a2_kernel_1
    v_lshrrev_b32 v2, 6, v0
    v_and_b32 v1, 63, v0
    v_readfirstlane_b32 s3, v2
    s_and_b32 s6, s2, 7
    s_lshr_b32 s7, s2, 3
    s_lshr_b32 s4, s7, 3
    s_lshl_b32 s6, s6, 2
    s_add_u32 s4, s4, s6
    s_and_b32 s5, s7, 7
    s_waitcnt lgkmcnt(0)
    s_cmp_lt_u32 s3, 2
    s_cselect_b32 s44, s18, s20
    s_cselect_b32 s45, s19, s21
    s_mov_b32 s46, 0x800000
    s_mov_b32 s47, 0x00020000
    s_mov_b32 s48, s40
    s_mov_b32 s49, s41
    s_mov_b32 s50, 0x400000
    s_mov_b32 s51, 0x00020000
    s_and_b32 s6, s3, 1
    s_lshl_b32 s6, s6, 11
    s_lshl_b32 s7, s4, 18
    s_add_u32 s60, s6, s7
    s_lshr_b32 s8, s3, 1
    s_lshl_b32 s8, s8, 21
    s_lshl_b32 s9, s5, 18
    s_add_u32 s8, s8, s9
    s_lshl_b32 s9, s6, 4
    s_add_u32 s61, s8, s9
    s_add_u32 s64, s40, 0xd00000
    s_addc_u32 s65, s41, 0
    s_mov_b32 s66, 0x200000
    s_mov_b32 s67, 0x00020000
    s_add_u32 s68, s40, 0xf00000
    s_addc_u32 s69, s41, 0
    s_mov_b32 s70, 0x200000
    s_mov_b32 s71, 0x00020000
    v_and_b32 v10, 15, v1
    v_lshrrev_b32 v11, 4, v1
    v_lshlrev_b32 v12, 12, v10
    v_lshl_add_u32 v12, v11, 4, v12
    v_lshlrev_b32 v17, 4, v1
    v_add_u32 v2, 0x0, v12
    v_add_u32 v6, 0x0, v17
    v_add_u32 v3, 0x10000, v12
    v_add_u32 v7, 0x10000, v17
    v_add_u32 v4, 0x20000, v12
    v_add_u32 v8, 0x20000, v17
    v_add_u32 v5, 0x30000, v12
    v_add_u32 v9, 0x30000, v17
    v_lshrrev_b32 v13, 3, v1
    v_and_b32 v14, 7, v1
    v_lshrrev_b32 v15, 4, v1
    v_xor_b32 v14, v14, v15
    v_lshlrev_b32 v13, 12, v13
    v_lshl_add_u32 v15, v14, 4, v13
    v_xor_b32 v14, 4, v14
    v_lshl_add_u32 v14, v14, 4, v13
    v_add_u32 v136, 0x0, v15
    v_add_u32 v137, 0x8000, v14
    v_add_u32 v138, 0x10000, v15
    v_add_u32 v139, 0x18000, v14
    v_add_u32 v140, 0x20000, v15
    v_add_u32 v141, 0x28000, v14
    v_add_u32 v142, 0x30000, v15
    v_add_u32 v143, 0x38000, v14
    s_mul_i32 s72, s3, 24576
    v_lshrrev_b32 v13, 1, v10
    v_xor_b32 v13, v13, v11
    v_lshlrev_b32 v13, 4, v13
    v_and_b32 v14, 7, v10
    v_lshl_add_u32 v13, v14, 7, v13
    v_lshrrev_b32 v14, 3, v10
    v_lshl_add_u32 v13, v14, 10, v13
    v_add_u32 v144, s72, v13
    v_xor_b32 v145, 64, v144
    s_add_u32 m0, s72, 0x0
    s_nop 0
    buffer_load_dwordx4 v136, s[44:47], s60 offen lds
    s_add_u32 m0, s72, 0x400
    s_nop 0
    buffer_load_dwordx4 v137, s[44:47], s60 offen lds
    s_add_u32 m0, s72, 0x800
    s_nop 0
    buffer_load_dwordx4 v138, s[44:47], s60 offen lds
    s_add_u32 m0, s72, 0xc00
    s_nop 0
    buffer_load_dwordx4 v139, s[44:47], s60 offen lds
    s_add_u32 m0, s72, 0x1000
    s_nop 0
    buffer_load_dwordx4 v140, s[44:47], s60 offen lds
    s_add_u32 m0, s72, 0x1400
    s_nop 0
    buffer_load_dwordx4 v141, s[44:47], s60 offen lds
    s_add_u32 m0, s72, 0x1800
    s_nop 0
    buffer_load_dwordx4 v142, s[44:47], s60 offen lds
    s_add_u32 m0, s72, 0x1c00
    s_nop 0
    buffer_load_dwordx4 v143, s[44:47], s60 offen lds
    s_add_u32 s60, s60, 0x80
    s_add_u32 m0, s72, 0x2000
    s_nop 0
    buffer_load_dwordx4 v136, s[44:47], s60 offen lds
    s_add_u32 m0, s72, 0x2400
    s_nop 0
    buffer_load_dwordx4 v137, s[44:47], s60 offen lds
    s_add_u32 m0, s72, 0x2800
    s_nop 0
    buffer_load_dwordx4 v138, s[44:47], s60 offen lds
    s_add_u32 m0, s72, 0x2c00
    s_nop 0
    buffer_load_dwordx4 v139, s[44:47], s60 offen lds
    s_add_u32 m0, s72, 0x3000
    s_nop 0
    buffer_load_dwordx4 v140, s[44:47], s60 offen lds
    s_add_u32 m0, s72, 0x3400
    s_nop 0
    buffer_load_dwordx4 v141, s[44:47], s60 offen lds
    s_add_u32 m0, s72, 0x3800
    s_nop 0
    buffer_load_dwordx4 v142, s[44:47], s60 offen lds
    s_add_u32 m0, s72, 0x3c00
    s_nop 0
    buffer_load_dwordx4 v143, s[44:47], s60 offen lds
    s_add_u32 s60, s60, 0x80
    s_add_u32 m0, s72, 0x4000
    s_nop 0
    buffer_load_dwordx4 v136, s[44:47], s60 offen lds
    s_add_u32 m0, s72, 0x4400
    s_nop 0
    buffer_load_dwordx4 v137, s[44:47], s60 offen lds
    s_add_u32 m0, s72, 0x4800
    s_nop 0
    buffer_load_dwordx4 v138, s[44:47], s60 offen lds
    s_add_u32 m0, s72, 0x4c00
    s_nop 0
    buffer_load_dwordx4 v139, s[44:47], s60 offen lds
    s_add_u32 m0, s72, 0x5000
    s_nop 0
    buffer_load_dwordx4 v140, s[44:47], s60 offen lds
    s_add_u32 m0, s72, 0x5400
    s_nop 0
    buffer_load_dwordx4 v141, s[44:47], s60 offen lds
    s_add_u32 m0, s72, 0x5800
    s_nop 0
    buffer_load_dwordx4 v142, s[44:47], s60 offen lds
    s_add_u32 m0, s72, 0x5c00
    s_nop 0
    buffer_load_dwordx4 v143, s[44:47], s60 offen lds
    s_add_u32 s60, s60, 0x80
    buffer_load_dwordx4 v[72:75], v6, s[48:51], s61 offen
    buffer_load_dwordx4 v[76:79], v7, s[48:51], s61 offen
    buffer_load_dwordx4 v[80:83], v8, s[48:51], s61 offen
    buffer_load_dwordx4 v[84:87], v9, s[48:51], s61 offen
    s_add_u32 s61, s61, 0x400
    buffer_load_dwordx4 v[88:91], v6, s[48:51], s61 offen
    buffer_load_dwordx4 v[92:95], v7, s[48:51], s61 offen
    buffer_load_dwordx4 v[96:99], v8, s[48:51], s61 offen
    buffer_load_dwordx4 v[100:103], v9, s[48:51], s61 offen
    s_add_u32 s61, s61, 0x400
    buffer_load_dwordx4 v[104:107], v6, s[48:51], s61 offen
    buffer_load_dwordx4 v[108:111], v7, s[48:51], s61 offen
    buffer_load_dwordx4 v[112:115], v8, s[48:51], s61 offen
    buffer_load_dwordx4 v[116:119], v9, s[48:51], s61 offen
    s_add_u32 s61, s61, 0x400
    buffer_load_dwordx4 v[120:123], v6, s[48:51], s61 offen
    buffer_load_dwordx4 v[124:127], v7, s[48:51], s61 offen
    buffer_load_dwordx4 v[128:131], v8, s[48:51], s61 offen
    buffer_load_dwordx4 v[132:135], v9, s[48:51], s61 offen
    s_add_u32 s61, s61, 0x400
    v_lshlrev_b32 v13, 10, v10
    v_lshl_add_u32 v13, v11, 3, v13
    v_mov_b32 v16, v13
    s_lshl_b32 s6, s4, 16
    s_lshl_b32 s7, s3, 14
    s_add_u32 s6, s6, s7
    s_lshl_b32 s7, s5, 7
    s_add_u32 s62, s6, s7
    buffer_load_dwordx2 v[24:25], v16, s[64:67], s62 offen offset:0
    buffer_load_dwordx2 v[26:27], v16, s[64:67], s62 offen offset:32
    buffer_load_dwordx2 v[28:29], v16, s[64:67], s62 offen offset:64
    buffer_load_dwordx2 v[30:31], v16, s[64:67], s62 offen offset:96
    s_waitcnt vmcnt(36)
    ds_read_b128 v[40:43], v144 offset:0
    ds_read_b128 v[44:47], v144 offset:2048
    ds_read_b128 v[48:51], v144 offset:4096
    ds_read_b128 v[52:55], v144 offset:6144
    ds_read_b128 v[56:59], v145 offset:0
    ds_read_b128 v[60:63], v145 offset:2048
    ds_read_b128 v[64:67], v145 offset:4096
    ds_read_b128 v[68:71], v145 offset:6144
    s_waitcnt lgkmcnt(4)
    s_waitcnt vmcnt(16)
    v_mfma_f32_16x16x32_bf16 a[0:3], v[72:75], v[40:43], 0
    v_mfma_f32_16x16x32_bf16 a[4:7], v[72:75], v[44:47], 0
    v_mfma_f32_16x16x32_bf16 a[8:11], v[72:75], v[48:51], 0
    v_mfma_f32_16x16x32_bf16 a[12:15], v[72:75], v[52:55], 0
    v_mfma_f32_16x16x32_bf16 a[16:19], v[76:79], v[40:43], 0
    v_mfma_f32_16x16x32_bf16 a[20:23], v[76:79], v[44:47], 0
    v_mfma_f32_16x16x32_bf16 a[24:27], v[76:79], v[48:51], 0
    v_mfma_f32_16x16x32_bf16 a[28:31], v[76:79], v[52:55], 0
    v_mfma_f32_16x16x32_bf16 a[32:35], v[80:83], v[40:43], 0
    v_mfma_f32_16x16x32_bf16 a[36:39], v[80:83], v[44:47], 0
    v_mfma_f32_16x16x32_bf16 a[40:43], v[80:83], v[48:51], 0
    v_mfma_f32_16x16x32_bf16 a[44:47], v[80:83], v[52:55], 0
    v_mfma_f32_16x16x32_bf16 a[48:51], v[84:87], v[40:43], 0
    v_mfma_f32_16x16x32_bf16 a[52:55], v[84:87], v[44:47], 0
    v_mfma_f32_16x16x32_bf16 a[56:59], v[84:87], v[48:51], 0
    v_mfma_f32_16x16x32_bf16 a[60:63], v[84:87], v[52:55], 0
    buffer_load_dwordx4 v[72:75], v6, s[48:51], s61 offen
    buffer_load_dwordx4 v[76:79], v7, s[48:51], s61 offen
    buffer_load_dwordx4 v[80:83], v8, s[48:51], s61 offen
    buffer_load_dwordx4 v[84:87], v9, s[48:51], s61 offen
    s_add_u32 s61, s61, 0x400
    ds_read_b128 v[40:43], v144 offset:8192
    ds_read_b128 v[44:47], v144 offset:10240
    ds_read_b128 v[48:51], v144 offset:12288
    ds_read_b128 v[52:55], v144 offset:14336
    s_waitcnt lgkmcnt(4)
    s_waitcnt vmcnt(16)
    v_mfma_f32_16x16x32_bf16 a[0:3], v[88:91], v[56:59], a[0:3]
    v_mfma_f32_16x16x32_bf16 a[4:7], v[88:91], v[60:63], a[4:7]
    v_mfma_f32_16x16x32_bf16 a[8:11], v[88:91], v[64:67], a[8:11]
    v_mfma_f32_16x16x32_bf16 a[12:15], v[88:91], v[68:71], a[12:15]
    v_mfma_f32_16x16x32_bf16 a[16:19], v[92:95], v[56:59], a[16:19]
    v_mfma_f32_16x16x32_bf16 a[20:23], v[92:95], v[60:63], a[20:23]
    v_mfma_f32_16x16x32_bf16 a[24:27], v[92:95], v[64:67], a[24:27]
    v_mfma_f32_16x16x32_bf16 a[28:31], v[92:95], v[68:71], a[28:31]
    v_mfma_f32_16x16x32_bf16 a[32:35], v[96:99], v[56:59], a[32:35]
    v_mfma_f32_16x16x32_bf16 a[36:39], v[96:99], v[60:63], a[36:39]
    v_mfma_f32_16x16x32_bf16 a[40:43], v[96:99], v[64:67], a[40:43]
    v_mfma_f32_16x16x32_bf16 a[44:47], v[96:99], v[68:71], a[44:47]
    v_mfma_f32_16x16x32_bf16 a[48:51], v[100:103], v[56:59], a[48:51]
    v_mfma_f32_16x16x32_bf16 a[52:55], v[100:103], v[60:63], a[52:55]
    v_mfma_f32_16x16x32_bf16 a[56:59], v[100:103], v[64:67], a[56:59]
    v_mfma_f32_16x16x32_bf16 a[60:63], v[100:103], v[68:71], a[60:63]
    s_add_u32 m0, s72, 0x0
    s_nop 0
    buffer_load_dwordx4 v136, s[44:47], s60 offen lds
    s_add_u32 m0, s72, 0x400
    s_nop 0
    buffer_load_dwordx4 v137, s[44:47], s60 offen lds
    s_add_u32 m0, s72, 0x800
    s_nop 0
    buffer_load_dwordx4 v138, s[44:47], s60 offen lds
    s_add_u32 m0, s72, 0xc00
    s_nop 0
    buffer_load_dwordx4 v139, s[44:47], s60 offen lds
    s_add_u32 m0, s72, 0x1000
    s_nop 0
    buffer_load_dwordx4 v140, s[44:47], s60 offen lds
    s_add_u32 m0, s72, 0x1400
    s_nop 0
    buffer_load_dwordx4 v141, s[44:47], s60 offen lds
    s_add_u32 m0, s72, 0x1800
    s_nop 0
    buffer_load_dwordx4 v142, s[44:47], s60 offen lds
    s_add_u32 m0, s72, 0x1c00
    s_nop 0
    buffer_load_dwordx4 v143, s[44:47], s60 offen lds
    s_add_u32 s60, s60, 0x80
    buffer_load_dwordx4 v[88:91], v6, s[48:51], s61 offen
    buffer_load_dwordx4 v[92:95], v7, s[48:51], s61 offen
    buffer_load_dwordx4 v[96:99], v8, s[48:51], s61 offen
    buffer_load_dwordx4 v[100:103], v9, s[48:51], s61 offen
    s_add_u32 s61, s61, 0x400
    ds_read_b128 v[56:59], v145 offset:8192
    ds_read_b128 v[60:63], v145 offset:10240
    ds_read_b128 v[64:67], v145 offset:12288
    ds_read_b128 v[68:71], v145 offset:14336
    s_waitcnt lgkmcnt(4)
    s_waitcnt vmcnt(24)
    v_mfma_f32_16x16x32_bf16 a[0:3], v[104:107], v[40:43], a[0:3]
    v_mfma_f32_16x16x32_bf16 a[4:7], v[104:107], v[44:47], a[4:7]
    v_mfma_f32_16x16x32_bf16 a[8:11], v[104:107], v[48:51], a[8:11]
    v_mfma_f32_16x16x32_bf16 a[12:15], v[104:107], v[52:55], a[12:15]
    v_mfma_f32_16x16x32_bf16 a[16:19], v[108:111], v[40:43], a[16:19]
    v_mfma_f32_16x16x32_bf16 a[20:23], v[108:111], v[44:47], a[20:23]
    v_mfma_f32_16x16x32_bf16 a[24:27], v[108:111], v[48:51], a[24:27]
    v_mfma_f32_16x16x32_bf16 a[28:31], v[108:111], v[52:55], a[28:31]
    v_mfma_f32_16x16x32_bf16 a[32:35], v[112:115], v[40:43], a[32:35]
    v_mfma_f32_16x16x32_bf16 a[36:39], v[112:115], v[44:47], a[36:39]
    v_mfma_f32_16x16x32_bf16 a[40:43], v[112:115], v[48:51], a[40:43]
    v_mfma_f32_16x16x32_bf16 a[44:47], v[112:115], v[52:55], a[44:47]
    v_mfma_f32_16x16x32_bf16 a[48:51], v[116:119], v[40:43], a[48:51]
    v_mfma_f32_16x16x32_bf16 a[52:55], v[116:119], v[44:47], a[52:55]
    v_mfma_f32_16x16x32_bf16 a[56:59], v[116:119], v[48:51], a[56:59]
    v_mfma_f32_16x16x32_bf16 a[60:63], v[116:119], v[52:55], a[60:63]
    buffer_load_dwordx4 v[104:107], v6, s[48:51], s61 offen
    buffer_load_dwordx4 v[108:111], v7, s[48:51], s61 offen
    buffer_load_dwordx4 v[112:115], v8, s[48:51], s61 offen
    buffer_load_dwordx4 v[116:119], v9, s[48:51], s61 offen
    s_add_u32 s61, s61, 0x400
    ds_read_b128 v[40:43], v144 offset:16384
    ds_read_b128 v[44:47], v144 offset:18432
    ds_read_b128 v[48:51], v144 offset:20480
    ds_read_b128 v[52:55], v144 offset:22528
    s_waitcnt lgkmcnt(4)
    s_waitcnt vmcnt(24)
    v_mfma_f32_16x16x32_bf16 a[0:3], v[120:123], v[56:59], a[0:3]
    v_mfma_f32_16x16x32_bf16 a[4:7], v[120:123], v[60:63], a[4:7]
    v_mfma_f32_16x16x32_bf16 a[8:11], v[120:123], v[64:67], a[8:11]
    v_mfma_f32_16x16x32_bf16 a[12:15], v[120:123], v[68:71], a[12:15]
    v_mfma_f32_16x16x32_bf16 a[16:19], v[124:127], v[56:59], a[16:19]
    v_mfma_f32_16x16x32_bf16 a[20:23], v[124:127], v[60:63], a[20:23]
    v_mfma_f32_16x16x32_bf16 a[24:27], v[124:127], v[64:67], a[24:27]
    v_mfma_f32_16x16x32_bf16 a[28:31], v[124:127], v[68:71], a[28:31]
    v_mfma_f32_16x16x32_bf16 a[32:35], v[128:131], v[56:59], a[32:35]
    v_mfma_f32_16x16x32_bf16 a[36:39], v[128:131], v[60:63], a[36:39]
    v_mfma_f32_16x16x32_bf16 a[40:43], v[128:131], v[64:67], a[40:43]
    v_mfma_f32_16x16x32_bf16 a[44:47], v[128:131], v[68:71], a[44:47]
    v_mfma_f32_16x16x32_bf16 a[48:51], v[132:135], v[56:59], a[48:51]
    v_mfma_f32_16x16x32_bf16 a[52:55], v[132:135], v[60:63], a[52:55]
    v_mfma_f32_16x16x32_bf16 a[56:59], v[132:135], v[64:67], a[56:59]
    v_mfma_f32_16x16x32_bf16 a[60:63], v[132:135], v[68:71], a[60:63]
    s_add_u32 m0, s72, 0x2000
    s_nop 0
    buffer_load_dwordx4 v136, s[44:47], s60 offen lds
    s_add_u32 m0, s72, 0x2400
    s_nop 0
    buffer_load_dwordx4 v137, s[44:47], s60 offen lds
    s_add_u32 m0, s72, 0x2800
    s_nop 0
    buffer_load_dwordx4 v138, s[44:47], s60 offen lds
    s_add_u32 m0, s72, 0x2c00
    s_nop 0
    buffer_load_dwordx4 v139, s[44:47], s60 offen lds
    s_add_u32 m0, s72, 0x3000
    s_nop 0
    buffer_load_dwordx4 v140, s[44:47], s60 offen lds
    s_add_u32 m0, s72, 0x3400
    s_nop 0
    buffer_load_dwordx4 v141, s[44:47], s60 offen lds
    s_add_u32 m0, s72, 0x3800
    s_nop 0
    buffer_load_dwordx4 v142, s[44:47], s60 offen lds
    s_add_u32 m0, s72, 0x3c00
    s_nop 0
    buffer_load_dwordx4 v143, s[44:47], s60 offen lds
    s_add_u32 s60, s60, 0x80
    buffer_load_dwordx4 v[120:123], v6, s[48:51], s61 offen
    buffer_load_dwordx4 v[124:127], v7, s[48:51], s61 offen
    buffer_load_dwordx4 v[128:131], v8, s[48:51], s61 offen
    buffer_load_dwordx4 v[132:135], v9, s[48:51], s61 offen
    s_add_u32 s61, s61, 0x400
    ds_read_b128 v[56:59], v145 offset:16384
    ds_read_b128 v[60:63], v145 offset:18432
    ds_read_b128 v[64:67], v145 offset:20480
    ds_read_b128 v[68:71], v145 offset:22528
    s_waitcnt lgkmcnt(4)
    s_waitcnt vmcnt(28)
    v_mfma_f32_16x16x32_bf16 a[0:3], v[72:75], v[40:43], a[0:3]
    v_mfma_f32_16x16x32_bf16 a[4:7], v[72:75], v[44:47], a[4:7]
    v_mfma_f32_16x16x32_bf16 a[8:11], v[72:75], v[48:51], a[8:11]
    v_mfma_f32_16x16x32_bf16 a[12:15], v[72:75], v[52:55], a[12:15]
    v_mfma_f32_16x16x32_bf16 a[16:19], v[76:79], v[40:43], a[16:19]
    v_mfma_f32_16x16x32_bf16 a[20:23], v[76:79], v[44:47], a[20:23]
    v_mfma_f32_16x16x32_bf16 a[24:27], v[76:79], v[48:51], a[24:27]
    v_mfma_f32_16x16x32_bf16 a[28:31], v[76:79], v[52:55], a[28:31]
    v_mfma_f32_16x16x32_bf16 a[32:35], v[80:83], v[40:43], a[32:35]
    v_mfma_f32_16x16x32_bf16 a[36:39], v[80:83], v[44:47], a[36:39]
    v_mfma_f32_16x16x32_bf16 a[40:43], v[80:83], v[48:51], a[40:43]
    v_mfma_f32_16x16x32_bf16 a[44:47], v[80:83], v[52:55], a[44:47]
    v_mfma_f32_16x16x32_bf16 a[48:51], v[84:87], v[40:43], a[48:51]
    v_mfma_f32_16x16x32_bf16 a[52:55], v[84:87], v[44:47], a[52:55]
    v_mfma_f32_16x16x32_bf16 a[56:59], v[84:87], v[48:51], a[56:59]
    v_mfma_f32_16x16x32_bf16 a[60:63], v[84:87], v[52:55], a[60:63]
    buffer_load_dwordx4 v[72:75], v6, s[48:51], s61 offen
    buffer_load_dwordx4 v[76:79], v7, s[48:51], s61 offen
    buffer_load_dwordx4 v[80:83], v8, s[48:51], s61 offen
    buffer_load_dwordx4 v[84:87], v9, s[48:51], s61 offen
    s_add_u32 s61, s61, 0x400
    s_waitcnt vmcnt(24)
    ds_read_b128 v[40:43], v144 offset:0
    ds_read_b128 v[44:47], v144 offset:2048
    ds_read_b128 v[48:51], v144 offset:4096
    ds_read_b128 v[52:55], v144 offset:6144
    s_waitcnt lgkmcnt(4)
    s_waitcnt vmcnt(20)
    v_mfma_f32_16x16x32_bf16 a[0:3], v[88:91], v[56:59], a[0:3]
    v_mfma_f32_16x16x32_bf16 a[4:7], v[88:91], v[60:63], a[4:7]
    v_mfma_f32_16x16x32_bf16 a[8:11], v[88:91], v[64:67], a[8:11]
    v_mfma_f32_16x16x32_bf16 a[12:15], v[88:91], v[68:71], a[12:15]
    v_mfma_f32_16x16x32_bf16 a[16:19], v[92:95], v[56:59], a[16:19]
    v_mfma_f32_16x16x32_bf16 a[20:23], v[92:95], v[60:63], a[20:23]
    v_mfma_f32_16x16x32_bf16 a[24:27], v[92:95], v[64:67], a[24:27]
    v_mfma_f32_16x16x32_bf16 a[28:31], v[92:95], v[68:71], a[28:31]
    v_mfma_f32_16x16x32_bf16 a[32:35], v[96:99], v[56:59], a[32:35]
    v_mfma_f32_16x16x32_bf16 a[36:39], v[96:99], v[60:63], a[36:39]
    v_mfma_f32_16x16x32_bf16 a[40:43], v[96:99], v[64:67], a[40:43]
    v_mfma_f32_16x16x32_bf16 a[44:47], v[96:99], v[68:71], a[44:47]
    v_mfma_f32_16x16x32_bf16 a[48:51], v[100:103], v[56:59], a[48:51]
    v_mfma_f32_16x16x32_bf16 a[52:55], v[100:103], v[60:63], a[52:55]
    v_mfma_f32_16x16x32_bf16 a[56:59], v[100:103], v[64:67], a[56:59]
    v_mfma_f32_16x16x32_bf16 a[60:63], v[100:103], v[68:71], a[60:63]
    s_add_u32 m0, s72, 0x4000
    s_nop 0
    buffer_load_dwordx4 v136, s[44:47], s60 offen lds
    s_add_u32 m0, s72, 0x4400
    s_nop 0
    buffer_load_dwordx4 v137, s[44:47], s60 offen lds
    s_add_u32 m0, s72, 0x4800
    s_nop 0
    buffer_load_dwordx4 v138, s[44:47], s60 offen lds
    s_add_u32 m0, s72, 0x4c00
    s_nop 0
    buffer_load_dwordx4 v139, s[44:47], s60 offen lds
    s_add_u32 m0, s72, 0x5000
    s_nop 0
    buffer_load_dwordx4 v140, s[44:47], s60 offen lds
    s_add_u32 m0, s72, 0x5400
    s_nop 0
    buffer_load_dwordx4 v141, s[44:47], s60 offen lds
    s_add_u32 m0, s72, 0x5800
    s_nop 0
    buffer_load_dwordx4 v142, s[44:47], s60 offen lds
    s_add_u32 m0, s72, 0x5c00
    s_nop 0
    buffer_load_dwordx4 v143, s[44:47], s60 offen lds
    s_add_u32 s60, s60, 0x80
    buffer_load_dwordx4 v[88:91], v6, s[48:51], s61 offen
    buffer_load_dwordx4 v[92:95], v7, s[48:51], s61 offen
    buffer_load_dwordx4 v[96:99], v8, s[48:51], s61 offen
    buffer_load_dwordx4 v[100:103], v9, s[48:51], s61 offen
    s_add_u32 s61, s61, 0x400
    ds_read_b128 v[56:59], v145 offset:0
    ds_read_b128 v[60:63], v145 offset:2048
    ds_read_b128 v[64:67], v145 offset:4096
    ds_read_b128 v[68:71], v145 offset:6144
    s_waitcnt lgkmcnt(4)
    s_waitcnt vmcnt(28)
    v_mfma_f32_16x16x32_bf16 a[0:3], v[104:107], v[40:43], a[0:3]
    v_mfma_f32_16x16x32_bf16 a[4:7], v[104:107], v[44:47], a[4:7]
    v_mfma_f32_16x16x32_bf16 a[8:11], v[104:107], v[48:51], a[8:11]
    v_mfma_f32_16x16x32_bf16 a[12:15], v[104:107], v[52:55], a[12:15]
    v_mfma_f32_16x16x32_bf16 a[16:19], v[108:111], v[40:43], a[16:19]
    v_mfma_f32_16x16x32_bf16 a[20:23], v[108:111], v[44:47], a[20:23]
    v_mfma_f32_16x16x32_bf16 a[24:27], v[108:111], v[48:51], a[24:27]
    v_mfma_f32_16x16x32_bf16 a[28:31], v[108:111], v[52:55], a[28:31]
    v_mfma_f32_16x16x32_bf16 a[32:35], v[112:115], v[40:43], a[32:35]
    v_mfma_f32_16x16x32_bf16 a[36:39], v[112:115], v[44:47], a[36:39]
    v_mfma_f32_16x16x32_bf16 a[40:43], v[112:115], v[48:51], a[40:43]
    v_mfma_f32_16x16x32_bf16 a[44:47], v[112:115], v[52:55], a[44:47]
    v_mfma_f32_16x16x32_bf16 a[48:51], v[116:119], v[40:43], a[48:51]
    v_mfma_f32_16x16x32_bf16 a[52:55], v[116:119], v[44:47], a[52:55]
    v_mfma_f32_16x16x32_bf16 a[56:59], v[116:119], v[48:51], a[56:59]
    v_mfma_f32_16x16x32_bf16 a[60:63], v[116:119], v[52:55], a[60:63]
    buffer_load_dwordx4 v[104:107], v6, s[48:51], s61 offen
    buffer_load_dwordx4 v[108:111], v7, s[48:51], s61 offen
    buffer_load_dwordx4 v[112:115], v8, s[48:51], s61 offen
    buffer_load_dwordx4 v[116:119], v9, s[48:51], s61 offen
    s_add_u32 s61, s61, 0x400
    s_waitcnt vmcnt(24)
    ds_read_b128 v[40:43], v144 offset:8192
    ds_read_b128 v[44:47], v144 offset:10240
    ds_read_b128 v[48:51], v144 offset:12288
    ds_read_b128 v[52:55], v144 offset:14336
    s_waitcnt lgkmcnt(4)
    s_waitcnt vmcnt(20)
    v_mfma_f32_16x16x32_bf16 a[0:3], v[120:123], v[56:59], a[0:3]
    v_mfma_f32_16x16x32_bf16 a[4:7], v[120:123], v[60:63], a[4:7]
    v_mfma_f32_16x16x32_bf16 a[8:11], v[120:123], v[64:67], a[8:11]
    v_mfma_f32_16x16x32_bf16 a[12:15], v[120:123], v[68:71], a[12:15]
    v_mfma_f32_16x16x32_bf16 a[16:19], v[124:127], v[56:59], a[16:19]
    v_mfma_f32_16x16x32_bf16 a[20:23], v[124:127], v[60:63], a[20:23]
    v_mfma_f32_16x16x32_bf16 a[24:27], v[124:127], v[64:67], a[24:27]
    v_mfma_f32_16x16x32_bf16 a[28:31], v[124:127], v[68:71], a[28:31]
    v_mfma_f32_16x16x32_bf16 a[32:35], v[128:131], v[56:59], a[32:35]
    v_mfma_f32_16x16x32_bf16 a[36:39], v[128:131], v[60:63], a[36:39]
    v_mfma_f32_16x16x32_bf16 a[40:43], v[128:131], v[64:67], a[40:43]
    v_mfma_f32_16x16x32_bf16 a[44:47], v[128:131], v[68:71], a[44:47]
    v_mfma_f32_16x16x32_bf16 a[48:51], v[132:135], v[56:59], a[48:51]
    v_mfma_f32_16x16x32_bf16 a[52:55], v[132:135], v[60:63], a[52:55]
    v_mfma_f32_16x16x32_bf16 a[56:59], v[132:135], v[64:67], a[56:59]
    v_mfma_f32_16x16x32_bf16 a[60:63], v[132:135], v[68:71], a[60:63]
    s_add_u32 m0, s72, 0x0
    s_nop 0
    buffer_load_dwordx4 v136, s[44:47], s60 offen lds
    s_add_u32 m0, s72, 0x400
    s_nop 0
    buffer_load_dwordx4 v137, s[44:47], s60 offen lds
    s_add_u32 m0, s72, 0x800
    s_nop 0
    buffer_load_dwordx4 v138, s[44:47], s60 offen lds
    s_add_u32 m0, s72, 0xc00
    s_nop 0
    buffer_load_dwordx4 v139, s[44:47], s60 offen lds
    s_add_u32 m0, s72, 0x1000
    s_nop 0
    buffer_load_dwordx4 v140, s[44:47], s60 offen lds
    s_add_u32 m0, s72, 0x1400
    s_nop 0
    buffer_load_dwordx4 v141, s[44:47], s60 offen lds
    s_add_u32 m0, s72, 0x1800
    s_nop 0
    buffer_load_dwordx4 v142, s[44:47], s60 offen lds
    s_add_u32 m0, s72, 0x1c00
    s_nop 0
    buffer_load_dwordx4 v143, s[44:47], s60 offen lds
    s_add_u32 s60, s60, 0x80
    buffer_load_dwordx4 v[120:123], v6, s[48:51], s61 offen
    buffer_load_dwordx4 v[124:127], v7, s[48:51], s61 offen
    buffer_load_dwordx4 v[128:131], v8, s[48:51], s61 offen
    buffer_load_dwordx4 v[132:135], v9, s[48:51], s61 offen
    s_add_u32 s61, s61, 0x400
    ds_read_b128 v[56:59], v145 offset:8192
    ds_read_b128 v[60:63], v145 offset:10240
    ds_read_b128 v[64:67], v145 offset:12288
    ds_read_b128 v[68:71], v145 offset:14336
    s_waitcnt lgkmcnt(4)
    s_waitcnt vmcnt(28)
    v_mfma_f32_16x16x32_bf16 a[0:3], v[72:75], v[40:43], a[0:3]
    v_mfma_f32_16x16x32_bf16 a[4:7], v[72:75], v[44:47], a[4:7]
    v_mfma_f32_16x16x32_bf16 a[8:11], v[72:75], v[48:51], a[8:11]
    v_mfma_f32_16x16x32_bf16 a[12:15], v[72:75], v[52:55], a[12:15]
    v_mfma_f32_16x16x32_bf16 a[16:19], v[76:79], v[40:43], a[16:19]
    v_mfma_f32_16x16x32_bf16 a[20:23], v[76:79], v[44:47], a[20:23]
    v_mfma_f32_16x16x32_bf16 a[24:27], v[76:79], v[48:51], a[24:27]
    v_mfma_f32_16x16x32_bf16 a[28:31], v[76:79], v[52:55], a[28:31]
    v_mfma_f32_16x16x32_bf16 a[32:35], v[80:83], v[40:43], a[32:35]
    v_mfma_f32_16x16x32_bf16 a[36:39], v[80:83], v[44:47], a[36:39]
    v_mfma_f32_16x16x32_bf16 a[40:43], v[80:83], v[48:51], a[40:43]
    v_mfma_f32_16x16x32_bf16 a[44:47], v[80:83], v[52:55], a[44:47]
    v_mfma_f32_16x16x32_bf16 a[48:51], v[84:87], v[40:43], a[48:51]
    v_mfma_f32_16x16x32_bf16 a[52:55], v[84:87], v[44:47], a[52:55]
    v_mfma_f32_16x16x32_bf16 a[56:59], v[84:87], v[48:51], a[56:59]
    v_mfma_f32_16x16x32_bf16 a[60:63], v[84:87], v[52:55], a[60:63]
    buffer_load_dwordx4 v[72:75], v6, s[48:51], s61 offen
    buffer_load_dwordx4 v[76:79], v7, s[48:51], s61 offen
    buffer_load_dwordx4 v[80:83], v8, s[48:51], s61 offen
    buffer_load_dwordx4 v[84:87], v9, s[48:51], s61 offen
    s_add_u32 s61, s61, 0x400
    s_waitcnt vmcnt(24)
    ds_read_b128 v[40:43], v144 offset:16384
    ds_read_b128 v[44:47], v144 offset:18432
    ds_read_b128 v[48:51], v144 offset:20480
    ds_read_b128 v[52:55], v144 offset:22528
    s_waitcnt lgkmcnt(4)
    s_waitcnt vmcnt(20)
    v_mfma_f32_16x16x32_bf16 a[0:3], v[88:91], v[56:59], a[0:3]
    v_mfma_f32_16x16x32_bf16 a[4:7], v[88:91], v[60:63], a[4:7]
    v_mfma_f32_16x16x32_bf16 a[8:11], v[88:91], v[64:67], a[8:11]
    v_mfma_f32_16x16x32_bf16 a[12:15], v[88:91], v[68:71], a[12:15]
    v_mfma_f32_16x16x32_bf16 a[16:19], v[92:95], v[56:59], a[16:19]
    v_mfma_f32_16x16x32_bf16 a[20:23], v[92:95], v[60:63], a[20:23]
    v_mfma_f32_16x16x32_bf16 a[24:27], v[92:95], v[64:67], a[24:27]
    v_mfma_f32_16x16x32_bf16 a[28:31], v[92:95], v[68:71], a[28:31]
    v_mfma_f32_16x16x32_bf16 a[32:35], v[96:99], v[56:59], a[32:35]
    v_mfma_f32_16x16x32_bf16 a[36:39], v[96:99], v[60:63], a[36:39]
    v_mfma_f32_16x16x32_bf16 a[40:43], v[96:99], v[64:67], a[40:43]
    v_mfma_f32_16x16x32_bf16 a[44:47], v[96:99], v[68:71], a[44:47]
    v_mfma_f32_16x16x32_bf16 a[48:51], v[100:103], v[56:59], a[48:51]
    v_mfma_f32_16x16x32_bf16 a[52:55], v[100:103], v[60:63], a[52:55]
    v_mfma_f32_16x16x32_bf16 a[56:59], v[100:103], v[64:67], a[56:59]
    v_mfma_f32_16x16x32_bf16 a[60:63], v[100:103], v[68:71], a[60:63]
    s_add_u32 m0, s72, 0x2000
    s_nop 0
    buffer_load_dwordx4 v136, s[44:47], s60 offen lds
    s_add_u32 m0, s72, 0x2400
    s_nop 0
    buffer_load_dwordx4 v137, s[44:47], s60 offen lds
    s_add_u32 m0, s72, 0x2800
    s_nop 0
    buffer_load_dwordx4 v138, s[44:47], s60 offen lds
    s_add_u32 m0, s72, 0x2c00
    s_nop 0
    buffer_load_dwordx4 v139, s[44:47], s60 offen lds
    s_add_u32 m0, s72, 0x3000
    s_nop 0
    buffer_load_dwordx4 v140, s[44:47], s60 offen lds
    s_add_u32 m0, s72, 0x3400
    s_nop 0
    buffer_load_dwordx4 v141, s[44:47], s60 offen lds
    s_add_u32 m0, s72, 0x3800
    s_nop 0
    buffer_load_dwordx4 v142, s[44:47], s60 offen lds
    s_add_u32 m0, s72, 0x3c00
    s_nop 0
    buffer_load_dwordx4 v143, s[44:47], s60 offen lds
    s_add_u32 s60, s60, 0x80
    buffer_load_dwordx4 v[88:91], v6, s[48:51], s61 offen
    buffer_load_dwordx4 v[92:95], v7, s[48:51], s61 offen
    buffer_load_dwordx4 v[96:99], v8, s[48:51], s61 offen
    buffer_load_dwordx4 v[100:103], v9, s[48:51], s61 offen
    s_add_u32 s61, s61, 0x400
    ds_read_b128 v[56:59], v145 offset:16384
    ds_read_b128 v[60:63], v145 offset:18432
    ds_read_b128 v[64:67], v145 offset:20480
    ds_read_b128 v[68:71], v145 offset:22528
    s_waitcnt lgkmcnt(4)
    s_waitcnt vmcnt(28)
    v_mfma_f32_16x16x32_bf16 a[0:3], v[104:107], v[40:43], a[0:3]
    v_mfma_f32_16x16x32_bf16 a[4:7], v[104:107], v[44:47], a[4:7]
    v_mfma_f32_16x16x32_bf16 a[8:11], v[104:107], v[48:51], a[8:11]
    v_mfma_f32_16x16x32_bf16 a[12:15], v[104:107], v[52:55], a[12:15]
    v_mfma_f32_16x16x32_bf16 a[16:19], v[108:111], v[40:43], a[16:19]
    v_mfma_f32_16x16x32_bf16 a[20:23], v[108:111], v[44:47], a[20:23]
    v_mfma_f32_16x16x32_bf16 a[24:27], v[108:111], v[48:51], a[24:27]
    v_mfma_f32_16x16x32_bf16 a[28:31], v[108:111], v[52:55], a[28:31]
    v_mfma_f32_16x16x32_bf16 a[32:35], v[112:115], v[40:43], a[32:35]
    v_mfma_f32_16x16x32_bf16 a[36:39], v[112:115], v[44:47], a[36:39]
    v_mfma_f32_16x16x32_bf16 a[40:43], v[112:115], v[48:51], a[40:43]
    v_mfma_f32_16x16x32_bf16 a[44:47], v[112:115], v[52:55], a[44:47]
    v_mfma_f32_16x16x32_bf16 a[48:51], v[116:119], v[40:43], a[48:51]
    v_mfma_f32_16x16x32_bf16 a[52:55], v[116:119], v[44:47], a[52:55]
    v_mfma_f32_16x16x32_bf16 a[56:59], v[116:119], v[48:51], a[56:59]
    v_mfma_f32_16x16x32_bf16 a[60:63], v[116:119], v[52:55], a[60:63]
    buffer_load_dwordx4 v[104:107], v6, s[48:51], s61 offen
    buffer_load_dwordx4 v[108:111], v7, s[48:51], s61 offen
    buffer_load_dwordx4 v[112:115], v8, s[48:51], s61 offen
    buffer_load_dwordx4 v[116:119], v9, s[48:51], s61 offen
    s_add_u32 s61, s61, 0x400
    s_waitcnt vmcnt(24)
    ds_read_b128 v[40:43], v144 offset:0
    ds_read_b128 v[44:47], v144 offset:2048
    ds_read_b128 v[48:51], v144 offset:4096
    ds_read_b128 v[52:55], v144 offset:6144
    s_waitcnt lgkmcnt(4)
    s_waitcnt vmcnt(20)
    v_mfma_f32_16x16x32_bf16 a[0:3], v[120:123], v[56:59], a[0:3]
    v_mfma_f32_16x16x32_bf16 a[4:7], v[120:123], v[60:63], a[4:7]
    v_mfma_f32_16x16x32_bf16 a[8:11], v[120:123], v[64:67], a[8:11]
    v_mfma_f32_16x16x32_bf16 a[12:15], v[120:123], v[68:71], a[12:15]
    v_mfma_f32_16x16x32_bf16 a[16:19], v[124:127], v[56:59], a[16:19]
    v_mfma_f32_16x16x32_bf16 a[20:23], v[124:127], v[60:63], a[20:23]
    v_mfma_f32_16x16x32_bf16 a[24:27], v[124:127], v[64:67], a[24:27]
    v_mfma_f32_16x16x32_bf16 a[28:31], v[124:127], v[68:71], a[28:31]
    v_mfma_f32_16x16x32_bf16 a[32:35], v[128:131], v[56:59], a[32:35]
    v_mfma_f32_16x16x32_bf16 a[36:39], v[128:131], v[60:63], a[36:39]
    v_mfma_f32_16x16x32_bf16 a[40:43], v[128:131], v[64:67], a[40:43]
    v_mfma_f32_16x16x32_bf16 a[44:47], v[128:131], v[68:71], a[44:47]
    v_mfma_f32_16x16x32_bf16 a[48:51], v[132:135], v[56:59], a[48:51]
    v_mfma_f32_16x16x32_bf16 a[52:55], v[132:135], v[60:63], a[52:55]
    v_mfma_f32_16x16x32_bf16 a[56:59], v[132:135], v[64:67], a[56:59]
    v_mfma_f32_16x16x32_bf16 a[60:63], v[132:135], v[68:71], a[60:63]
    s_add_u32 m0, s72, 0x4000
    s_nop 0
    buffer_load_dwordx4 v136, s[44:47], s60 offen lds
    s_add_u32 m0, s72, 0x4400
    s_nop 0
    buffer_load_dwordx4 v137, s[44:47], s60 offen lds
    s_add_u32 m0, s72, 0x4800
    s_nop 0
    buffer_load_dwordx4 v138, s[44:47], s60 offen lds
    s_add_u32 m0, s72, 0x4c00
    s_nop 0
    buffer_load_dwordx4 v139, s[44:47], s60 offen lds
    s_add_u32 m0, s72, 0x5000
    s_nop 0
    buffer_load_dwordx4 v140, s[44:47], s60 offen lds
    s_add_u32 m0, s72, 0x5400
    s_nop 0
    buffer_load_dwordx4 v141, s[44:47], s60 offen lds
    s_add_u32 m0, s72, 0x5800
    s_nop 0
    buffer_load_dwordx4 v142, s[44:47], s60 offen lds
    s_add_u32 m0, s72, 0x5c00
    s_nop 0
    buffer_load_dwordx4 v143, s[44:47], s60 offen lds
    s_add_u32 s60, s60, 0x80
    buffer_load_dwordx4 v[120:123], v6, s[48:51], s61 offen
    buffer_load_dwordx4 v[124:127], v7, s[48:51], s61 offen
    buffer_load_dwordx4 v[128:131], v8, s[48:51], s61 offen
    buffer_load_dwordx4 v[132:135], v9, s[48:51], s61 offen
    s_add_u32 s61, s61, 0x400
    ds_read_b128 v[56:59], v145 offset:0
    ds_read_b128 v[60:63], v145 offset:2048
    ds_read_b128 v[64:67], v145 offset:4096
    ds_read_b128 v[68:71], v145 offset:6144
    s_waitcnt lgkmcnt(4)
    s_waitcnt vmcnt(28)
    v_mfma_f32_16x16x32_bf16 a[0:3], v[72:75], v[40:43], a[0:3]
    v_mfma_f32_16x16x32_bf16 a[4:7], v[72:75], v[44:47], a[4:7]
    v_mfma_f32_16x16x32_bf16 a[8:11], v[72:75], v[48:51], a[8:11]
    v_mfma_f32_16x16x32_bf16 a[12:15], v[72:75], v[52:55], a[12:15]
    v_mfma_f32_16x16x32_bf16 a[16:19], v[76:79], v[40:43], a[16:19]
    v_mfma_f32_16x16x32_bf16 a[20:23], v[76:79], v[44:47], a[20:23]
    v_mfma_f32_16x16x32_bf16 a[24:27], v[76:79], v[48:51], a[24:27]
    v_mfma_f32_16x16x32_bf16 a[28:31], v[76:79], v[52:55], a[28:31]
    v_mfma_f32_16x16x32_bf16 a[32:35], v[80:83], v[40:43], a[32:35]
    v_mfma_f32_16x16x32_bf16 a[36:39], v[80:83], v[44:47], a[36:39]
    v_mfma_f32_16x16x32_bf16 a[40:43], v[80:83], v[48:51], a[40:43]
    v_mfma_f32_16x16x32_bf16 a[44:47], v[80:83], v[52:55], a[44:47]
    v_mfma_f32_16x16x32_bf16 a[48:51], v[84:87], v[40:43], a[48:51]
    v_mfma_f32_16x16x32_bf16 a[52:55], v[84:87], v[44:47], a[52:55]
    v_mfma_f32_16x16x32_bf16 a[56:59], v[84:87], v[48:51], a[56:59]
    v_mfma_f32_16x16x32_bf16 a[60:63], v[84:87], v[52:55], a[60:63]
    buffer_load_dwordx4 v[72:75], v6, s[48:51], s61 offen
    buffer_load_dwordx4 v[76:79], v7, s[48:51], s61 offen
    buffer_load_dwordx4 v[80:83], v8, s[48:51], s61 offen
    buffer_load_dwordx4 v[84:87], v9, s[48:51], s61 offen
    s_add_u32 s61, s61, 0x400
    s_waitcnt vmcnt(24)
    ds_read_b128 v[40:43], v144 offset:8192
    ds_read_b128 v[44:47], v144 offset:10240
    ds_read_b128 v[48:51], v144 offset:12288
    ds_read_b128 v[52:55], v144 offset:14336
    s_waitcnt lgkmcnt(4)
    s_waitcnt vmcnt(20)
    v_mfma_f32_16x16x32_bf16 a[0:3], v[88:91], v[56:59], a[0:3]
    v_mfma_f32_16x16x32_bf16 a[4:7], v[88:91], v[60:63], a[4:7]
    v_mfma_f32_16x16x32_bf16 a[8:11], v[88:91], v[64:67], a[8:11]
    v_mfma_f32_16x16x32_bf16 a[12:15], v[88:91], v[68:71], a[12:15]
    v_mfma_f32_16x16x32_bf16 a[16:19], v[92:95], v[56:59], a[16:19]
    v_mfma_f32_16x16x32_bf16 a[20:23], v[92:95], v[60:63], a[20:23]
    v_mfma_f32_16x16x32_bf16 a[24:27], v[92:95], v[64:67], a[24:27]
    v_mfma_f32_16x16x32_bf16 a[28:31], v[92:95], v[68:71], a[28:31]
    v_mfma_f32_16x16x32_bf16 a[32:35], v[96:99], v[56:59], a[32:35]
    v_mfma_f32_16x16x32_bf16 a[36:39], v[96:99], v[60:63], a[36:39]
    v_mfma_f32_16x16x32_bf16 a[40:43], v[96:99], v[64:67], a[40:43]
    v_mfma_f32_16x16x32_bf16 a[44:47], v[96:99], v[68:71], a[44:47]
    v_mfma_f32_16x16x32_bf16 a[48:51], v[100:103], v[56:59], a[48:51]
    v_mfma_f32_16x16x32_bf16 a[52:55], v[100:103], v[60:63], a[52:55]
    v_mfma_f32_16x16x32_bf16 a[56:59], v[100:103], v[64:67], a[56:59]
    v_mfma_f32_16x16x32_bf16 a[60:63], v[100:103], v[68:71], a[60:63]
    s_add_u32 m0, s72, 0x0
    s_nop 0
    buffer_load_dwordx4 v136, s[44:47], s60 offen lds
    s_add_u32 m0, s72, 0x400
    s_nop 0
    buffer_load_dwordx4 v137, s[44:47], s60 offen lds
    s_add_u32 m0, s72, 0x800
    s_nop 0
    buffer_load_dwordx4 v138, s[44:47], s60 offen lds
    s_add_u32 m0, s72, 0xc00
    s_nop 0
    buffer_load_dwordx4 v139, s[44:47], s60 offen lds
    s_add_u32 m0, s72, 0x1000
    s_nop 0
    buffer_load_dwordx4 v140, s[44:47], s60 offen lds
    s_add_u32 m0, s72, 0x1400
    s_nop 0
    buffer_load_dwordx4 v141, s[44:47], s60 offen lds
    s_add_u32 m0, s72, 0x1800
    s_nop 0
    buffer_load_dwordx4 v142, s[44:47], s60 offen lds
    s_add_u32 m0, s72, 0x1c00
    s_nop 0
    buffer_load_dwordx4 v143, s[44:47], s60 offen lds
    s_add_u32 s60, s60, 0x80
    buffer_load_dwordx4 v[88:91], v6, s[48:51], s61 offen
    buffer_load_dwordx4 v[92:95], v7, s[48:51], s61 offen
    buffer_load_dwordx4 v[96:99], v8, s[48:51], s61 offen
    buffer_load_dwordx4 v[100:103], v9, s[48:51], s61 offen
    s_add_u32 s61, s61, 0x400
    ds_read_b128 v[56:59], v145 offset:8192
    ds_read_b128 v[60:63], v145 offset:10240
    ds_read_b128 v[64:67], v145 offset:12288
    ds_read_b128 v[68:71], v145 offset:14336
    s_waitcnt lgkmcnt(4)
    s_waitcnt vmcnt(28)
    v_mfma_f32_16x16x32_bf16 a[0:3], v[104:107], v[40:43], a[0:3]
    v_mfma_f32_16x16x32_bf16 a[4:7], v[104:107], v[44:47], a[4:7]
    v_mfma_f32_16x16x32_bf16 a[8:11], v[104:107], v[48:51], a[8:11]
    v_mfma_f32_16x16x32_bf16 a[12:15], v[104:107], v[52:55], a[12:15]
    v_mfma_f32_16x16x32_bf16 a[16:19], v[108:111], v[40:43], a[16:19]
    v_mfma_f32_16x16x32_bf16 a[20:23], v[108:111], v[44:47], a[20:23]
    v_mfma_f32_16x16x32_bf16 a[24:27], v[108:111], v[48:51], a[24:27]
    v_mfma_f32_16x16x32_bf16 a[28:31], v[108:111], v[52:55], a[28:31]
    v_mfma_f32_16x16x32_bf16 a[32:35], v[112:115], v[40:43], a[32:35]
    v_mfma_f32_16x16x32_bf16 a[36:39], v[112:115], v[44:47], a[36:39]
    v_mfma_f32_16x16x32_bf16 a[40:43], v[112:115], v[48:51], a[40:43]
    v_mfma_f32_16x16x32_bf16 a[44:47], v[112:115], v[52:55], a[44:47]
    v_mfma_f32_16x16x32_bf16 a[48:51], v[116:119], v[40:43], a[48:51]
    v_mfma_f32_16x16x32_bf16 a[52:55], v[116:119], v[44:47], a[52:55]
    v_mfma_f32_16x16x32_bf16 a[56:59], v[116:119], v[48:51], a[56:59]
    v_mfma_f32_16x16x32_bf16 a[60:63], v[116:119], v[52:55], a[60:63]
    buffer_load_dwordx4 v[104:107], v6, s[48:51], s61 offen
    buffer_load_dwordx4 v[108:111], v7, s[48:51], s61 offen
    buffer_load_dwordx4 v[112:115], v8, s[48:51], s61 offen
    buffer_load_dwordx4 v[116:119], v9, s[48:51], s61 offen
    s_add_u32 s61, s61, 0x400
    s_waitcnt vmcnt(24)
    ds_read_b128 v[40:43], v144 offset:16384
    ds_read_b128 v[44:47], v144 offset:18432
    ds_read_b128 v[48:51], v144 offset:20480
    ds_read_b128 v[52:55], v144 offset:22528
    s_waitcnt lgkmcnt(4)
    s_waitcnt vmcnt(20)
    v_mfma_f32_16x16x32_bf16 a[0:3], v[120:123], v[56:59], a[0:3]
    v_mfma_f32_16x16x32_bf16 a[4:7], v[120:123], v[60:63], a[4:7]
    v_mfma_f32_16x16x32_bf16 a[8:11], v[120:123], v[64:67], a[8:11]
    v_mfma_f32_16x16x32_bf16 a[12:15], v[120:123], v[68:71], a[12:15]
    v_mfma_f32_16x16x32_bf16 a[16:19], v[124:127], v[56:59], a[16:19]
    v_mfma_f32_16x16x32_bf16 a[20:23], v[124:127], v[60:63], a[20:23]
    v_mfma_f32_16x16x32_bf16 a[24:27], v[124:127], v[64:67], a[24:27]
    v_mfma_f32_16x16x32_bf16 a[28:31], v[124:127], v[68:71], a[28:31]
    v_mfma_f32_16x16x32_bf16 a[32:35], v[128:131], v[56:59], a[32:35]
    v_mfma_f32_16x16x32_bf16 a[36:39], v[128:131], v[60:63], a[36:39]
    v_mfma_f32_16x16x32_bf16 a[40:43], v[128:131], v[64:67], a[40:43]
    v_mfma_f32_16x16x32_bf16 a[44:47], v[128:131], v[68:71], a[44:47]
    v_mfma_f32_16x16x32_bf16 a[48:51], v[132:135], v[56:59], a[48:51]
    v_mfma_f32_16x16x32_bf16 a[52:55], v[132:135], v[60:63], a[52:55]
    v_mfma_f32_16x16x32_bf16 a[56:59], v[132:135], v[64:67], a[56:59]
    v_mfma_f32_16x16x32_bf16 a[60:63], v[132:135], v[68:71], a[60:63]
    s_add_u32 m0, s72, 0x2000
    s_nop 0
    buffer_load_dwordx4 v136, s[44:47], s60 offen lds
    s_add_u32 m0, s72, 0x2400
    s_nop 0
    buffer_load_dwordx4 v137, s[44:47], s60 offen lds
    s_add_u32 m0, s72, 0x2800
    s_nop 0
    buffer_load_dwordx4 v138, s[44:47], s60 offen lds
    s_add_u32 m0, s72, 0x2c00
    s_nop 0
    buffer_load_dwordx4 v139, s[44:47], s60 offen lds
    s_add_u32 m0, s72, 0x3000
    s_nop 0
    buffer_load_dwordx4 v140, s[44:47], s60 offen lds
    s_add_u32 m0, s72, 0x3400
    s_nop 0
    buffer_load_dwordx4 v141, s[44:47], s60 offen lds
    s_add_u32 m0, s72, 0x3800
    s_nop 0
    buffer_load_dwordx4 v142, s[44:47], s60 offen lds
    s_add_u32 m0, s72, 0x3c00
    s_nop 0
    buffer_load_dwordx4 v143, s[44:47], s60 offen lds
    s_add_u32 s60, s60, 0x80
    buffer_load_dwordx4 v[120:123], v6, s[48:51], s61 offen
    buffer_load_dwordx4 v[124:127], v7, s[48:51], s61 offen
    buffer_load_dwordx4 v[128:131], v8, s[48:51], s61 offen
    buffer_load_dwordx4 v[132:135], v9, s[48:51], s61 offen
    s_add_u32 s61, s61, 0x400
    ds_read_b128 v[56:59], v145 offset:16384
    ds_read_b128 v[60:63], v145 offset:18432
    ds_read_b128 v[64:67], v145 offset:20480
    ds_read_b128 v[68:71], v145 offset:22528
    s_waitcnt lgkmcnt(4)
    s_waitcnt vmcnt(28)
    v_mfma_f32_16x16x32_bf16 a[0:3], v[72:75], v[40:43], a[0:3]
    v_mfma_f32_16x16x32_bf16 a[4:7], v[72:75], v[44:47], a[4:7]
    v_mfma_f32_16x16x32_bf16 a[8:11], v[72:75], v[48:51], a[8:11]
    v_mfma_f32_16x16x32_bf16 a[12:15], v[72:75], v[52:55], a[12:15]
    v_mfma_f32_16x16x32_bf16 a[16:19], v[76:79], v[40:43], a[16:19]
    v_mfma_f32_16x16x32_bf16 a[20:23], v[76:79], v[44:47], a[20:23]
    v_mfma_f32_16x16x32_bf16 a[24:27], v[76:79], v[48:51], a[24:27]
    v_mfma_f32_16x16x32_bf16 a[28:31], v[76:79], v[52:55], a[28:31]
    v_mfma_f32_16x16x32_bf16 a[32:35], v[80:83], v[40:43], a[32:35]
    v_mfma_f32_16x16x32_bf16 a[36:39], v[80:83], v[44:47], a[36:39]
    v_mfma_f32_16x16x32_bf16 a[40:43], v[80:83], v[48:51], a[40:43]
    v_mfma_f32_16x16x32_bf16 a[44:47], v[80:83], v[52:55], a[44:47]
    v_mfma_f32_16x16x32_bf16 a[48:51], v[84:87], v[40:43], a[48:51]
    v_mfma_f32_16x16x32_bf16 a[52:55], v[84:87], v[44:47], a[52:55]
    v_mfma_f32_16x16x32_bf16 a[56:59], v[84:87], v[48:51], a[56:59]
    v_mfma_f32_16x16x32_bf16 a[60:63], v[84:87], v[52:55], a[60:63]
    buffer_load_dwordx4 v[72:75], v6, s[48:51], s61 offen
    buffer_load_dwordx4 v[76:79], v7, s[48:51], s61 offen
    buffer_load_dwordx4 v[80:83], v8, s[48:51], s61 offen
    buffer_load_dwordx4 v[84:87], v9, s[48:51], s61 offen
    s_add_u32 s61, s61, 0x400
    s_waitcnt vmcnt(24)
    ds_read_b128 v[40:43], v144 offset:0
    ds_read_b128 v[44:47], v144 offset:2048
    ds_read_b128 v[48:51], v144 offset:4096
    ds_read_b128 v[52:55], v144 offset:6144
    s_waitcnt lgkmcnt(4)
    s_waitcnt vmcnt(20)
    v_mfma_f32_16x16x32_bf16 a[0:3], v[88:91], v[56:59], a[0:3]
    v_mfma_f32_16x16x32_bf16 a[4:7], v[88:91], v[60:63], a[4:7]
    v_mfma_f32_16x16x32_bf16 a[8:11], v[88:91], v[64:67], a[8:11]
    v_mfma_f32_16x16x32_bf16 a[12:15], v[88:91], v[68:71], a[12:15]
    v_mfma_f32_16x16x32_bf16 a[16:19], v[92:95], v[56:59], a[16:19]
    v_mfma_f32_16x16x32_bf16 a[20:23], v[92:95], v[60:63], a[20:23]
    v_mfma_f32_16x16x32_bf16 a[24:27], v[92:95], v[64:67], a[24:27]
    v_mfma_f32_16x16x32_bf16 a[28:31], v[92:95], v[68:71], a[28:31]
    v_mfma_f32_16x16x32_bf16 a[32:35], v[96:99], v[56:59], a[32:35]
    v_mfma_f32_16x16x32_bf16 a[36:39], v[96:99], v[60:63], a[36:39]
    v_mfma_f32_16x16x32_bf16 a[40:43], v[96:99], v[64:67], a[40:43]
    v_mfma_f32_16x16x32_bf16 a[44:47], v[96:99], v[68:71], a[44:47]
    v_mfma_f32_16x16x32_bf16 a[48:51], v[100:103], v[56:59], a[48:51]
    v_mfma_f32_16x16x32_bf16 a[52:55], v[100:103], v[60:63], a[52:55]
    v_mfma_f32_16x16x32_bf16 a[56:59], v[100:103], v[64:67], a[56:59]
    v_mfma_f32_16x16x32_bf16 a[60:63], v[100:103], v[68:71], a[60:63]
    s_add_u32 m0, s72, 0x4000
    s_nop 0
    buffer_load_dwordx4 v136, s[44:47], s60 offen lds
    s_add_u32 m0, s72, 0x4400
    s_nop 0
    buffer_load_dwordx4 v137, s[44:47], s60 offen lds
    s_add_u32 m0, s72, 0x4800
    s_nop 0
    buffer_load_dwordx4 v138, s[44:47], s60 offen lds
    s_add_u32 m0, s72, 0x4c00
    s_nop 0
    buffer_load_dwordx4 v139, s[44:47], s60 offen lds
    s_add_u32 m0, s72, 0x5000
    s_nop 0
    buffer_load_dwordx4 v140, s[44:47], s60 offen lds
    s_add_u32 m0, s72, 0x5400
    s_nop 0
    buffer_load_dwordx4 v141, s[44:47], s60 offen lds
    s_add_u32 m0, s72, 0x5800
    s_nop 0
    buffer_load_dwordx4 v142, s[44:47], s60 offen lds
    s_add_u32 m0, s72, 0x5c00
    s_nop 0
    buffer_load_dwordx4 v143, s[44:47], s60 offen lds
    s_add_u32 s60, s60, 0x80
    buffer_load_dwordx4 v[88:91], v6, s[48:51], s61 offen
    buffer_load_dwordx4 v[92:95], v7, s[48:51], s61 offen
    buffer_load_dwordx4 v[96:99], v8, s[48:51], s61 offen
    buffer_load_dwordx4 v[100:103], v9, s[48:51], s61 offen
    s_add_u32 s61, s61, 0x400
    ds_read_b128 v[56:59], v145 offset:0
    ds_read_b128 v[60:63], v145 offset:2048
    ds_read_b128 v[64:67], v145 offset:4096
    ds_read_b128 v[68:71], v145 offset:6144
    s_waitcnt lgkmcnt(4)
    s_waitcnt vmcnt(28)
    v_mfma_f32_16x16x32_bf16 a[0:3], v[104:107], v[40:43], a[0:3]
    v_mfma_f32_16x16x32_bf16 a[4:7], v[104:107], v[44:47], a[4:7]
    v_mfma_f32_16x16x32_bf16 a[8:11], v[104:107], v[48:51], a[8:11]
    v_mfma_f32_16x16x32_bf16 a[12:15], v[104:107], v[52:55], a[12:15]
    v_mfma_f32_16x16x32_bf16 a[16:19], v[108:111], v[40:43], a[16:19]
    v_mfma_f32_16x16x32_bf16 a[20:23], v[108:111], v[44:47], a[20:23]
    v_mfma_f32_16x16x32_bf16 a[24:27], v[108:111], v[48:51], a[24:27]
    v_mfma_f32_16x16x32_bf16 a[28:31], v[108:111], v[52:55], a[28:31]
    v_mfma_f32_16x16x32_bf16 a[32:35], v[112:115], v[40:43], a[32:35]
    v_mfma_f32_16x16x32_bf16 a[36:39], v[112:115], v[44:47], a[36:39]
    v_mfma_f32_16x16x32_bf16 a[40:43], v[112:115], v[48:51], a[40:43]
    v_mfma_f32_16x16x32_bf16 a[44:47], v[112:115], v[52:55], a[44:47]
    v_mfma_f32_16x16x32_bf16 a[48:51], v[116:119], v[40:43], a[48:51]
    v_mfma_f32_16x16x32_bf16 a[52:55], v[116:119], v[44:47], a[52:55]
    v_mfma_f32_16x16x32_bf16 a[56:59], v[116:119], v[48:51], a[56:59]
    v_mfma_f32_16x16x32_bf16 a[60:63], v[116:119], v[52:55], a[60:63]
    buffer_load_dwordx4 v[104:107], v6, s[48:51], s61 offen
    buffer_load_dwordx4 v[108:111], v7, s[48:51], s61 offen
    buffer_load_dwordx4 v[112:115], v8, s[48:51], s61 offen
    buffer_load_dwordx4 v[116:119], v9, s[48:51], s61 offen
    s_add_u32 s61, s61, 0x400
    s_waitcnt vmcnt(24)
    ds_read_b128 v[40:43], v144 offset:8192
    ds_read_b128 v[44:47], v144 offset:10240
    ds_read_b128 v[48:51], v144 offset:12288
    ds_read_b128 v[52:55], v144 offset:14336
    s_waitcnt lgkmcnt(4)
    s_waitcnt vmcnt(20)
    v_mfma_f32_16x16x32_bf16 a[0:3], v[120:123], v[56:59], a[0:3]
    v_mfma_f32_16x16x32_bf16 a[4:7], v[120:123], v[60:63], a[4:7]
    v_mfma_f32_16x16x32_bf16 a[8:11], v[120:123], v[64:67], a[8:11]
    v_mfma_f32_16x16x32_bf16 a[12:15], v[120:123], v[68:71], a[12:15]
    v_mfma_f32_16x16x32_bf16 a[16:19], v[124:127], v[56:59], a[16:19]
    v_mfma_f32_16x16x32_bf16 a[20:23], v[124:127], v[60:63], a[20:23]
    v_mfma_f32_16x16x32_bf16 a[24:27], v[124:127], v[64:67], a[24:27]
    v_mfma_f32_16x16x32_bf16 a[28:31], v[124:127], v[68:71], a[28:31]
    v_mfma_f32_16x16x32_bf16 a[32:35], v[128:131], v[56:59], a[32:35]
    v_mfma_f32_16x16x32_bf16 a[36:39], v[128:131], v[60:63], a[36:39]
    v_mfma_f32_16x16x32_bf16 a[40:43], v[128:131], v[64:67], a[40:43]
    v_mfma_f32_16x16x32_bf16 a[44:47], v[128:131], v[68:71], a[44:47]
    v_mfma_f32_16x16x32_bf16 a[48:51], v[132:135], v[56:59], a[48:51]
    v_mfma_f32_16x16x32_bf16 a[52:55], v[132:135], v[60:63], a[52:55]
    v_mfma_f32_16x16x32_bf16 a[56:59], v[132:135], v[64:67], a[56:59]
    v_mfma_f32_16x16x32_bf16 a[60:63], v[132:135], v[68:71], a[60:63]
    s_add_u32 m0, s72, 0x0
    s_nop 0
    buffer_load_dwordx4 v136, s[44:47], s60 offen lds
    s_add_u32 m0, s72, 0x400
    s_nop 0
    buffer_load_dwordx4 v137, s[44:47], s60 offen lds
    s_add_u32 m0, s72, 0x800
    s_nop 0
    buffer_load_dwordx4 v138, s[44:47], s60 offen lds
    s_add_u32 m0, s72, 0xc00
    s_nop 0
    buffer_load_dwordx4 v139, s[44:47], s60 offen lds
    s_add_u32 m0, s72, 0x1000
    s_nop 0
    buffer_load_dwordx4 v140, s[44:47], s60 offen lds
    s_add_u32 m0, s72, 0x1400
    s_nop 0
    buffer_load_dwordx4 v141, s[44:47], s60 offen lds
    s_add_u32 m0, s72, 0x1800
    s_nop 0
    buffer_load_dwordx4 v142, s[44:47], s60 offen lds
    s_add_u32 m0, s72, 0x1c00
    s_nop 0
    buffer_load_dwordx4 v143, s[44:47], s60 offen lds
    s_add_u32 s60, s60, 0x80
    buffer_load_dwordx4 v[120:123], v6, s[48:51], s61 offen
    buffer_load_dwordx4 v[124:127], v7, s[48:51], s61 offen
    buffer_load_dwordx4 v[128:131], v8, s[48:51], s61 offen
    buffer_load_dwordx4 v[132:135], v9, s[48:51], s61 offen
    s_add_u32 s61, s61, 0x400
    ds_read_b128 v[56:59], v145 offset:8192
    ds_read_b128 v[60:63], v145 offset:10240
    ds_read_b128 v[64:67], v145 offset:12288
    ds_read_b128 v[68:71], v145 offset:14336
    s_waitcnt lgkmcnt(4)
    s_waitcnt vmcnt(28)
    v_mfma_f32_16x16x32_bf16 a[0:3], v[72:75], v[40:43], a[0:3]
    v_mfma_f32_16x16x32_bf16 a[4:7], v[72:75], v[44:47], a[4:7]
    v_mfma_f32_16x16x32_bf16 a[8:11], v[72:75], v[48:51], a[8:11]
    v_mfma_f32_16x16x32_bf16 a[12:15], v[72:75], v[52:55], a[12:15]
    v_mfma_f32_16x16x32_bf16 a[16:19], v[76:79], v[40:43], a[16:19]
    v_mfma_f32_16x16x32_bf16 a[20:23], v[76:79], v[44:47], a[20:23]
    v_mfma_f32_16x16x32_bf16 a[24:27], v[76:79], v[48:51], a[24:27]
    v_mfma_f32_16x16x32_bf16 a[28:31], v[76:79], v[52:55], a[28:31]
    v_mfma_f32_16x16x32_bf16 a[32:35], v[80:83], v[40:43], a[32:35]
    v_mfma_f32_16x16x32_bf16 a[36:39], v[80:83], v[44:47], a[36:39]
    v_mfma_f32_16x16x32_bf16 a[40:43], v[80:83], v[48:51], a[40:43]
    v_mfma_f32_16x16x32_bf16 a[44:47], v[80:83], v[52:55], a[44:47]
    v_mfma_f32_16x16x32_bf16 a[48:51], v[84:87], v[40:43], a[48:51]
    v_mfma_f32_16x16x32_bf16 a[52:55], v[84:87], v[44:47], a[52:55]
    v_mfma_f32_16x16x32_bf16 a[56:59], v[84:87], v[48:51], a[56:59]
    v_mfma_f32_16x16x32_bf16 a[60:63], v[84:87], v[52:55], a[60:63]
    buffer_load_dwordx4 v[72:75], v6, s[48:51], s61 offen
    buffer_load_dwordx4 v[76:79], v7, s[48:51], s61 offen
    buffer_load_dwordx4 v[80:83], v8, s[48:51], s61 offen
    buffer_load_dwordx4 v[84:87], v9, s[48:51], s61 offen
    s_add_u32 s61, s61, 0x400
    s_waitcnt vmcnt(24)
    ds_read_b128 v[40:43], v144 offset:16384
    ds_read_b128 v[44:47], v144 offset:18432
    ds_read_b128 v[48:51], v144 offset:20480
    ds_read_b128 v[52:55], v144 offset:22528
    s_waitcnt lgkmcnt(4)
    s_waitcnt vmcnt(20)
    v_mfma_f32_16x16x32_bf16 a[0:3], v[88:91], v[56:59], a[0:3]
    v_mfma_f32_16x16x32_bf16 a[4:7], v[88:91], v[60:63], a[4:7]
    v_mfma_f32_16x16x32_bf16 a[8:11], v[88:91], v[64:67], a[8:11]
    v_mfma_f32_16x16x32_bf16 a[12:15], v[88:91], v[68:71], a[12:15]
    v_mfma_f32_16x16x32_bf16 a[16:19], v[92:95], v[56:59], a[16:19]
    v_mfma_f32_16x16x32_bf16 a[20:23], v[92:95], v[60:63], a[20:23]
    v_mfma_f32_16x16x32_bf16 a[24:27], v[92:95], v[64:67], a[24:27]
    v_mfma_f32_16x16x32_bf16 a[28:31], v[92:95], v[68:71], a[28:31]
    v_mfma_f32_16x16x32_bf16 a[32:35], v[96:99], v[56:59], a[32:35]
    v_mfma_f32_16x16x32_bf16 a[36:39], v[96:99], v[60:63], a[36:39]
    v_mfma_f32_16x16x32_bf16 a[40:43], v[96:99], v[64:67], a[40:43]
    v_mfma_f32_16x16x32_bf16 a[44:47], v[96:99], v[68:71], a[44:47]
    v_mfma_f32_16x16x32_bf16 a[48:51], v[100:103], v[56:59], a[48:51]
    v_mfma_f32_16x16x32_bf16 a[52:55], v[100:103], v[60:63], a[52:55]
    v_mfma_f32_16x16x32_bf16 a[56:59], v[100:103], v[64:67], a[56:59]
    v_mfma_f32_16x16x32_bf16 a[60:63], v[100:103], v[68:71], a[60:63]
    s_add_u32 m0, s72, 0x2000
    s_nop 0
    buffer_load_dwordx4 v136, s[44:47], s60 offen lds
    s_add_u32 m0, s72, 0x2400
    s_nop 0
    buffer_load_dwordx4 v137, s[44:47], s60 offen lds
    s_add_u32 m0, s72, 0x2800
    s_nop 0
    buffer_load_dwordx4 v138, s[44:47], s60 offen lds
    s_add_u32 m0, s72, 0x2c00
    s_nop 0
    buffer_load_dwordx4 v139, s[44:47], s60 offen lds
    s_add_u32 m0, s72, 0x3000
    s_nop 0
    buffer_load_dwordx4 v140, s[44:47], s60 offen lds
    s_add_u32 m0, s72, 0x3400
    s_nop 0
    buffer_load_dwordx4 v141, s[44:47], s60 offen lds
    s_add_u32 m0, s72, 0x3800
    s_nop 0
    buffer_load_dwordx4 v142, s[44:47], s60 offen lds
    s_add_u32 m0, s72, 0x3c00
    s_nop 0
    buffer_load_dwordx4 v143, s[44:47], s60 offen lds
    s_add_u32 s60, s60, 0x80
    buffer_load_dwordx4 v[88:91], v6, s[48:51], s61 offen
    buffer_load_dwordx4 v[92:95], v7, s[48:51], s61 offen
    buffer_load_dwordx4 v[96:99], v8, s[48:51], s61 offen
    buffer_load_dwordx4 v[100:103], v9, s[48:51], s61 offen
    s_add_u32 s61, s61, 0x400
    ds_read_b128 v[56:59], v145 offset:16384
    ds_read_b128 v[60:63], v145 offset:18432
    ds_read_b128 v[64:67], v145 offset:20480
    ds_read_b128 v[68:71], v145 offset:22528
    s_waitcnt lgkmcnt(4)
    s_waitcnt vmcnt(28)
    v_mfma_f32_16x16x32_bf16 a[0:3], v[104:107], v[40:43], a[0:3]
    v_mfma_f32_16x16x32_bf16 a[4:7], v[104:107], v[44:47], a[4:7]
    v_mfma_f32_16x16x32_bf16 a[8:11], v[104:107], v[48:51], a[8:11]
    v_mfma_f32_16x16x32_bf16 a[12:15], v[104:107], v[52:55], a[12:15]
    v_mfma_f32_16x16x32_bf16 a[16:19], v[108:111], v[40:43], a[16:19]
    v_mfma_f32_16x16x32_bf16 a[20:23], v[108:111], v[44:47], a[20:23]
    v_mfma_f32_16x16x32_bf16 a[24:27], v[108:111], v[48:51], a[24:27]
    v_mfma_f32_16x16x32_bf16 a[28:31], v[108:111], v[52:55], a[28:31]
    v_mfma_f32_16x16x32_bf16 a[32:35], v[112:115], v[40:43], a[32:35]
    v_mfma_f32_16x16x32_bf16 a[36:39], v[112:115], v[44:47], a[36:39]
    v_mfma_f32_16x16x32_bf16 a[40:43], v[112:115], v[48:51], a[40:43]
    v_mfma_f32_16x16x32_bf16 a[44:47], v[112:115], v[52:55], a[44:47]
    v_mfma_f32_16x16x32_bf16 a[48:51], v[116:119], v[40:43], a[48:51]
    v_mfma_f32_16x16x32_bf16 a[52:55], v[116:119], v[44:47], a[52:55]
    v_mfma_f32_16x16x32_bf16 a[56:59], v[116:119], v[48:51], a[56:59]
    v_mfma_f32_16x16x32_bf16 a[60:63], v[116:119], v[52:55], a[60:63]
    buffer_load_dwordx4 v[104:107], v6, s[48:51], s61 offen
    buffer_load_dwordx4 v[108:111], v7, s[48:51], s61 offen
    buffer_load_dwordx4 v[112:115], v8, s[48:51], s61 offen
    buffer_load_dwordx4 v[116:119], v9, s[48:51], s61 offen
    s_add_u32 s61, s61, 0x400
    s_waitcnt vmcnt(24)
    ds_read_b128 v[40:43], v144 offset:0
    ds_read_b128 v[44:47], v144 offset:2048
    ds_read_b128 v[48:51], v144 offset:4096
    ds_read_b128 v[52:55], v144 offset:6144
    s_waitcnt lgkmcnt(4)
    s_waitcnt vmcnt(20)
    v_mfma_f32_16x16x32_bf16 a[0:3], v[120:123], v[56:59], a[0:3]
    v_mfma_f32_16x16x32_bf16 a[4:7], v[120:123], v[60:63], a[4:7]
    v_mfma_f32_16x16x32_bf16 a[8:11], v[120:123], v[64:67], a[8:11]
    v_mfma_f32_16x16x32_bf16 a[12:15], v[120:123], v[68:71], a[12:15]
    v_mfma_f32_16x16x32_bf16 a[16:19], v[124:127], v[56:59], a[16:19]
    v_mfma_f32_16x16x32_bf16 a[20:23], v[124:127], v[60:63], a[20:23]
    v_mfma_f32_16x16x32_bf16 a[24:27], v[124:127], v[64:67], a[24:27]
    v_mfma_f32_16x16x32_bf16 a[28:31], v[124:127], v[68:71], a[28:31]
    v_mfma_f32_16x16x32_bf16 a[32:35], v[128:131], v[56:59], a[32:35]
    v_mfma_f32_16x16x32_bf16 a[36:39], v[128:131], v[60:63], a[36:39]
    v_mfma_f32_16x16x32_bf16 a[40:43], v[128:131], v[64:67], a[40:43]
    v_mfma_f32_16x16x32_bf16 a[44:47], v[128:131], v[68:71], a[44:47]
    v_mfma_f32_16x16x32_bf16 a[48:51], v[132:135], v[56:59], a[48:51]
    v_mfma_f32_16x16x32_bf16 a[52:55], v[132:135], v[60:63], a[52:55]
    v_mfma_f32_16x16x32_bf16 a[56:59], v[132:135], v[64:67], a[56:59]
    v_mfma_f32_16x16x32_bf16 a[60:63], v[132:135], v[68:71], a[60:63]
    s_add_u32 m0, s72, 0x4000
    s_nop 0
    buffer_load_dwordx4 v136, s[44:47], s60 offen lds
    s_add_u32 m0, s72, 0x4400
    s_nop 0
    buffer_load_dwordx4 v137, s[44:47], s60 offen lds
    s_add_u32 m0, s72, 0x4800
    s_nop 0
    buffer_load_dwordx4 v138, s[44:47], s60 offen lds
    s_add_u32 m0, s72, 0x4c00
    s_nop 0
    buffer_load_dwordx4 v139, s[44:47], s60 offen lds
    s_add_u32 m0, s72, 0x5000
    s_nop 0
    buffer_load_dwordx4 v140, s[44:47], s60 offen lds
    s_add_u32 m0, s72, 0x5400
    s_nop 0
    buffer_load_dwordx4 v141, s[44:47], s60 offen lds
    s_add_u32 m0, s72, 0x5800
    s_nop 0
    buffer_load_dwordx4 v142, s[44:47], s60 offen lds
    s_add_u32 m0, s72, 0x5c00
    s_nop 0
    buffer_load_dwordx4 v143, s[44:47], s60 offen lds
    s_add_u32 s60, s60, 0x80
    buffer_load_dwordx4 v[120:123], v6, s[48:51], s61 offen
    buffer_load_dwordx4 v[124:127], v7, s[48:51], s61 offen
    buffer_load_dwordx4 v[128:131], v8, s[48:51], s61 offen
    buffer_load_dwordx4 v[132:135], v9, s[48:51], s61 offen
    s_add_u32 s61, s61, 0x400
    ds_read_b128 v[56:59], v145 offset:0
    ds_read_b128 v[60:63], v145 offset:2048
    ds_read_b128 v[64:67], v145 offset:4096
    ds_read_b128 v[68:71], v145 offset:6144
    s_waitcnt lgkmcnt(4)
    s_waitcnt vmcnt(28)
    v_mfma_f32_16x16x32_bf16 a[0:3], v[72:75], v[40:43], a[0:3]
    v_mfma_f32_16x16x32_bf16 a[4:7], v[72:75], v[44:47], a[4:7]
    v_mfma_f32_16x16x32_bf16 a[8:11], v[72:75], v[48:51], a[8:11]
    v_mfma_f32_16x16x32_bf16 a[12:15], v[72:75], v[52:55], a[12:15]
    v_mfma_f32_16x16x32_bf16 a[16:19], v[76:79], v[40:43], a[16:19]
    v_mfma_f32_16x16x32_bf16 a[20:23], v[76:79], v[44:47], a[20:23]
    v_mfma_f32_16x16x32_bf16 a[24:27], v[76:79], v[48:51], a[24:27]
    v_mfma_f32_16x16x32_bf16 a[28:31], v[76:79], v[52:55], a[28:31]
    v_mfma_f32_16x16x32_bf16 a[32:35], v[80:83], v[40:43], a[32:35]
    v_mfma_f32_16x16x32_bf16 a[36:39], v[80:83], v[44:47], a[36:39]
    v_mfma_f32_16x16x32_bf16 a[40:43], v[80:83], v[48:51], a[40:43]
    v_mfma_f32_16x16x32_bf16 a[44:47], v[80:83], v[52:55], a[44:47]
    v_mfma_f32_16x16x32_bf16 a[48:51], v[84:87], v[40:43], a[48:51]
    v_mfma_f32_16x16x32_bf16 a[52:55], v[84:87], v[44:47], a[52:55]
    v_mfma_f32_16x16x32_bf16 a[56:59], v[84:87], v[48:51], a[56:59]
    v_mfma_f32_16x16x32_bf16 a[60:63], v[84:87], v[52:55], a[60:63]
    buffer_load_dwordx4 v[72:75], v6, s[48:51], s61 offen
    buffer_load_dwordx4 v[76:79], v7, s[48:51], s61 offen
    buffer_load_dwordx4 v[80:83], v8, s[48:51], s61 offen
    buffer_load_dwordx4 v[84:87], v9, s[48:51], s61 offen
    s_add_u32 s61, s61, 0x400
    s_waitcnt vmcnt(24)
    ds_read_b128 v[40:43], v144 offset:8192
    ds_read_b128 v[44:47], v144 offset:10240
    ds_read_b128 v[48:51], v144 offset:12288
    ds_read_b128 v[52:55], v144 offset:14336
    s_waitcnt lgkmcnt(4)
    s_waitcnt vmcnt(20)
    v_mfma_f32_16x16x32_bf16 a[0:3], v[88:91], v[56:59], a[0:3]
    v_mfma_f32_16x16x32_bf16 a[4:7], v[88:91], v[60:63], a[4:7]
    v_mfma_f32_16x16x32_bf16 a[8:11], v[88:91], v[64:67], a[8:11]
    v_mfma_f32_16x16x32_bf16 a[12:15], v[88:91], v[68:71], a[12:15]
    v_mfma_f32_16x16x32_bf16 a[16:19], v[92:95], v[56:59], a[16:19]
    v_mfma_f32_16x16x32_bf16 a[20:23], v[92:95], v[60:63], a[20:23]
    v_mfma_f32_16x16x32_bf16 a[24:27], v[92:95], v[64:67], a[24:27]
    v_mfma_f32_16x16x32_bf16 a[28:31], v[92:95], v[68:71], a[28:31]
    v_mfma_f32_16x16x32_bf16 a[32:35], v[96:99], v[56:59], a[32:35]
    v_mfma_f32_16x16x32_bf16 a[36:39], v[96:99], v[60:63], a[36:39]
    v_mfma_f32_16x16x32_bf16 a[40:43], v[96:99], v[64:67], a[40:43]
    v_mfma_f32_16x16x32_bf16 a[44:47], v[96:99], v[68:71], a[44:47]
    v_mfma_f32_16x16x32_bf16 a[48:51], v[100:103], v[56:59], a[48:51]
    v_mfma_f32_16x16x32_bf16 a[52:55], v[100:103], v[60:63], a[52:55]
    v_mfma_f32_16x16x32_bf16 a[56:59], v[100:103], v[64:67], a[56:59]
    v_mfma_f32_16x16x32_bf16 a[60:63], v[100:103], v[68:71], a[60:63]
    s_add_u32 m0, s72, 0x0
    s_nop 0
    buffer_load_dwordx4 v136, s[44:47], s60 offen lds
    s_add_u32 m0, s72, 0x400
    s_nop 0
    buffer_load_dwordx4 v137, s[44:47], s60 offen lds
    s_add_u32 m0, s72, 0x800
    s_nop 0
    buffer_load_dwordx4 v138, s[44:47], s60 offen lds
    s_add_u32 m0, s72, 0xc00
    s_nop 0
    buffer_load_dwordx4 v139, s[44:47], s60 offen lds
    s_add_u32 m0, s72, 0x1000
    s_nop 0
    buffer_load_dwordx4 v140, s[44:47], s60 offen lds
    s_add_u32 m0, s72, 0x1400
    s_nop 0
    buffer_load_dwordx4 v141, s[44:47], s60 offen lds
    s_add_u32 m0, s72, 0x1800
    s_nop 0
    buffer_load_dwordx4 v142, s[44:47], s60 offen lds
    s_add_u32 m0, s72, 0x1c00
    s_nop 0
    buffer_load_dwordx4 v143, s[44:47], s60 offen lds
    s_add_u32 s60, s60, 0x80
    buffer_load_dwordx4 v[88:91], v6, s[48:51], s61 offen
    buffer_load_dwordx4 v[92:95], v7, s[48:51], s61 offen
    buffer_load_dwordx4 v[96:99], v8, s[48:51], s61 offen
    buffer_load_dwordx4 v[100:103], v9, s[48:51], s61 offen
    s_add_u32 s61, s61, 0x400
    ds_read_b128 v[56:59], v145 offset:8192
    ds_read_b128 v[60:63], v145 offset:10240
    ds_read_b128 v[64:67], v145 offset:12288
    ds_read_b128 v[68:71], v145 offset:14336
    s_waitcnt lgkmcnt(4)
    s_waitcnt vmcnt(28)
    v_mfma_f32_16x16x32_bf16 a[0:3], v[104:107], v[40:43], a[0:3]
    v_mfma_f32_16x16x32_bf16 a[4:7], v[104:107], v[44:47], a[4:7]
    v_mfma_f32_16x16x32_bf16 a[8:11], v[104:107], v[48:51], a[8:11]
    v_mfma_f32_16x16x32_bf16 a[12:15], v[104:107], v[52:55], a[12:15]
    v_mfma_f32_16x16x32_bf16 a[16:19], v[108:111], v[40:43], a[16:19]
    v_mfma_f32_16x16x32_bf16 a[20:23], v[108:111], v[44:47], a[20:23]
    v_mfma_f32_16x16x32_bf16 a[24:27], v[108:111], v[48:51], a[24:27]
    v_mfma_f32_16x16x32_bf16 a[28:31], v[108:111], v[52:55], a[28:31]
    v_mfma_f32_16x16x32_bf16 a[32:35], v[112:115], v[40:43], a[32:35]
    v_mfma_f32_16x16x32_bf16 a[36:39], v[112:115], v[44:47], a[36:39]
    v_mfma_f32_16x16x32_bf16 a[40:43], v[112:115], v[48:51], a[40:43]
    v_mfma_f32_16x16x32_bf16 a[44:47], v[112:115], v[52:55], a[44:47]
    v_mfma_f32_16x16x32_bf16 a[48:51], v[116:119], v[40:43], a[48:51]
    v_mfma_f32_16x16x32_bf16 a[52:55], v[116:119], v[44:47], a[52:55]
    v_mfma_f32_16x16x32_bf16 a[56:59], v[116:119], v[48:51], a[56:59]
    v_mfma_f32_16x16x32_bf16 a[60:63], v[116:119], v[52:55], a[60:63]
    buffer_load_dwordx4 v[104:107], v6, s[48:51], s61 offen
    buffer_load_dwordx4 v[108:111], v7, s[48:51], s61 offen
    buffer_load_dwordx4 v[112:115], v8, s[48:51], s61 offen
    buffer_load_dwordx4 v[116:119], v9, s[48:51], s61 offen
    s_add_u32 s61, s61, 0x400
    s_waitcnt vmcnt(24)
    ds_read_b128 v[40:43], v144 offset:16384
    ds_read_b128 v[44:47], v144 offset:18432
    ds_read_b128 v[48:51], v144 offset:20480
    ds_read_b128 v[52:55], v144 offset:22528
    s_waitcnt lgkmcnt(4)
    s_waitcnt vmcnt(20)
    v_mfma_f32_16x16x32_bf16 a[0:3], v[120:123], v[56:59], a[0:3]
    v_mfma_f32_16x16x32_bf16 a[4:7], v[120:123], v[60:63], a[4:7]
    v_mfma_f32_16x16x32_bf16 a[8:11], v[120:123], v[64:67], a[8:11]
    v_mfma_f32_16x16x32_bf16 a[12:15], v[120:123], v[68:71], a[12:15]
    v_mfma_f32_16x16x32_bf16 a[16:19], v[124:127], v[56:59], a[16:19]
    v_mfma_f32_16x16x32_bf16 a[20:23], v[124:127], v[60:63], a[20:23]
    v_mfma_f32_16x16x32_bf16 a[24:27], v[124:127], v[64:67], a[24:27]
    v_mfma_f32_16x16x32_bf16 a[28:31], v[124:127], v[68:71], a[28:31]
    v_mfma_f32_16x16x32_bf16 a[32:35], v[128:131], v[56:59], a[32:35]
    v_mfma_f32_16x16x32_bf16 a[36:39], v[128:131], v[60:63], a[36:39]
    v_mfma_f32_16x16x32_bf16 a[40:43], v[128:131], v[64:67], a[40:43]
    v_mfma_f32_16x16x32_bf16 a[44:47], v[128:131], v[68:71], a[44:47]
    v_mfma_f32_16x16x32_bf16 a[48:51], v[132:135], v[56:59], a[48:51]
    v_mfma_f32_16x16x32_bf16 a[52:55], v[132:135], v[60:63], a[52:55]
    v_mfma_f32_16x16x32_bf16 a[56:59], v[132:135], v[64:67], a[56:59]
    v_mfma_f32_16x16x32_bf16 a[60:63], v[132:135], v[68:71], a[60:63]
    buffer_load_dwordx4 v[120:123], v6, s[48:51], s61 offen
    buffer_load_dwordx4 v[124:127], v7, s[48:51], s61 offen
    buffer_load_dwordx4 v[128:131], v8, s[48:51], s61 offen
    buffer_load_dwordx4 v[132:135], v9, s[48:51], s61 offen
    s_add_u32 s61, s61, 0x400
    ds_read_b128 v[56:59], v145 offset:16384
    ds_read_b128 v[60:63], v145 offset:18432
    ds_read_b128 v[64:67], v145 offset:20480
    ds_read_b128 v[68:71], v145 offset:22528
    s_waitcnt lgkmcnt(4)
    s_waitcnt vmcnt(20)
    v_mfma_f32_16x16x32_bf16 a[0:3], v[72:75], v[40:43], a[0:3]
    v_mfma_f32_16x16x32_bf16 a[4:7], v[72:75], v[44:47], a[4:7]
    v_mfma_f32_16x16x32_bf16 a[8:11], v[72:75], v[48:51], a[8:11]
    v_mfma_f32_16x16x32_bf16 a[12:15], v[72:75], v[52:55], a[12:15]
    v_mfma_f32_16x16x32_bf16 a[16:19], v[76:79], v[40:43], a[16:19]
    v_mfma_f32_16x16x32_bf16 a[20:23], v[76:79], v[44:47], a[20:23]
    v_mfma_f32_16x16x32_bf16 a[24:27], v[76:79], v[48:51], a[24:27]
    v_mfma_f32_16x16x32_bf16 a[28:31], v[76:79], v[52:55], a[28:31]
    v_mfma_f32_16x16x32_bf16 a[32:35], v[80:83], v[40:43], a[32:35]
    v_mfma_f32_16x16x32_bf16 a[36:39], v[80:83], v[44:47], a[36:39]
    v_mfma_f32_16x16x32_bf16 a[40:43], v[80:83], v[48:51], a[40:43]
    v_mfma_f32_16x16x32_bf16 a[44:47], v[80:83], v[52:55], a[44:47]
    v_mfma_f32_16x16x32_bf16 a[48:51], v[84:87], v[40:43], a[48:51]
    v_mfma_f32_16x16x32_bf16 a[52:55], v[84:87], v[44:47], a[52:55]
    v_mfma_f32_16x16x32_bf16 a[56:59], v[84:87], v[48:51], a[56:59]
    v_mfma_f32_16x16x32_bf16 a[60:63], v[84:87], v[52:55], a[60:63]
    s_waitcnt vmcnt(12)
    ds_read_b128 v[40:43], v144 offset:0
    ds_read_b128 v[44:47], v144 offset:2048
    ds_read_b128 v[48:51], v144 offset:4096
    ds_read_b128 v[52:55], v144 offset:6144
    s_waitcnt lgkmcnt(4)
    s_waitcnt vmcnt(8)
    v_mfma_f32_16x16x32_bf16 a[0:3], v[88:91], v[56:59], a[0:3]
    v_mfma_f32_16x16x32_bf16 a[4:7], v[88:91], v[60:63], a[4:7]
    v_mfma_f32_16x16x32_bf16 a[8:11], v[88:91], v[64:67], a[8:11]
    v_mfma_f32_16x16x32_bf16 a[12:15], v[88:91], v[68:71], a[12:15]
    v_mfma_f32_16x16x32_bf16 a[16:19], v[92:95], v[56:59], a[16:19]
    v_mfma_f32_16x16x32_bf16 a[20:23], v[92:95], v[60:63], a[20:23]
    v_mfma_f32_16x16x32_bf16 a[24:27], v[92:95], v[64:67], a[24:27]
    v_mfma_f32_16x16x32_bf16 a[28:31], v[92:95], v[68:71], a[28:31]
    v_mfma_f32_16x16x32_bf16 a[32:35], v[96:99], v[56:59], a[32:35]
    v_mfma_f32_16x16x32_bf16 a[36:39], v[96:99], v[60:63], a[36:39]
    v_mfma_f32_16x16x32_bf16 a[40:43], v[96:99], v[64:67], a[40:43]
    v_mfma_f32_16x16x32_bf16 a[44:47], v[96:99], v[68:71], a[44:47]
    v_mfma_f32_16x16x32_bf16 a[48:51], v[100:103], v[56:59], a[48:51]
    v_mfma_f32_16x16x32_bf16 a[52:55], v[100:103], v[60:63], a[52:55]
    v_mfma_f32_16x16x32_bf16 a[56:59], v[100:103], v[64:67], a[56:59]
    v_mfma_f32_16x16x32_bf16 a[60:63], v[100:103], v[68:71], a[60:63]
    ds_read_b128 v[56:59], v145 offset:0
    ds_read_b128 v[60:63], v145 offset:2048
    ds_read_b128 v[64:67], v145 offset:4096
    ds_read_b128 v[68:71], v145 offset:6144
    s_waitcnt lgkmcnt(4)
    s_waitcnt vmcnt(4)
    v_mfma_f32_16x16x32_bf16 a[0:3], v[104:107], v[40:43], a[0:3]
    v_mfma_f32_16x16x32_bf16 a[4:7], v[104:107], v[44:47], a[4:7]
    v_mfma_f32_16x16x32_bf16 a[8:11], v[104:107], v[48:51], a[8:11]
    v_mfma_f32_16x16x32_bf16 a[12:15], v[104:107], v[52:55], a[12:15]
    v_mfma_f32_16x16x32_bf16 a[16:19], v[108:111], v[40:43], a[16:19]
    v_mfma_f32_16x16x32_bf16 a[20:23], v[108:111], v[44:47], a[20:23]
    v_mfma_f32_16x16x32_bf16 a[24:27], v[108:111], v[48:51], a[24:27]
    v_mfma_f32_16x16x32_bf16 a[28:31], v[108:111], v[52:55], a[28:31]
    v_mfma_f32_16x16x32_bf16 a[32:35], v[112:115], v[40:43], a[32:35]
    v_mfma_f32_16x16x32_bf16 a[36:39], v[112:115], v[44:47], a[36:39]
    v_mfma_f32_16x16x32_bf16 a[40:43], v[112:115], v[48:51], a[40:43]
    v_mfma_f32_16x16x32_bf16 a[44:47], v[112:115], v[52:55], a[44:47]
    v_mfma_f32_16x16x32_bf16 a[48:51], v[116:119], v[40:43], a[48:51]
    v_mfma_f32_16x16x32_bf16 a[52:55], v[116:119], v[44:47], a[52:55]
    v_mfma_f32_16x16x32_bf16 a[56:59], v[116:119], v[48:51], a[56:59]
    v_mfma_f32_16x16x32_bf16 a[60:63], v[116:119], v[52:55], a[60:63]
    s_waitcnt lgkmcnt(0)
    s_waitcnt vmcnt(0)
    v_mfma_f32_16x16x32_bf16 a[0:3], v[120:123], v[56:59], a[0:3]
    v_mfma_f32_16x16x32_bf16 a[4:7], v[120:123], v[60:63], a[4:7]
    v_mfma_f32_16x16x32_bf16 a[8:11], v[120:123], v[64:67], a[8:11]
    v_mfma_f32_16x16x32_bf16 a[12:15], v[120:123], v[68:71], a[12:15]
    v_mfma_f32_16x16x32_bf16 a[16:19], v[124:127], v[56:59], a[16:19]
    v_mfma_f32_16x16x32_bf16 a[20:23], v[124:127], v[60:63], a[20:23]
    v_mfma_f32_16x16x32_bf16 a[24:27], v[124:127], v[64:67], a[24:27]
    v_mfma_f32_16x16x32_bf16 a[28:31], v[124:127], v[68:71], a[28:31]
    v_mfma_f32_16x16x32_bf16 a[32:35], v[128:131], v[56:59], a[32:35]
    v_mfma_f32_16x16x32_bf16 a[36:39], v[128:131], v[60:63], a[36:39]
    v_mfma_f32_16x16x32_bf16 a[40:43], v[128:131], v[64:67], a[40:43]
    v_mfma_f32_16x16x32_bf16 a[44:47], v[128:131], v[68:71], a[44:47]
    v_mfma_f32_16x16x32_bf16 a[48:51], v[132:135], v[56:59], a[48:51]
    v_mfma_f32_16x16x32_bf16 a[52:55], v[132:135], v[60:63], a[52:55]
    v_mfma_f32_16x16x32_bf16 a[56:59], v[132:135], v[64:67], a[56:59]
    v_mfma_f32_16x16x32_bf16 a[60:63], v[132:135], v[68:71], a[60:63]
    s_barrier
    v_lshlrev_b32 v13, 4, v1
    s_lshl_b32 s6, s3, 12
    v_add_u32 v14, s6, v13
    s_lshl_b32 s7, s3, 14
    v_add_u32 v15, s7, v13
    s_nop 7
    s_nop 3
    ds_write_b128 v14, a[0:3] offset:0
    ds_write_b128 v14, a[16:19] offset:1024
    ds_write_b128 v14, a[32:35] offset:2048
    ds_write_b128 v14, a[48:51] offset:3072
    ds_write_b128 v14, a[4:7] offset:16384
    ds_write_b128 v14, a[20:23] offset:17408
    ds_write_b128 v14, a[36:39] offset:18432
    ds_write_b128 v14, a[52:55] offset:19456
    ds_write_b128 v14, a[8:11] offset:32768
    ds_write_b128 v14, a[24:27] offset:33792
    ds_write_b128 v14, a[40:43] offset:34816
    ds_write_b128 v14, a[56:59] offset:35840
    ds_write_b128 v14, a[12:15] offset:49152
    ds_write_b128 v14, a[28:31] offset:50176
    ds_write_b128 v14, a[44:47] offset:51200
    ds_write_b128 v14, a[60:63] offset:52224
    s_waitcnt lgkmcnt(0)
    s_barrier
    ds_read_b128 v[40:43], v15 offset:0
    ds_read_b128 v[44:47], v15 offset:1024
    ds_read_b128 v[48:51], v15 offset:2048
    ds_read_b128 v[52:55], v15 offset:3072
    ds_read_b128 v[56:59], v15 offset:4096
    ds_read_b128 v[60:63], v15 offset:5120
    ds_read_b128 v[64:67], v15 offset:6144
    ds_read_b128 v[68:71], v15 offset:7168
    ds_read_b128 v[72:75], v15 offset:8192
    ds_read_b128 v[76:79], v15 offset:9216
    ds_read_b128 v[80:83], v15 offset:10240
    ds_read_b128 v[84:87], v15 offset:11264
    ds_read_b128 v[88:91], v15 offset:12288
    ds_read_b128 v[92:95], v15 offset:13312
    ds_read_b128 v[96:99], v15 offset:14336
    ds_read_b128 v[100:103], v15 offset:15360
    s_waitcnt lgkmcnt(3)
    v_add_f32 v40, v40, v56
    v_add_f32 v72, v72, v88
    v_add_f32 v41, v41, v57
    v_add_f32 v73, v73, v89
    v_add_f32 v42, v42, v58
    v_add_f32 v74, v74, v90
    v_add_f32 v43, v43, v59
    v_add_f32 v75, v75, v91
    v_cvt_pk_bf16_f32 v104, v40, v41
    v_cvt_pk_bf16_f32 v105, v42, v43
    v_cvt_pk_bf16_f32 v106, v72, v73
    v_cvt_pk_bf16_f32 v107, v74, v75
    v_lshlrev_b32 v40, 16, v104
    v_and_b32 v41, 0xffff0000, v104
    v_lshlrev_b32 v42, 16, v105
    v_and_b32 v43, 0xffff0000, v105
    v_lshlrev_b32 v72, 16, v106
    v_and_b32 v73, 0xffff0000, v106
    v_lshlrev_b32 v74, 16, v107
    v_and_b32 v75, 0xffff0000, v107
    v_sub_f32 v40, v40, v72
    v_sub_f32 v41, v41, v73
    v_sub_f32 v42, v42, v74
    v_sub_f32 v43, v43, v75
    v_cvt_pk_bf16_f32 v104, v40, v41
    v_cvt_pk_bf16_f32 v105, v42, v43
    v_lshlrev_b32 v40, 16, v104
    v_and_b32 v41, 0xffff0000, v104
    v_lshlrev_b32 v42, 16, v105
    v_and_b32 v43, 0xffff0000, v105
    v_lshlrev_b32 v72, 16, v24
    v_and_b32 v73, 0xffff0000, v24
    v_lshlrev_b32 v74, 16, v25
    v_and_b32 v75, 0xffff0000, v25
    v_add_f32 v40, v40, v72
    v_add_f32 v41, v41, v73
    v_add_f32 v42, v42, v74
    v_add_f32 v43, v43, v75
    v_cvt_pk_bf16_f32 v108, v40, v41
    v_cvt_pk_bf16_f32 v109, v42, v43
    buffer_store_dwordx2 v[108:109], v16, s[68:71], s62 offen offset:0
    s_waitcnt lgkmcnt(2)
    v_add_f32 v44, v44, v60
    v_add_f32 v76, v76, v92
    v_add_f32 v45, v45, v61
    v_add_f32 v77, v77, v93
    v_add_f32 v46, v46, v62
    v_add_f32 v78, v78, v94
    v_add_f32 v47, v47, v63
    v_add_f32 v79, v79, v95
    v_cvt_pk_bf16_f32 v104, v44, v45
    v_cvt_pk_bf16_f32 v105, v46, v47
    v_cvt_pk_bf16_f32 v106, v76, v77
    v_cvt_pk_bf16_f32 v107, v78, v79
    v_lshlrev_b32 v44, 16, v104
    v_and_b32 v45, 0xffff0000, v104
    v_lshlrev_b32 v46, 16, v105
    v_and_b32 v47, 0xffff0000, v105
    v_lshlrev_b32 v76, 16, v106
    v_and_b32 v77, 0xffff0000, v106
    v_lshlrev_b32 v78, 16, v107
    v_and_b32 v79, 0xffff0000, v107
    v_sub_f32 v44, v44, v76
    v_sub_f32 v45, v45, v77
    v_sub_f32 v46, v46, v78
    v_sub_f32 v47, v47, v79
    v_cvt_pk_bf16_f32 v104, v44, v45
    v_cvt_pk_bf16_f32 v105, v46, v47
    v_lshlrev_b32 v44, 16, v104
    v_and_b32 v45, 0xffff0000, v104
    v_lshlrev_b32 v46, 16, v105
    v_and_b32 v47, 0xffff0000, v105
    v_lshlrev_b32 v76, 16, v26
    v_and_b32 v77, 0xffff0000, v26
    v_lshlrev_b32 v78, 16, v27
    v_and_b32 v79, 0xffff0000, v27
    v_add_f32 v44, v44, v76
    v_add_f32 v45, v45, v77
    v_add_f32 v46, v46, v78
    v_add_f32 v47, v47, v79
    v_cvt_pk_bf16_f32 v110, v44, v45
    v_cvt_pk_bf16_f32 v111, v46, v47
    buffer_store_dwordx2 v[110:111], v16, s[68:71], s62 offen offset:32
    s_waitcnt lgkmcnt(1)
    v_add_f32 v48, v48, v64
    v_add_f32 v80, v80, v96
    v_add_f32 v49, v49, v65
    v_add_f32 v81, v81, v97
    v_add_f32 v50, v50, v66
    v_add_f32 v82, v82, v98
    v_add_f32 v51, v51, v67
    v_add_f32 v83, v83, v99
    v_cvt_pk_bf16_f32 v104, v48, v49
    v_cvt_pk_bf16_f32 v105, v50, v51
    v_cvt_pk_bf16_f32 v106, v80, v81
    v_cvt_pk_bf16_f32 v107, v82, v83
    v_lshlrev_b32 v48, 16, v104
    v_and_b32 v49, 0xffff0000, v104
    v_lshlrev_b32 v50, 16, v105
    v_and_b32 v51, 0xffff0000, v105
    v_lshlrev_b32 v80, 16, v106
    v_and_b32 v81, 0xffff0000, v106
    v_lshlrev_b32 v82, 16, v107
    v_and_b32 v83, 0xffff0000, v107
    v_sub_f32 v48, v48, v80
    v_sub_f32 v49, v49, v81
    v_sub_f32 v50, v50, v82
    v_sub_f32 v51, v51, v83
    v_cvt_pk_bf16_f32 v104, v48, v49
    v_cvt_pk_bf16_f32 v105, v50, v51
    v_lshlrev_b32 v48, 16, v104
    v_and_b32 v49, 0xffff0000, v104
    v_lshlrev_b32 v50, 16, v105
    v_and_b32 v51, 0xffff0000, v105
    v_lshlrev_b32 v80, 16, v28
    v_and_b32 v81, 0xffff0000, v28
    v_lshlrev_b32 v82, 16, v29
    v_and_b32 v83, 0xffff0000, v29
    v_add_f32 v48, v48, v80
    v_add_f32 v49, v49, v81
    v_add_f32 v50, v50, v82
    v_add_f32 v51, v51, v83
    v_cvt_pk_bf16_f32 v108, v48, v49
    v_cvt_pk_bf16_f32 v109, v50, v51
    buffer_store_dwordx2 v[108:109], v16, s[68:71], s62 offen offset:64
    s_waitcnt lgkmcnt(0)
    v_add_f32 v52, v52, v68
    v_add_f32 v84, v84, v100
    v_add_f32 v53, v53, v69
    v_add_f32 v85, v85, v101
    v_add_f32 v54, v54, v70
    v_add_f32 v86, v86, v102
    v_add_f32 v55, v55, v71
    v_add_f32 v87, v87, v103
    v_cvt_pk_bf16_f32 v104, v52, v53
    v_cvt_pk_bf16_f32 v105, v54, v55
    v_cvt_pk_bf16_f32 v106, v84, v85
    v_cvt_pk_bf16_f32 v107, v86, v87
    v_lshlrev_b32 v52, 16, v104
    v_and_b32 v53, 0xffff0000, v104
    v_lshlrev_b32 v54, 16, v105
    v_and_b32 v55, 0xffff0000, v105
    v_lshlrev_b32 v84, 16, v106
    v_and_b32 v85, 0xffff0000, v106
    v_lshlrev_b32 v86, 16, v107
    v_and_b32 v87, 0xffff0000, v107
    v_sub_f32 v52, v52, v84
    v_sub_f32 v53, v53, v85
    v_sub_f32 v54, v54, v86
    v_sub_f32 v55, v55, v87
    v_cvt_pk_bf16_f32 v104, v52, v53
    v_cvt_pk_bf16_f32 v105, v54, v55
    v_lshlrev_b32 v52, 16, v104
    v_and_b32 v53, 0xffff0000, v104
    v_lshlrev_b32 v54, 16, v105
    v_and_b32 v55, 0xffff0000, v105
    v_lshlrev_b32 v84, 16, v30
    v_and_b32 v85, 0xffff0000, v30
    v_lshlrev_b32 v86, 16, v31
    v_and_b32 v87, 0xffff0000, v31
    v_add_f32 v52, v52, v84
    v_add_f32 v53, v53, v85
    v_add_f32 v54, v54, v86
    v_add_f32 v55, v55, v87
    v_cvt_pk_bf16_f32 v110, v52, v53
    v_cvt_pk_bf16_f32 v111, v54, v55
    buffer_store_dwordx2 v[110:111], v16, s[68:71], s62 offen offset:96
.end_k6a2_kernel_1:
    s_endpgm
.section .rodata,"a"
.p2align 6
.amdhsa_kernel k6a2_kernel
  .amdhsa_next_free_vgpr 264
  .amdhsa_next_free_sgpr 100
  .amdhsa_accum_offset 200
  .amdhsa_group_segment_fixed_size 0
  .amdhsa_kernarg_size 104
  .amdhsa_user_sgpr_count 2
  .amdhsa_user_sgpr_kernarg_segment_ptr 1
  .amdhsa_system_sgpr_workgroup_id_x 1
  .amdhsa_float_denorm_mode_32 3
.end_amdhsa_kernel
.text

.globl k7b1_kernel
.p2align 8
.type k7b1_kernel,@function
k7b1_kernel:
    s_load_dwordx16 s[16:31], s[0:1], 0
    s_load_dwordx8 s[32:39], s[0:1], 64
    s_load_dwordx2 s[40:41], s[0:1], 96
    s_cmp_ge_u32 s2, 224
    s_cbranch_scc1 .end_k7b1_kernel_1
    v_lshrrev_b32 v2, 6, v0
    v_and_b32 v1, 63, v0
    v_readfirstlane_b32 s3, v2
    s_mul_i32 s4, s2, 0x4925
    s_lshr_b32 s4, s4, 17
    s_mul_i32 s6, s4, 7
    s_sub_u32 s5, s2, s6
    v_lshrrev_b32 v2, 3, v1
    v_and_b32 v3, 7, v1
    v_lshlrev_b32 v4, 10, v2
    v_lshl_add_u32 v4, v3, 4, v4
    s_lshl_b32 s6, s3, 13
    v_add_u32 v22, s6, v4
    s_lshl_b32 s60, s4, 16
    s_waitcnt lgkmcnt(0)
    s_add_u32 s44, s40, 0xf00000
    s_addc_u32 s45, s41, 0
    s_mov_b32 s46, 0x200000
    s_mov_b32 s47, 0x00020000
    buffer_load_dwordx4 v[88:91], v22, s[44:47], s60 offen offset:0
    buffer_load_dwordx4 v[92:95], v22, s[44:47], s60 offen offset:128
    buffer_load_dwordx4 v[96:99], v22, s[44:47], s60 offen offset:256
    buffer_load_dwordx4 v[100:103], v22, s[44:47], s60 offen offset:384
    buffer_load_dwordx4 v[104:107], v22, s[44:47], s60 offen offset:512
    buffer_load_dwordx4 v[108:111], v22, s[44:47], s60 offen offset:640
    buffer_load_dwordx4 v[112:115], v22, s[44:47], s60 offen offset:768
    buffer_load_dwordx4 v[116:119], v22, s[44:47], s60 offen offset:896
    s_cmp_ge_u32 s3, 4
    s_cbranch_scc1 .skipb_k7b1_kernel_2
    v_and_b32 v5, 15, v1
    v_lshrrev_b32 v6, 4, v1
    s_add_u32 s48, s40, 0x1100000
    s_addc_u32 s49, s41, 0
    s_mov_b32 s50, 0x1c0000
    s_mov_b32 s51, 0x00020000
    s_add_u32 s52, s40, 0x400000
    s_addc_u32 s53, s41, 0
    s_mov_b32 s54, 0x700000
    s_mov_b32 s55, 0x00020000
    s_mov_b32 s56, s30
    s_mov_b32 s57, s31
    s_mov_b32 s58, 0xe00
    s_mov_b32 s59, 0x00020000
    s_lshl_b32 s6, s5, 8
    s_lshl_b32 s7, s3, 6
    s_add_u32 s6, s6, s7
    s_lshl_b32 s61, s6, 10
    s_lshl_b32 s63, s6, 1
    v_lshlrev_b32 v7, 4, v1
    v_add_u32 v10, 0x0, v7
    v_add_u32 v11, 0x4000, v7
    v_add_u32 v12, 0x8000, v7
    v_add_u32 v13, 0xc000, v7
    v_add_u32 v7, 0, v6
    v_xor_b32 v7, v7, v5
    v_lshlrev_b32 v7, 4, v7
    v_lshl_add_u32 v16, v5, 10, v7
    v_add_u32 v7, 4, v6
    v_xor_b32 v7, v7, v5
    v_lshlrev_b32 v7, 4, v7
    v_lshl_add_u32 v17, v5, 10, v7
    v_add_u32 v7, 8, v6
    v_xor_b32 v7, v7, v5
    v_lshlrev_b32 v7, 4, v7
    v_lshl_add_u32 v18, v5, 10, v7
    v_add_u32 v7, 12, v6
    v_xor_b32 v7, v7, v5
    v_lshlrev_b32 v7, 4, v7
    v_lshl_add_u32 v19, v5, 10, v7
.skipb_k7b1_kernel_2:
    v_xor_b32 v7, v3, v2
    v_lshlrev_b32 v7, 4, v7
    v_lshl_add_u32 v7, v2, 10, v7
    s_and_b32 s7, s3, 1
    s_lshl_b32 s7, s7, 7
    s_lshl_b32 s6, s3, 13
    s_add_u32 s8, s6, s7
    s_sub_u32 s9, s6, s7
    v_add_u32 v20, s8, v7
    v_add_u32 v21, s9, v7
    s_mov_b32 s8, 0x3f803f80
    v_mov_b32 v24, 0
    v_mov_b32 v25, 0
    v_mov_b32 v26, 0
    v_mov_b32 v27, 0
    s_waitcnt vmcnt(7)
    v_dot2c_f32_bf16 v24, s8, v88
    v_dot2c_f32_bf16 v25, s8, v89
    v_dot2c_f32_bf16 v26, s8, v90
    v_dot2c_f32_bf16 v27, s8, v91
    s_waitcnt vmcnt(6)
    v_dot2c_f32_bf16 v24, s8, v92
    v_dot2c_f32_bf16 v25, s8, v93
    v_dot2c_f32_bf16 v26, s8, v94
    v_dot2c_f32_bf16 v27, s8, v95
    s_waitcnt vmcnt(5)
    v_dot2c_f32_bf16 v24, s8, v96
    v_dot2c_f32_bf16 v25, s8, v97
    v_dot2c_f32_bf16 v26, s8, v98
    v_dot2c_f32_bf16 v27, s8, v99
    s_waitcnt vmcnt(4)
    v_dot2c_f32_bf16 v24, s8, v100
    v_dot2c_f32_bf16 v25, s8, v101
    v_dot2c_f32_bf16 v26, s8, v102
    v_dot2c_f32_bf16 v27, s8, v103
    s_waitcnt vmcnt(3)
    v_dot2c_f32_bf16 v24, s8, v104
    v_dot2c_f32_bf16 v25, s8, v105
    v_dot2c_f32_bf16 v26, s8, v106
    v_dot2c_f32_bf16 v27, s8, v107
    s_waitcnt vmcnt(2)
    v_dot2c_f32_bf16 v24, s8, v108
    v_dot2c_f32_bf16 v25, s8, v109
    v_dot2c_f32_bf16 v26, s8, v110
    v_dot2c_f32_bf16 v27, s8, v111
    s_waitcnt vmcnt(1)
    v_dot2c_f32_bf16 v24, s8, v112
    v_dot2c_f32_bf16 v25, s8, v113
    v_dot2c_f32_bf16 v26, s8, v114
    v_dot2c_f32_bf16 v27, s8, v115
    s_waitcnt vmcnt(0)
    v_dot2c_f32_bf16 v24, s8, v116
    v_dot2c_f32_bf16 v25, s8, v117
    v_dot2c_f32_bf16 v26, s8, v118
    v_dot2c_f32_bf16 v27, s8, v119
    s_nop 2
    s_cmp_ge_u32 s3, 4
    s_cbranch_scc1 .skip2_k7b1_kernel_3
    buffer_load_dwordx4 v[40:43], v10, s[48:51], s61 offen
    buffer_load_dwordx4 v[44:47], v11, s[48:51], s61 offen
    buffer_load_dwordx4 v[48:51], v12, s[48:51], s61 offen
    buffer_load_dwordx4 v[52:55], v13, s[48:51], s61 offen
    s_add_u32 s61, s61, 0x400
    buffer_load_dwordx4 v[56:59], v10, s[48:51], s61 offen
    buffer_load_dwordx4 v[60:63], v11, s[48:51], s61 offen
    buffer_load_dwordx4 v[64:67], v12, s[48:51], s61 offen
    buffer_load_dwordx4 v[68:71], v13, s[48:51], s61 offen
    s_add_u32 s61, s61, 0x400
    buffer_load_dwordx4 v[72:75], v10, s[48:51], s61 offen
    buffer_load_dwordx4 v[76:79], v11, s[48:51], s61 offen
    buffer_load_dwordx4 v[80:83], v12, s[48:51], s61 offen
    buffer_load_dwordx4 v[84:87], v13, s[48:51], s61 offen
    s_add_u32 s61, s61, 0x400
.skip2_k7b1_kernel_3:
    v_add_f32 v24, v24, v25
    v_add_f32 v26, v26, v27
    v_add_f32 v24, v24, v26
    s_nop 1
    v_add_f32_dpp v25, v24, v24 quad_perm:[1,0,3,2] row_mask:0xf bank_mask:0xf
    s_nop 1
    v_add_f32_dpp v24, v25, v25 quad_perm:[2,3,0,1] row_mask:0xf bank_mask:0xf
    s_nop 1
    v_add_f32_dpp v25, v24, v24 row_half_mirror row_mask:0xf bank_mask:0xf
    v_mov_b32 v24, v25
    v_mul_f32 v28, 0x3b000000, v24
    v_sub_f32 v30, 0, v28
    v_sub_f32 v31, 0, v28
    v_mov_b32 v32, 0
    v_mov_b32 v33, 0
    v_mov_b32 v34, 0
    v_mov_b32 v35, 0
    v_lshlrev_b32 v120, 16, v88
    v_and_b32 v121, 0xffff0000, v88
    v_pk_add_f32 v[120:121], v[120:121], v[30:31]
    v_pk_fma_f32 v[32:33], v[120:121], v[120:121], v[32:33]
    v_lshlrev_b32 v122, 16, v89
    v_and_b32 v123, 0xffff0000, v89
    v_pk_add_f32 v[122:123], v[122:123], v[30:31]
    v_pk_fma_f32 v[34:35], v[122:123], v[122:123], v[34:35]
    v_lshlrev_b32 v124, 16, v90
    v_and_b32 v125, 0xffff0000, v90
    v_pk_add_f32 v[124:125], v[124:125], v[30:31]
    v_pk_fma_f32 v[32:33], v[124:125], v[124:125], v[32:33]
    v_lshlrev_b32 v126, 16, v91
    v_and_b32 v127, 0xffff0000, v91
    v_pk_add_f32 v[126:127], v[126:127], v[30:31]
    v_pk_fma_f32 v[34:35], v[126:127], v[126:127], v[34:35]
    v_lshlrev_b32 v128, 16, v92
    v_and_b32 v129, 0xffff0000, v92
    v_pk_add_f32 v[128:129], v[128:129], v[30:31]
    v_pk_fma_f32 v[32:33], v[128:129], v[128:129], v[32:33]
    v_lshlrev_b32 v130, 16, v93
    v_and_b32 v131, 0xffff0000, v93
    v_pk_add_f32 v[130:131], v[130:131], v[30:31]
    v_pk_fma_f32 v[34:35], v[130:131], v[130:131], v[34:35]
    v_lshlrev_b32 v132, 16, v94
    v_and_b32 v133, 0xffff0000, v94
    v_pk_add_f32 v[132:133], v[132:133], v[30:31]
    v_pk_fma_f32 v[32:33], v[132:133], v[132:133], v[32:33]
    v_lshlrev_b32 v134, 16, v95
    v_and_b32 v135, 0xffff0000, v95
    v_pk_add_f32 v[134:135], v[134:135], v[30:31]
    v_pk_fma_f32 v[34:35], v[134:135], v[134:135], v[34:35]
    v_lshlrev_b32 v136, 16, v96
    v_and_b32 v137, 0xffff0000, v96
    v_pk_add_f32 v[136:137], v[136:137], v[30:31]
    v_pk_fma_f32 v[32:33], v[136:137], v[136:137], v[32:33]
    v_lshlrev_b32 v138, 16, v97
    v_and_b32 v139, 0xffff0000, v97
    v_pk_add_f32 v[138:139], v[138:139], v[30:31]
    v_pk_fma_f32 v[34:35], v[138:139], v[138:139], v[34:35]
    v_lshlrev_b32 v140, 16, v98
    v_and_b32 v141, 0xffff0000, v98
    v_pk_add_f32 v[140:141], v[140:141], v[30:31]
    v_pk_fma_f32 v[32:33], v[140:141], v[140:141], v[32:33]
    v_lshlrev_b32 v142, 16, v99
    v_and_b32 v143, 0xffff0000, v99
    v_pk_add_f32 v[142:143], v[142:143], v[30:31]
    v_pk_fma_f32 v[34:35], v[142:143], v[142:143], v[34:35]
    v_lshlrev_b32 v144, 16, v100
    v_and_b32 v145, 0xffff0000, v100
    v_pk_add_f32 v[144:145], v[144:145], v[30:31]
    v_pk_fma_f32 v[32:33], v[144:145], v[144:145], v[32:33]
    v_lshlrev_b32 v146, 16, v101
    v_and_b32 v147, 0xffff0000, v101
    v_pk_add_f32 v[146:147], v[146:147], v[30:31]
    v_pk_fma_f32 v[34:35], v[146:147], v[146:147], v[34:35]
    v_lshlrev_b32 v148, 16, v102
    v_and_b32 v149, 0xffff0000, v102
    v_pk_add_f32 v[148:149], v[148:149], v[30:31]
    v_pk_fma_f32 v[32:33], v[148:149], v[148:149], v[32:33]
    v_lshlrev_b32 v150, 16, v103
    v_and_b32 v151, 0xffff0000, v103
    v_pk_add_f32 v[150:151], v[150:151], v[30:31]
    v_pk_fma_f32 v[34:35], v[150:151], v[150:151], v[34:35]
    v_lshlrev_b32 v152, 16, v104
    v_and_b32 v153, 0xffff0000, v104
    v_pk_add_f32 v[152:153], v[152:153], v[30:31]
    v_pk_fma_f32 v[32:33], v[152:153], v[152:153], v[32:33]
    v_lshlrev_b32 v154, 16, v105
    v_and_b32 v155, 0xffff0000, v105
    v_pk_add_f32 v[154:155], v[154:155], v[30:31]
    v_pk_fma_f32 v[34:35], v[154:155], v[154:155], v[34:35]
    v_lshlrev_b32 v156, 16, v106
    v_and_b32 v157, 0xffff0000, v106
    v_pk_add_f32 v[156:157], v[156:157], v[30:31]
    v_pk_fma_f32 v[32:33], v[156:157], v[156:157], v[32:33]
    v_lshlrev_b32 v158, 16, v107
    v_and_b32 v159, 0xffff0000, v107
    v_pk_add_f32 v[158:159], v[158:159], v[30:31]
    v_pk_fma_f32 v[34:35], v[158:159], v[158:159], v[34:35]
    v_lshlrev_b32 v160, 16, v108
    v_and_b32 v161, 0xffff0000, v108
    v_pk_add_f32 v[160:161], v[160:161], v[30:31]
    v_pk_fma_f32 v[32:33], v[160:161], v[160:161], v[32:33]
    v_lshlrev_b32 v162, 16, v109
    v_and_b32 v163, 0xffff0000, v109
    v_pk_add_f32 v[162:163], v[162:163], v[30:31]
    v_pk_fma_f32 v[34:35], v[162:163], v[162:163], v[34:35]
    v_lshlrev_b32 v164, 16, v110
    v_and_b32 v165, 0xffff0000, v110
    v_pk_add_f32 v[164:165], v[164:165], v[30:31]
    v_pk_fma_f32 v[32:33], v[164:165], v[164:165], v[32:33]
    v_lshlrev_b32 v166, 16, v111
    v_and_b32 v167, 0xffff0000, v111
    v_pk_add_f32 v[166:167], v[166:167], v[30:31]
    v_pk_fma_f32 v[34:35], v[166:167], v[166:167], v[34:35]
    v_lshlrev_b32 v168, 16, v112
    v_and_b32 v169, 0xffff0000, v112
    v_pk_add_f32 v[168:169], v[168:169], v[30:31]
    v_pk_fma_f32 v[32:33], v[168:169], v[168:169], v[32:33]
    v_lshlrev_b32 v170, 16, v113
    v_and_b32 v171, 0xffff0000, v113
    v_pk_add_f32 v[170:171], v[170:171], v[30:31]
    v_pk_fma_f32 v[34:35], v[170:171], v[170:171], v[34:35]
    v_lshlrev_b32 v172, 16, v114
    v_and_b32 v173, 0xffff0000, v114
    v_pk_add_f32 v[172:173], v[172:173], v[30:31]
    v_pk_fma_f32 v[32:33], v[172:173], v[172:173], v[32:33]
    v_lshlrev_b32 v174, 16, v115
    v_and_b32 v175, 0xffff0000, v115
    v_pk_add_f32 v[174:175], v[174:175], v[30:31]
    v_pk_fma_f32 v[34:35], v[174:175], v[174:175], v[34:35]
    v_lshlrev_b32 v176, 16, v116
    v_and_b32 v177, 0xffff0000, v116
    v_pk_add_f32 v[176:177], v[176:177], v[30:31]
    v_pk_fma_f32 v[32:33], v[176:177], v[176:177], v[32:33]
    v_lshlrev_b32 v178, 16, v117
    v_and_b32 v179, 0xffff0000, v117
    v_pk_add_f32 v[178:179], v[178:179], v[30:31]
    v_pk_fma_f32 v[34:35], v[178:179], v[178:179], v[34:35]
    v_lshlrev_b32 v180, 16, v118
    v_and_b32 v181, 0xffff0000, v118
    v_pk_add_f32 v[180:181], v[180:181], v[30:31]
    v_pk_fma_f32 v[32:33], v[180:181], v[180:181], v[32:33]
    v_lshlrev_b32 v182, 16, v119
    v_and_b32 v183, 0xffff0000, v119
    v_pk_add_f32 v[182:183], v[182:183], v[30:31]
    v_pk_fma_f32 v[34:35], v[182:183], v[182:183], v[34:35]
    v_add_f32 v32, v32, v33
    v_add_f32 v34, v34, v35
    v_add_f32 v32, v32, v34
    s_nop 1
    v_add_f32_dpp v33, v32, v32 quad_perm:[1,0,3,2] row_mask:0xf bank_mask:0xf
    s_nop 1
    v_add_f32_dpp v32, v33, v33 quad_perm:[2,3,0,1] row_mask:0xf bank_mask:0xf
    s_nop 1
    v_add_f32_dpp v33, v32, v32 row_half_mirror row_mask:0xf bank_mask:0xf
    v_mov_b32 v32, v33
    v_mul_f32 v32, 0x3b000000, v32
    v_cvt_pk_bf16_f32 v33, v32, v28
    v_lshlrev_b32 v34, 16, v33
    v_and_b32 v35, 0xffff0000, v33
    v_add_f32 v34, 0x3727c5ac, v34
    v_cvt_pk_bf16_f32 v33, v34, v34
    v_lshlrev_b32 v34, 16, v33
    v_sqrt_f32 v34, v34
    s_nop 0
    v_cvt_pk_bf16_f32 v33, v34, v34
    v_lshlrev_b32 v34, 16, v33
    v_rcp_f32 v30, v34
    s_nop 0
    v_mov_b32 v31, v30
    v_sub_f32 v36, v28, v35
    v_mul_f32 v36, v36, v30
    v_mov_b32 v37, v36
    v_pk_fma_f32 v[120:121], v[120:121], v[30:31], v[36:37]
    v_cvt_pk_bf16_f32 v88, v120, v121
    v_pk_fma_f32 v[122:123], v[122:123], v[30:31], v[36:37]
    v_cvt_pk_bf16_f32 v89, v122, v123
    v_pk_fma_f32 v[124:125], v[124:125], v[30:31], v[36:37]
    v_cvt_pk_bf16_f32 v90, v124, v125
    v_pk_fma_f32 v[126:127], v[126:127], v[30:31], v[36:37]
    v_cvt_pk_bf16_f32 v91, v126, v127
    s_nop 0
    ds_write_b128 v20, v[88:91] offset:0
    v_pk_fma_f32 v[128:129], v[128:129], v[30:31], v[36:37]
    v_cvt_pk_bf16_f32 v92, v128, v129
    v_pk_fma_f32 v[130:131], v[130:131], v[30:31], v[36:37]
    v_cvt_pk_bf16_f32 v93, v130, v131
    v_pk_fma_f32 v[132:133], v[132:133], v[30:31], v[36:37]
    v_cvt_pk_bf16_f32 v94, v132, v133
    v_pk_fma_f32 v[134:135], v[134:135], v[30:31], v[36:37]
    v_cvt_pk_bf16_f32 v95, v134, v135
    s_nop 0
    ds_write_b128 v21, v[92:95] offset:128
    v_pk_fma_f32 v[136:137], v[136:137], v[30:31], v[36:37]
    v_cvt_pk_bf16_f32 v96, v136, v137
    v_pk_fma_f32 v[138:139], v[138:139], v[30:31], v[36:37]
    v_cvt_pk_bf16_f32 v97, v138, v139
    v_pk_fma_f32 v[140:141], v[140:141], v[30:31], v[36:37]
    v_cvt_pk_bf16_f32 v98, v140, v141
    v_pk_fma_f32 v[142:143], v[142:143], v[30:31], v[36:37]
    v_cvt_pk_bf16_f32 v99, v142, v143
    s_nop 0
    ds_write_b128 v20, v[96:99] offset:256
    v_pk_fma_f32 v[144:145], v[144:145], v[30:31], v[36:37]
    v_cvt_pk_bf16_f32 v100, v144, v145
    v_pk_fma_f32 v[146:147], v[146:147], v[30:31], v[36:37]
    v_cvt_pk_bf16_f32 v101, v146, v147
    v_pk_fma_f32 v[148:149], v[148:149], v[30:31], v[36:37]
    v_cvt_pk_bf16_f32 v102, v148, v149
    v_pk_fma_f32 v[150:151], v[150:151], v[30:31], v[36:37]
    v_cvt_pk_bf16_f32 v103, v150, v151
    s_nop 0
    ds_write_b128 v21, v[100:103] offset:384
    v_pk_fma_f32 v[152:153], v[152:153], v[30:31], v[36:37]
    v_cvt_pk_bf16_f32 v104, v152, v153
    v_pk_fma_f32 v[154:155], v[154:155], v[30:31], v[36:37]
    v_cvt_pk_bf16_f32 v105, v154, v155
    v_pk_fma_f32 v[156:157], v[156:157], v[30:31], v[36:37]
    v_cvt_pk_bf16_f32 v106, v156, v157
    v_pk_fma_f32 v[158:159], v[158:159], v[30:31], v[36:37]
    v_cvt_pk_bf16_f32 v107, v158, v159
    s_nop 0
    ds_write_b128 v20, v[104:107] offset:512
    v_pk_fma_f32 v[160:161], v[160:161], v[30:31], v[36:37]
    v_cvt_pk_bf16_f32 v108, v160, v161
    v_pk_fma_f32 v[162:163], v[162:163], v[30:31], v[36:37]
    v_cvt_pk_bf16_f32 v109, v162, v163
    v_pk_fma_f32 v[164:165], v[164:165], v[30:31], v[36:37]
    v_cvt_pk_bf16_f32 v110, v164, v165
    v_pk_fma_f32 v[166:167], v[166:167], v[30:31], v[36:37]
    v_cvt_pk_bf16_f32 v111, v166, v167
    s_nop 0
    ds_write_b128 v21, v[108:111] offset:640
    v_pk_fma_f32 v[168:169], v[168:169], v[30:31], v[36:37]
    v_cvt_pk_bf16_f32 v112, v168, v169
    v_pk_fma_f32 v[170:171], v[170:171], v[30:31], v[36:37]
    v_cvt_pk_bf16_f32 v113, v170, v171
    v_pk_fma_f32 v[172:173], v[172:173], v[30:31], v[36:37]
    v_cvt_pk_bf16_f32 v114, v172, v173
    v_pk_fma_f32 v[174:175], v[174:175], v[30:31], v[36:37]
    v_cvt_pk_bf16_f32 v115, v174, v175
    s_nop 0
    ds_write_b128 v20, v[112:115] offset:768
    v_pk_fma_f32 v[176:177], v[176:177], v[30:31], v[36:37]
    v_cvt_pk_bf16_f32 v116, v176, v177
    v_pk_fma_f32 v[178:179], v[178:179], v[30:31], v[36:37]
    v_cvt_pk_bf16_f32 v117, v178, v179
    v_pk_fma_f32 v[180:181], v[180:181], v[30:31], v[36:37]
    v_cvt_pk_bf16_f32 v118, v180, v181
    v_pk_fma_f32 v[182:183], v[182:183], v[30:31], v[36:37]
    v_cvt_pk_bf16_f32 v119, v182, v183
    s_nop 0
    ds_write_b128 v21, v[116:119] offset:896
    s_waitcnt lgkmcnt(0)
    s_barrier
    s_cmp_ge_u32 s3, 4
    s_cbranch_scc1 .end_k7b1_kernel_1
    ds_read_b128 v[88:91], v16 offset:0
    ds_read_b128 v[92:95], v16 offset:16384
    ds_read_b128 v[96:99], v16 offset:32768
    ds_read_b128 v[100:103], v16 offset:49152
    ds_read_b128 v[104:107], v17 offset:0
    ds_read_b128 v[108:111], v17 offset:16384
    ds_read_b128 v[112:115], v17 offset:32768
    ds_read_b128 v[116:119], v17 offset:49152
    s_waitcnt lgkmcnt(4)
    s_waitcnt vmcnt(8)
    v_mfma_f32_16x16x32_bf16 a[0:3], v[40:43], v[88:91], 0
    v_mfma_f32_16x16x32_bf16 a[4:7], v[40:43], v[92:95], 0
    v_mfma_f32_16x16x32_bf16 a[8:11], v[40:43], v[96:99], 0
    v_mfma_f32_16x16x32_bf16 a[12:15], v[40:43], v[100:103], 0
    v_mfma_f32_16x16x32_bf16 a[16:19], v[44:47], v[88:91], 0
    v_mfma_f32_16x16x32_bf16 a[20:23], v[44:47], v[92:95], 0
    v_mfma_f32_16x16x32_bf16 a[24:27], v[44:47], v[96:99], 0
    v_mfma_f32_16x16x32_bf16 a[28:31], v[44:47], v[100:103], 0
    v_mfma_f32_16x16x32_bf16 a[32:35], v[48:51], v[88:91], 0
    v_mfma_f32_16x16x32_bf16 a[36:39], v[48:51], v[92:95], 0
    v_mfma_f32_16x16x32_bf16 a[40:43], v[48:51], v[96:99], 0
    v_mfma_f32_16x16x32_bf16 a[44:47], v[48:51], v[100:103], 0
    v_mfma_f32_16x16x32_bf16 a[48:51], v[52:55], v[88:91], 0
    v_mfma_f32_16x16x32_bf16 a[52:55], v[52:55], v[92:95], 0
    v_mfma_f32_16x16x32_bf16 a[56:59], v[52:55], v[96:99], 0
    v_mfma_f32_16x16x32_bf16 a[60:63], v[52:55], v[100:103], 0
    buffer_load_dwordx4 v[40:43], v10, s[48:51], s61 offen
    buffer_load_dwordx4 v[44:47], v11, s[48:51], s61 offen
    buffer_load_dwordx4 v[48:51], v12, s[48:51], s61 offen
    buffer_load_dwordx4 v[52:55], v13, s[48:51], s61 offen
    s_add_u32 s61, s61, 0x400
    ds_read_b128 v[88:91], v18 offset:0
    ds_read_b128 v[92:95], v18 offset:16384
    ds_read_b128 v[96:99], v18 offset:32768
    ds_read_b128 v[100:103], v18 offset:49152
    s_waitcnt lgkmcnt(4)
    s_waitcnt vmcnt(8)
    v_mfma_f32_16x16x32_bf16 a[0:3], v[56:59], v[104:107], a[0:3]
    v_mfma_f32_16x16x32_bf16 a[4:7], v[56:59], v[108:111], a[4:7]
    v_mfma_f32_16x16x32_bf16 a[8:11], v[56:59], v[112:115], a[8:11]
    v_mfma_f32_16x16x32_bf16 a[12:15], v[56:59], v[116:119], a[12:15]
    v_mfma_f32_16x16x32_bf16 a[16:19], v[60:63], v[104:107], a[16:19]
    v_mfma_f32_16x16x32_bf16 a[20:23], v[60:63], v[108:111], a[20:23]
    v_mfma_f32_16x16x32_bf16 a[24:27], v[60:63], v[112:115], a[24:27]
    v_mfma_f32_16x16x32_bf16 a[28:31], v[60:63], v[116:119], a[28:31]
    v_mfma_f32_16x16x32_bf16 a[32:35], v[64:67], v[104:107], a[32:35]
    v_mfma_f32_16x16x32_bf16 a[36:39], v[64:67], v[108:111], a[36:39]
    v_mfma_f32_16x16x32_bf16 a[40:43], v[64:67], v[112:115], a[40:43]
    v_mfma_f32_16x16x32_bf16 a[44:47], v[64:67], v[116:119], a[44:47]
    v_mfma_f32_16x16x32_bf16 a[48:51], v[68:71], v[104:107], a[48:51]
    v_mfma_f32_16x16x32_bf16 a[52:55], v[68:71], v[108:111], a[52:55]
    v_mfma_f32_16x16x32_bf16 a[56:59], v[68:71], v[112:115], a[56:59]
    v_mfma_f32_16x16x32_bf16 a[60:63], v[68:71], v[116:119], a[60:63]
    buffer_load_dwordx4 v[56:59], v10, s[48:51], s61 offen
    buffer_load_dwordx4 v[60:63], v11, s[48:51], s61 offen
    buffer_load_dwordx4 v[64:67], v12, s[48:51], s61 offen
    buffer_load_dwordx4 v[68:71], v13, s[48:51], s61 offen
    s_add_u32 s61, s61, 0x400
    ds_read_b128 v[104:107], v19 offset:0
    ds_read_b128 v[108:111], v19 offset:16384
    ds_read_b128 v[112:115], v19 offset:32768
    ds_read_b128 v[116:119], v19 offset:49152
    s_waitcnt lgkmcnt(4)
    s_waitcnt vmcnt(8)
    v_mfma_f32_16x16x32_bf16 a[0:3], v[72:75], v[88:91], a[0:3]
    v_mfma_f32_16x16x32_bf16 a[4:7], v[72:75], v[92:95], a[4:7]
    v_mfma_f32_16x16x32_bf16 a[8:11], v[72:75], v[96:99], a[8:11]
    v_mfma_f32_16x16x32_bf16 a[12:15], v[72:75], v[100:103], a[12:15]
    v_mfma_f32_16x16x32_bf16 a[16:19], v[76:79], v[88:91], a[16:19]
    v_mfma_f32_16x16x32_bf16 a[20:23], v[76:79], v[92:95], a[20:23]
    v_mfma_f32_16x16x32_bf16 a[24:27], v[76:79], v[96:99], a[24:27]
    v_mfma_f32_16x16x32_bf16 a[28:31], v[76:79], v[100:103], a[28:31]
    v_mfma_f32_16x16x32_bf16 a[32:35], v[80:83], v[88:91], a[32:35]
    v_mfma_f32_16x16x32_bf16 a[36:39], v[80:83], v[92:95], a[36:39]
    v_mfma_f32_16x16x32_bf16 a[40:43], v[80:83], v[96:99], a[40:43]
    v_mfma_f32_16x16x32_bf16 a[44:47], v[80:83], v[100:103], a[44:47]
    v_mfma_f32_16x16x32_bf16 a[48:51], v[84:87], v[88:91], a[48:51]
    v_mfma_f32_16x16x32_bf16 a[52:55], v[84:87], v[92:95], a[52:55]
    v_mfma_f32_16x16x32_bf16 a[56:59], v[84:87], v[96:99], a[56:59]
    v_mfma_f32_16x16x32_bf16 a[60:63], v[84:87], v[100:103], a[60:63]
    buffer_load_dwordx4 v[72:75], v10, s[48:51], s61 offen
    buffer_load_dwordx4 v[76:79], v11, s[48:51], s61 offen
    buffer_load_dwordx4 v[80:83], v12, s[48:51], s61 offen
    buffer_load_dwordx4 v[84:87], v13, s[48:51], s61 offen
    s_add_u32 s61, s61, 0x400
    ds_read_b128 v[88:91], v16 offset:256
    ds_read_b128 v[92:95], v16 offset:16640
    ds_read_b128 v[96:99], v16 offset:33024
    ds_read_b128 v[100:103], v16 offset:49408
    s_waitcnt lgkmcnt(4)
    s_waitcnt vmcnt(8)
    v_mfma_f32_16x16x32_bf16 a[0:3], v[40:43], v[104:107], a[0:3]
    v_mfma_f32_16x16x32_bf16 a[4:7], v[40:43], v[108:111], a[4:7]
    v_mfma_f32_16x16x32_bf16 a[8:11], v[40:43], v[112:115], a[8:11]
    v_mfma_f32_16x16x32_bf16 a[12:15], v[40:43], v[116:119], a[12:15]
    v_mfma_f32_16x16x32_bf16 a[16:19], v[44:47], v[104:107], a[16:19]
    v_mfma_f32_16x16x32_bf16 a[20:23], v[44:47], v[108:111], a[20:23]
    v_mfma_f32_16x16x32_bf16 a[24:27], v[44:47], v[112:115], a[24:27]
    v_mfma_f32_16x16x32_bf16 a[28:31], v[44:47], v[116:119], a[28:31]
    v_mfma_f32_16x16x32_bf16 a[32:35], v[48:51], v[104:107], a[32:35]
    v_mfma_f32_16x16x32_bf16 a[36:39], v[48:51], v[108:111], a[36:39]
    v_mfma_f32_16x16x32_bf16 a[40:43], v[48:51], v[112:115], a[40:43]
    v_mfma_f32_16x16x32_bf16 a[44:47], v[48:51], v[116:119], a[44:47]
    v_mfma_f32_16x16x32_bf16 a[48:51], v[52:55], v[104:107], a[48:51]
    v_mfma_f32_16x16x32_bf16 a[52:55], v[52:55], v[108:111], a[52:55]
    v_mfma_f32_16x16x32_bf16 a[56:59], v[52:55], v[112:115], a[56:59]
    v_mfma_f32_16x16x32_bf16 a[60:63], v[52:55], v[116:119], a[60:63]
    buffer_load_dwordx4 v[40:43], v10, s[48:51], s61 offen
    buffer_load_dwordx4 v[44:47], v11, s[48:51], s61 offen
    buffer_load_dwordx4 v[48:51], v12, s[48:51], s61 offen
    buffer_load_dwordx4 v[52:55], v13, s[48:51], s61 offen
    s_add_u32 s61, s61, 0x400
    ds_read_b128 v[104:107], v17 offset:256
    ds_read_b128 v[108:111], v17 offset:16640
    ds_read_b128 v[112:115], v17 offset:33024
    ds_read_b128 v[116:119], v17 offset:49408
    s_waitcnt lgkmcnt(4)
    s_waitcnt vmcnt(8)
    v_mfma_f32_16x16x32_bf16 a[0:3], v[56:59], v[88:91], a[0:3]
    v_mfma_f32_16x16x32_bf16 a[4:7], v[56:59], v[92:95], a[4:7]
    v_mfma_f32_16x16x32_bf16 a[8:11], v[56:59], v[96:99], a[8:11]
    v_mfma_f32_16x16x32_bf16 a[12:15], v[56:59], v[100:103], a[12:15]
    v_mfma_f32_16x16x32_bf16 a[16:19], v[60:63], v[88:91], a[16:19]
    v_mfma_f32_16x16x32_bf16 a[20:23], v[60:63], v[92:95], a[20:23]
    v_mfma_f32_16x16x32_bf16 a[24:27], v[60:63], v[96:99], a[24:27]
    v_mfma_f32_16x16x32_bf16 a[28:31], v[60:63], v[100:103], a[28:31]
    v_mfma_f32_16x16x32_bf16 a[32:35], v[64:67], v[88:91], a[32:35]
    v_mfma_f32_16x16x32_bf16 a[36:39], v[64:67], v[92:95], a[36:39]
    v_mfma_f32_16x16x32_bf16 a[40:43], v[64:67], v[96:99], a[40:43]
    v_mfma_f32_16x16x32_bf16 a[44:47], v[64:67], v[100:103], a[44:47]
    v_mfma_f32_16x16x32_bf16 a[48:51], v[68:71], v[88:91], a[48:51]
    v_mfma_f32_16x16x32_bf16 a[52:55], v[68:71], v[92:95], a[52:55]
    v_mfma_f32_16x16x32_bf16 a[56:59], v[68:71], v[96:99], a[56:59]
    v_mfma_f32_16x16x32_bf16 a[60:63], v[68:71], v[100:103], a[60:63]
    buffer_load_dwordx4 v[56:59], v10, s[48:51], s61 offen
    buffer_load_dwordx4 v[60:63], v11, s[48:51], s61 offen
    buffer_load_dwordx4 v[64:67], v12, s[48:51], s61 offen
    buffer_load_dwordx4 v[68:71], v13, s[48:51], s61 offen
    s_add_u32 s61, s61, 0x400
    ds_read_b128 v[88:91], v18 offset:256
    ds_read_b128 v[92:95], v18 offset:16640
    ds_read_b128 v[96:99], v18 offset:33024
    ds_read_b128 v[100:103], v18 offset:49408
    s_waitcnt lgkmcnt(4)
    s_waitcnt vmcnt(8)
    v_mfma_f32_16x16x32_bf16 a[0:3], v[72:75], v[104:107], a[0:3]
    v_mfma_f32_16x16x32_bf16 a[4:7], v[72:75], v[108:111], a[4:7]
    v_mfma_f32_16x16x32_bf16 a[8:11], v[72:75], v[112:115], a[8:11]
    v_mfma_f32_16x16x32_bf16 a[12:15], v[72:75], v[116:119], a[12:15]
    v_mfma_f32_16x16x32_bf16 a[16:19], v[76:79], v[104:107], a[16:19]
    v_mfma_f32_16x16x32_bf16 a[20:23], v[76:79], v[108:111], a[20:23]
    v_mfma_f32_16x16x32_bf16 a[24:27], v[76:79], v[112:115], a[24:27]
    v_mfma_f32_16x16x32_bf16 a[28:31], v[76:79], v[116:119], a[28:31]
    v_mfma_f32_16x16x32_bf16 a[32:35], v[80:83], v[104:107], a[32:35]
    v_mfma_f32_16x16x32_bf16 a[36:39], v[80:83], v[108:111], a[36:39]
    v_mfma_f32_16x16x32_bf16 a[40:43], v[80:83], v[112:115], a[40:43]
    v_mfma_f32_16x16x32_bf16 a[44:47], v[80:83], v[116:119], a[44:47]
    v_mfma_f32_16x16x32_bf16 a[48:51], v[84:87], v[104:107], a[48:51]
    v_mfma_f32_16x16x32_bf16 a[52:55], v[84:87], v[108:111], a[52:55]
    v_mfma_f32_16x16x32_bf16 a[56:59], v[84:87], v[112:115], a[56:59]
    v_mfma_f32_16x16x32_bf16 a[60:63], v[84:87], v[116:119], a[60:63]
    buffer_load_dwordx4 v[72:75], v10, s[48:51], s61 offen
    buffer_load_dwordx4 v[76:79], v11, s[48:51], s61 offen
    buffer_load_dwordx4 v[80:83], v12, s[48:51], s61 offen
    buffer_load_dwordx4 v[84:87], v13, s[48:51], s61 offen
    s_add_u32 s61, s61, 0x400
    ds_read_b128 v[104:107], v19 offset:256
    ds_read_b128 v[108:111], v19 offset:16640
    ds_read_b128 v[112:115], v19 offset:33024
    ds_read_b128 v[116:119], v19 offset:49408
    s_waitcnt lgkmcnt(4)
    s_waitcnt vmcnt(8)
    v_mfma_f32_16x16x32_bf16 a[0:3], v[40:43], v[88:91], a[0:3]
    v_mfma_f32_16x16x32_bf16 a[4:7], v[40:43], v[92:95], a[4:7]
    v_mfma_f32_16x16x32_bf16 a[8:11], v[40:43], v[96:99], a[8:11]
    v_mfma_f32_16x16x32_bf16 a[12:15], v[40:43], v[100:103], a[12:15]
    v_mfma_f32_16x16x32_bf16 a[16:19], v[44:47], v[88:91], a[16:19]
    v_mfma_f32_16x16x32_bf16 a[20:23], v[44:47], v[92:95], a[20:23]
    v_mfma_f32_16x16x32_bf16 a[24:27], v[44:47], v[96:99], a[24:27]
    v_mfma_f32_16x16x32_bf16 a[28:31], v[44:47], v[100:103], a[28:31]
    v_mfma_f32_16x16x32_bf16 a[32:35], v[48:51], v[88:91], a[32:35]
    v_mfma_f32_16x16x32_bf16 a[36:39], v[48:51], v[92:95], a[36:39]
    v_mfma_f32_16x16x32_bf16 a[40:43], v[48:51], v[96:99], a[40:43]
    v_mfma_f32_16x16x32_bf16 a[44:47], v[48:51], v[100:103], a[44:47]
    v_mfma_f32_16x16x32_bf16 a[48:51], v[52:55], v[88:91], a[48:51]
    v_mfma_f32_16x16x32_bf16 a[52:55], v[52:55], v[92:95], a[52:55]
    v_mfma_f32_16x16x32_bf16 a[56:59], v[52:55], v[96:99], a[56:59]
    v_mfma_f32_16x16x32_bf16 a[60:63], v[52:55], v[100:103], a[60:63]
    buffer_load_dwordx4 v[40:43], v10, s[48:51], s61 offen
    buffer_load_dwordx4 v[44:47], v11, s[48:51], s61 offen
    buffer_load_dwordx4 v[48:51], v12, s[48:51], s61 offen
    buffer_load_dwordx4 v[52:55], v13, s[48:51], s61 offen
    s_add_u32 s61, s61, 0x400
    ds_read_b128 v[88:91], v16 offset:512
    ds_read_b128 v[92:95], v16 offset:16896
    ds_read_b128 v[96:99], v16 offset:33280
    ds_read_b128 v[100:103], v16 offset:49664
    s_waitcnt lgkmcnt(4)
    s_waitcnt vmcnt(8)
    v_mfma_f32_16x16x32_bf16 a[0:3], v[56:59], v[104:107], a[0:3]
    v_mfma_f32_16x16x32_bf16 a[4:7], v[56:59], v[108:111], a[4:7]
    v_mfma_f32_16x16x32_bf16 a[8:11], v[56:59], v[112:115], a[8:11]
    v_mfma_f32_16x16x32_bf16 a[12:15], v[56:59], v[116:119], a[12:15]
    v_mfma_f32_16x16x32_bf16 a[16:19], v[60:63], v[104:107], a[16:19]
    v_mfma_f32_16x16x32_bf16 a[20:23], v[60:63], v[108:111], a[20:23]
    v_mfma_f32_16x16x32_bf16 a[24:27], v[60:63], v[112:115], a[24:27]
    v_mfma_f32_16x16x32_bf16 a[28:31], v[60:63], v[116:119], a[28:31]
    v_mfma_f32_16x16x32_bf16 a[32:35], v[64:67], v[104:107], a[32:35]
    v_mfma_f32_16x16x32_bf16 a[36:39], v[64:67], v[108:111], a[36:39]
    v_mfma_f32_16x16x32_bf16 a[40:43], v[64:67], v[112:115], a[40:43]
    v_mfma_f32_16x16x32_bf16 a[44:47], v[64:67], v[116:119], a[44:47]
    v_mfma_f32_16x16x32_bf16 a[48:51], v[68:71], v[104:107], a[48:51]
    v_mfma_f32_16x16x32_bf16 a[52:55], v[68:71], v[108:111], a[52:55]
    v_mfma_f32_16x16x32_bf16 a[56:59], v[68:71], v[112:115], a[56:59]
    v_mfma_f32_16x16x32_bf16 a[60:63], v[68:71], v[116:119], a[60:63]
    buffer_load_dwordx4 v[56:59], v10, s[48:51], s61 offen
    buffer_load_dwordx4 v[60:63], v11, s[48:51], s61 offen
    buffer_load_dwordx4 v[64:67], v12, s[48:51], s61 offen
    buffer_load_dwordx4 v[68:71], v13, s[48:51], s61 offen
    s_add_u32 s61, s61, 0x400
    ds_read_b128 v[104:107], v17 offset:512
    ds_read_b128 v[108:111], v17 offset:16896
    ds_read_b128 v[112:115], v17 offset:33280
    ds_read_b128 v[116:119], v17 offset:49664
    s_waitcnt lgkmcnt(4)
    s_waitcnt vmcnt(8)
    v_mfma_f32_16x16x32_bf16 a[0:3], v[72:75], v[88:91], a[0:3]
    v_mfma_f32_16x16x32_bf16 a[4:7], v[72:75], v[92:95], a[4:7]
    v_mfma_f32_16x16x32_bf16 a[8:11], v[72:75], v[96:99], a[8:11]
    v_mfma_f32_16x16x32_bf16 a[12:15], v[72:75], v[100:103], a[12:15]
    v_mfma_f32_16x16x32_bf16 a[16:19], v[76:79], v[88:91], a[16:19]
    v_mfma_f32_16x16x32_bf16 a[20:23], v[76:79], v[92:95], a[20:23]
    v_mfma_f32_16x16x32_bf16 a[24:27], v[76:79], v[96:99], a[24:27]
    v_mfma_f32_16x16x32_bf16 a[28:31], v[76:79], v[100:103], a[28:31]
    v_mfma_f32_16x16x32_bf16 a[32:35], v[80:83], v[88:91], a[32:35]
    v_mfma_f32_16x16x32_bf16 a[36:39], v[80:83], v[92:95], a[36:39]
    v_mfma_f32_16x16x32_bf16 a[40:43], v[80:83], v[96:99], a[40:43]
    v_mfma_f32_16x16x32_bf16 a[44:47], v[80:83], v[100:103], a[44:47]
    v_mfma_f32_16x16x32_bf16 a[48:51], v[84:87], v[88:91], a[48:51]
    v_mfma_f32_16x16x32_bf16 a[52:55], v[84:87], v[92:95], a[52:55]
    v_mfma_f32_16x16x32_bf16 a[56:59], v[84:87], v[96:99], a[56:59]
    v_mfma_f32_16x16x32_bf16 a[60:63], v[84:87], v[100:103], a[60:63]
    buffer_load_dwordx4 v[72:75], v10, s[48:51], s61 offen
    buffer_load_dwordx4 v[76:79], v11, s[48:51], s61 offen
    buffer_load_dwordx4 v[80:83], v12, s[48:51], s61 offen
    buffer_load_dwordx4 v[84:87], v13, s[48:51], s61 offen
    s_add_u32 s61, s61, 0x400
    ds_read_b128 v[88:91], v18 offset:512
    ds_read_b128 v[92:95], v18 offset:16896
    ds_read_b128 v[96:99], v18 offset:33280
    ds_read_b128 v[100:103], v18 offset:49664
    s_waitcnt lgkmcnt(4)
    s_waitcnt vmcnt(8)
    v_mfma_f32_16x16x32_bf16 a[0:3], v[40:43], v[104:107], a[0:3]
    v_mfma_f32_16x16x32_bf16 a[4:7], v[40:43], v[108:111], a[4:7]
    v_mfma_f32_16x16x32_bf16 a[8:11], v[40:43], v[112:115], a[8:11]
    v_mfma_f32_16x16x32_bf16 a[12:15], v[40:43], v[116:119], a[12:15]
    v_mfma_f32_16x16x32_bf16 a[16:19], v[44:47], v[104:107], a[16:19]
    v_mfma_f32_16x16x32_bf16 a[20:23], v[44:47], v[108:111], a[20:23]
    v_mfma_f32_16x16x32_bf16 a[24:27], v[44:47], v[112:115], a[24:27]
    v_mfma_f32_16x16x32_bf16 a[28:31], v[44:47], v[116:119], a[28:31]
    v_mfma_f32_16x16x32_bf16 a[32:35], v[48:51], v[104:107], a[32:35]
    v_mfma_f32_16x16x32_bf16 a[36:39], v[48:51], v[108:111], a[36:39]
    v_mfma_f32_16x16x32_bf16 a[40:43], v[48:51], v[112:115], a[40:43]
    v_mfma_f32_16x16x32_bf16 a[44:47], v[48:51], v[116:119], a[44:47]
    v_mfma_f32_16x16x32_bf16 a[48:51], v[52:55], v[104:107], a[48:51]
    v_mfma_f32_16x16x32_bf16 a[52:55], v[52:55], v[108:111], a[52:55]
    v_mfma_f32_16x16x32_bf16 a[56:59], v[52:55], v[112:115], a[56:59]
    v_mfma_f32_16x16x32_bf16 a[60:63], v[52:55], v[116:119], a[60:63]
    buffer_load_dwordx4 v[40:43], v10, s[48:51], s61 offen
    buffer_load_dwordx4 v[44:47], v11, s[48:51], s61 offen
    buffer_load_dwordx4 v[48:51], v12, s[48:51], s61 offen
    buffer_load_dwordx4 v[52:55], v13, s[48:51], s61 offen
    s_add_u32 s61, s61, 0x400
    ds_read_b128 v[104:107], v19 offset:512
    ds_read_b128 v[108:111], v19 offset:16896
    ds_read_b128 v[112:115], v19 offset:33280
    ds_read_b128 v[116:119], v19 offset:49664
    s_waitcnt lgkmcnt(4)
    s_waitcnt vmcnt(8)
    v_mfma_f32_16x16x32_bf16 a[0:3], v[56:59], v[88:91], a[0:3]
    v_mfma_f32_16x16x32_bf16 a[4:7], v[56:59], v[92:95], a[4:7]
    v_mfma_f32_16x16x32_bf16 a[8:11], v[56:59], v[96:99], a[8:11]
    v_mfma_f32_16x16x32_bf16 a[12:15], v[56:59], v[100:103], a[12:15]
    v_mfma_f32_16x16x32_bf16 a[16:19], v[60:63], v[88:91], a[16:19]
    v_mfma_f32_16x16x32_bf16 a[20:23], v[60:63], v[92:95], a[20:23]
    v_mfma_f32_16x16x32_bf16 a[24:27], v[60:63], v[96:99], a[24:27]
    v_mfma_f32_16x16x32_bf16 a[28:31], v[60:63], v[100:103], a[28:31]
    v_mfma_f32_16x16x32_bf16 a[32:35], v[64:67], v[88:91], a[32:35]
    v_mfma_f32_16x16x32_bf16 a[36:39], v[64:67], v[92:95], a[36:39]
    v_mfma_f32_16x16x32_bf16 a[40:43], v[64:67], v[96:99], a[40:43]
    v_mfma_f32_16x16x32_bf16 a[44:47], v[64:67], v[100:103], a[44:47]
    v_mfma_f32_16x16x32_bf16 a[48:51], v[68:71], v[88:91], a[48:51]
    v_mfma_f32_16x16x32_bf16 a[52:55], v[68:71], v[92:95], a[52:55]
    v_mfma_f32_16x16x32_bf16 a[56:59], v[68:71], v[96:99], a[56:59]
    v_mfma_f32_16x16x32_bf16 a[60:63], v[68:71], v[100:103], a[60:63]
    buffer_load_dwordx4 v[56:59], v10, s[48:51], s61 offen
    buffer_load_dwordx4 v[60:63], v11, s[48:51], s61 offen
    buffer_load_dwordx4 v[64:67], v12, s[48:51], s61 offen
    buffer_load_dwordx4 v[68:71], v13, s[48:51], s61 offen
    s_add_u32 s61, s61, 0x400
    ds_read_b128 v[88:91], v16 offset:768
    ds_read_b128 v[92:95], v16 offset:17152
    ds_read_b128 v[96:99], v16 offset:33536
    ds_read_b128 v[100:103], v16 offset:49920
    s_waitcnt lgkmcnt(4)
    s_waitcnt vmcnt(8)
    v_mfma_f32_16x16x32_bf16 a[0:3], v[72:75], v[104:107], a[0:3]
    v_mfma_f32_16x16x32_bf16 a[4:7], v[72:75], v[108:111], a[4:7]
    v_mfma_f32_16x16x32_bf16 a[8:11], v[72:75], v[112:115], a[8:11]
    v_mfma_f32_16x16x32_bf16 a[12:15], v[72:75], v[116:119], a[12:15]
    v_mfma_f32_16x16x32_bf16 a[16:19], v[76:79], v[104:107], a[16:19]
    v_mfma_f32_16x16x32_bf16 a[20:23], v[76:79], v[108:111], a[20:23]
    v_mfma_f32_16x16x32_bf16 a[24:27], v[76:79], v[112:115], a[24:27]
    v_mfma_f32_16x16x32_bf16 a[28:31], v[76:79], v[116:119], a[28:31]
    v_mfma_f32_16x16x32_bf16 a[32:35], v[80:83], v[104:107], a[32:35]
    v_mfma_f32_16x16x32_bf16 a[36:39], v[80:83], v[108:111], a[36:39]
    v_mfma_f32_16x16x32_bf16 a[40:43], v[80:83], v[112:115], a[40:43]
    v_mfma_f32_16x16x32_bf16 a[44:47], v[80:83], v[116:119], a[44:47]
    v_mfma_f32_16x16x32_bf16 a[48:51], v[84:87], v[104:107], a[48:51]
    v_mfma_f32_16x16x32_bf16 a[52:55], v[84:87], v[108:111], a[52:55]
    v_mfma_f32_16x16x32_bf16 a[56:59], v[84:87], v[112:115], a[56:59]
    v_mfma_f32_16x16x32_bf16 a[60:63], v[84:87], v[116:119], a[60:63]
    buffer_load_dwordx4 v[72:75], v10, s[48:51], s61 offen
    buffer_load_dwordx4 v[76:79], v11, s[48:51], s61 offen
    buffer_load_dwordx4 v[80:83], v12, s[48:51], s61 offen
    buffer_load_dwordx4 v[84:87], v13, s[48:51], s61 offen
    s_add_u32 s61, s61, 0x400
    ds_read_b128 v[104:107], v17 offset:768
    ds_read_b128 v[108:111], v17 offset:17152
    ds_read_b128 v[112:115], v17 offset:33536
    ds_read_b128 v[116:119], v17 offset:49920
    s_waitcnt lgkmcnt(4)
    s_waitcnt vmcnt(8)
    v_mfma_f32_16x16x32_bf16 a[0:3], v[40:43], v[88:91], a[0:3]
    v_mfma_f32_16x16x32_bf16 a[4:7], v[40:43], v[92:95], a[4:7]
    v_mfma_f32_16x16x32_bf16 a[8:11], v[40:43], v[96:99], a[8:11]
    v_mfma_f32_16x16x32_bf16 a[12:15], v[40:43], v[100:103], a[12:15]
    v_mfma_f32_16x16x32_bf16 a[16:19], v[44:47], v[88:91], a[16:19]
    v_mfma_f32_16x16x32_bf16 a[20:23], v[44:47], v[92:95], a[20:23]
    v_mfma_f32_16x16x32_bf16 a[24:27], v[44:47], v[96:99], a[24:27]
    v_mfma_f32_16x16x32_bf16 a[28:31], v[44:47], v[100:103], a[28:31]
    v_mfma_f32_16x16x32_bf16 a[32:35], v[48:51], v[88:91], a[32:35]
    v_mfma_f32_16x16x32_bf16 a[36:39], v[48:51], v[92:95], a[36:39]
    v_mfma_f32_16x16x32_bf16 a[40:43], v[48:51], v[96:99], a[40:43]
    v_mfma_f32_16x16x32_bf16 a[44:47], v[48:51], v[100:103], a[44:47]
    v_mfma_f32_16x16x32_bf16 a[48:51], v[52:55], v[88:91], a[48:51]
    v_mfma_f32_16x16x32_bf16 a[52:55], v[52:55], v[92:95], a[52:55]
    v_mfma_f32_16x16x32_bf16 a[56:59], v[52:55], v[96:99], a[56:59]
    v_mfma_f32_16x16x32_bf16 a[60:63], v[52:55], v[100:103], a[60:63]
    buffer_load_dwordx4 v[40:43], v10, s[48:51], s61 offen
    buffer_load_dwordx4 v[44:47], v11, s[48:51], s61 offen
    buffer_load_dwordx4 v[48:51], v12, s[48:51], s61 offen
    buffer_load_dwordx4 v[52:55], v13, s[48:51], s61 offen
    s_add_u32 s61, s61, 0x400
    ds_read_b128 v[88:91], v18 offset:768
    ds_read_b128 v[92:95], v18 offset:17152
    ds_read_b128 v[96:99], v18 offset:33536
    ds_read_b128 v[100:103], v18 offset:49920
    s_waitcnt lgkmcnt(4)
    s_waitcnt vmcnt(8)
    v_mfma_f32_16x16x32_bf16 a[0:3], v[56:59], v[104:107], a[0:3]
    v_mfma_f32_16x16x32_bf16 a[4:7], v[56:59], v[108:111], a[4:7]
    v_mfma_f32_16x16x32_bf16 a[8:11], v[56:59], v[112:115], a[8:11]
    v_mfma_f32_16x16x32_bf16 a[12:15], v[56:59], v[116:119], a[12:15]
    v_mfma_f32_16x16x32_bf16 a[16:19], v[60:63], v[104:107], a[16:19]
    v_mfma_f32_16x16x32_bf16 a[20:23], v[60:63], v[108:111], a[20:23]
    v_mfma_f32_16x16x32_bf16 a[24:27], v[60:63], v[112:115], a[24:27]
    v_mfma_f32_16x16x32_bf16 a[28:31], v[60:63], v[116:119], a[28:31]
    v_mfma_f32_16x16x32_bf16 a[32:35], v[64:67], v[104:107], a[32:35]
    v_mfma_f32_16x16x32_bf16 a[36:39], v[64:67], v[108:111], a[36:39]
    v_mfma_f32_16x16x32_bf16 a[40:43], v[64:67], v[112:115], a[40:43]
    v_mfma_f32_16x16x32_bf16 a[44:47], v[64:67], v[116:119], a[44:47]
    v_mfma_f32_16x16x32_bf16 a[48:51], v[68:71], v[104:107], a[48:51]
    v_mfma_f32_16x16x32_bf16 a[52:55], v[68:71], v[108:111], a[52:55]
    v_mfma_f32_16x16x32_bf16 a[56:59], v[68:71], v[112:115], a[56:59]
    v_mfma_f32_16x16x32_bf16 a[60:63], v[68:71], v[116:119], a[60:63]
    ds_read_b128 v[104:107], v19 offset:768
    ds_read_b128 v[108:111], v19 offset:17152
    ds_read_b128 v[112:115], v19 offset:33536
    ds_read_b128 v[116:119], v19 offset:49920
    s_waitcnt lgkmcnt(4)
    s_waitcnt vmcnt(4)
    v_mfma_f32_16x16x32_bf16 a[0:3], v[72:75], v[88:91], a[0:3]
    v_mfma_f32_16x16x32_bf16 a[4:7], v[72:75], v[92:95], a[4:7]
    v_mfma_f32_16x16x32_bf16 a[8:11], v[72:75], v[96:99], a[8:11]
    v_mfma_f32_16x16x32_bf16 a[12:15], v[72:75], v[100:103], a[12:15]
    v_mfma_f32_16x16x32_bf16 a[16:19], v[76:79], v[88:91], a[16:19]
    v_mfma_f32_16x16x32_bf16 a[20:23], v[76:79], v[92:95], a[20:23]
    v_mfma_f32_16x16x32_bf16 a[24:27], v[76:79], v[96:99], a[24:27]
    v_mfma_f32_16x16x32_bf16 a[28:31], v[76:79], v[100:103], a[28:31]
    v_mfma_f32_16x16x32_bf16 a[32:35], v[80:83], v[88:91], a[32:35]
    v_mfma_f32_16x16x32_bf16 a[36:39], v[80:83], v[92:95], a[36:39]
    v_mfma_f32_16x16x32_bf16 a[40:43], v[80:83], v[96:99], a[40:43]
    v_mfma_f32_16x16x32_bf16 a[44:47], v[80:83], v[100:103], a[44:47]
    v_mfma_f32_16x16x32_bf16 a[48:51], v[84:87], v[88:91], a[48:51]
    v_mfma_f32_16x16x32_bf16 a[52:55], v[84:87], v[92:95], a[52:55]
    v_mfma_f32_16x16x32_bf16 a[56:59], v[84:87], v[96:99], a[56:59]
    v_mfma_f32_16x16x32_bf16 a[60:63], v[84:87], v[100:103], a[60:63]
    s_waitcnt lgkmcnt(0)
    s_waitcnt vmcnt(0)
    v_mfma_f32_16x16x32_bf16 a[0:3], v[40:43], v[104:107], a[0:3]
    v_mfma_f32_16x16x32_bf16 a[4:7], v[40:43], v[108:111], a[4:7]
    v_mfma_f32_16x16x32_bf16 a[8:11], v[40:43], v[112:115], a[8:11]
    v_mfma_f32_16x16x32_bf16 a[12:15], v[40:43], v[116:119], a[12:15]
    v_mfma_f32_16x16x32_bf16 a[16:19], v[44:47], v[104:107], a[16:19]
    v_mfma_f32_16x16x32_bf16 a[20:23], v[44:47], v[108:111], a[20:23]
    v_mfma_f32_16x16x32_bf16 a[24:27], v[44:47], v[112:115], a[24:27]
    v_mfma_f32_16x16x32_bf16 a[28:31], v[44:47], v[116:119], a[28:31]
    v_mfma_f32_16x16x32_bf16 a[32:35], v[48:51], v[104:107], a[32:35]
    v_mfma_f32_16x16x32_bf16 a[36:39], v[48:51], v[108:111], a[36:39]
    v_mfma_f32_16x16x32_bf16 a[40:43], v[48:51], v[112:115], a[40:43]
    v_mfma_f32_16x16x32_bf16 a[44:47], v[48:51], v[116:119], a[44:47]
    v_mfma_f32_16x16x32_bf16 a[48:51], v[52:55], v[104:107], a[48:51]
    v_mfma_f32_16x16x32_bf16 a[52:55], v[52:55], v[108:111], a[52:55]
    v_mfma_f32_16x16x32_bf16 a[56:59], v[52:55], v[112:115], a[56:59]
    v_mfma_f32_16x16x32_bf16 a[60:63], v[52:55], v[116:119], a[60:63]
    v_and_b32 v2, 15, v1
    v_lshrrev_b32 v3, 4, v1
    v_lshlrev_b32 v4, 4, v2
    v_lshrrev_b32 v5, 1, v3
    v_lshl_add_u32 v4, v5, 8, v4
    v_and_b32 v5, 1, v3
    v_lshl_add_u32 v4, v5, 3, v4
    v_lshlrev_b32 v5, 3, v3
    buffer_load_dwordx2 v[136:137], v5, s[56:59], s63 offen offset:0
    buffer_load_dwordx2 v[138:139], v5, s[56:59], s63 offen offset:32
    buffer_load_dwordx2 v[140:141], v5, s[56:59], s63 offen offset:64
    buffer_load_dwordx2 v[142:143], v5, s[56:59], s63 offen offset:96
    s_mul_i32 s6, s4, 0x38000
    s_lshl_b32 s7, s63, 4
    s_add_u32 s64, s6, s7
    s_add_u32 s65, s64, 0xe000
    s_add_u32 s66, s64, 0x1c000
    s_add_u32 s67, s64, 0x2a000
    s_waitcnt vmcnt(0)
    v_lshlrev_b32 v144, 16, v136
    v_and_b32 v145, 0xffff0000, v136
    v_lshlrev_b32 v146, 16, v137
    v_and_b32 v147, 0xffff0000, v137
    v_lshlrev_b32 v148, 16, v138
    v_and_b32 v149, 0xffff0000, v138
    v_lshlrev_b32 v150, 16, v139
    v_and_b32 v151, 0xffff0000, v139
    v_lshlrev_b32 v152, 16, v140
    v_and_b32 v153, 0xffff0000, v140
    v_lshlrev_b32 v154, 16, v141
    v_and_b32 v155, 0xffff0000, v141
    v_lshlrev_b32 v156, 16, v142
    v_and_b32 v157, 0xffff0000, v142
    v_lshlrev_b32 v158, 16, v143
    v_and_b32 v159, 0xffff0000, v143
    s_nop 7
    v_accvgpr_read_b32 v120, a0
    v_accvgpr_read_b32 v121, a1
    v_accvgpr_read_b32 v122, a2
    v_accvgpr_read_b32 v123, a3
    v_cvt_pk_bf16_f32 v124, v120, v121
    v_cvt_pk_bf16_f32 v125, v122, v123
    v_lshlrev_b32 v120, 16, v124
    v_and_b32 v121, 0xffff0000, v124
    v_lshlrev_b32 v122, 16, v125
    v_and_b32 v123, 0xffff0000, v125
    v_pk_add_f32 v[120:121], v[120:121], v[144:145]
    v_pk_add_f32 v[122:123], v[122:123], v[146:147]
    v_cvt_pk_bf16_f32 v124, v120, v121
    v_cvt_pk_bf16_f32 v125, v122, v123
    v_pk_max_i16 v124, v124, 0
    v_pk_max_i16 v125, v125, 0
    v_lshlrev_b32 v120, 16, v124
    v_and_b32 v121, 0xffff0000, v124
    v_lshlrev_b32 v122, 16, v125
    v_and_b32 v123, 0xffff0000, v125
    v_pk_mul_f32 v[120:121], v[120:121], v[120:121]
    v_pk_mul_f32 v[122:123], v[122:123], v[122:123]
    v_cvt_pk_bf16_f32 v124, v120, v121
    v_cvt_pk_bf16_f32 v125, v122, v123
    buffer_store_dwordx2 v[124:125], v4, s[52:55], s64 offen offset:0
    v_accvgpr_read_b32 v128, a4
    v_accvgpr_read_b32 v129, a5
    v_accvgpr_read_b32 v130, a6
    v_accvgpr_read_b32 v131, a7
    v_cvt_pk_bf16_f32 v132, v128, v129
    v_cvt_pk_bf16_f32 v133, v130, v131
    v_lshlrev_b32 v128, 16, v132
    v_and_b32 v129, 0xffff0000, v132
    v_lshlrev_b32 v130, 16, v133
    v_and_b32 v131, 0xffff0000, v133
    v_pk_add_f32 v[128:129], v[128:129], v[144:145]
    v_pk_add_f32 v[130:131], v[130:131], v[146:147]
    v_cvt_pk_bf16_f32 v132, v128, v129
    v_cvt_pk_bf16_f32 v133, v130, v131
    v_pk_max_i16 v132, v132, 0
    v_pk_max_i16 v133, v133, 0
    v_lshlrev_b32 v128, 16, v132
    v_and_b32 v129, 0xffff0000, v132
    v_lshlrev_b32 v130, 16, v133
    v_and_b32 v131, 0xffff0000, v133
    v_pk_mul_f32 v[128:129], v[128:129], v[128:129]
    v_pk_mul_f32 v[130:131], v[130:131], v[130:131]
    v_cvt_pk_bf16_f32 v132, v128, v129
    v_cvt_pk_bf16_f32 v133, v130, v131
    buffer_store_dwordx2 v[132:133], v4, s[52:55], s65 offen offset:0
    v_accvgpr_read_b32 v120, a8
    v_accvgpr_read_b32 v121, a9
    v_accvgpr_read_b32 v122, a10
    v_accvgpr_read_b32 v123, a11
    v_cvt_pk_bf16_f32 v124, v120, v121
    v_cvt_pk_bf16_f32 v125, v122, v123
    v_lshlrev_b32 v120, 16, v124
    v_and_b32 v121, 0xffff0000, v124
    v_lshlrev_b32 v122, 16, v125
    v_and_b32 v123, 0xffff0000, v125
    v_pk_add_f32 v[120:121], v[120:121], v[144:145]
    v_pk_add_f32 v[122:123], v[122:123], v[146:147]
    v_cvt_pk_bf16_f32 v124, v120, v121
    v_cvt_pk_bf16_f32 v125, v122, v123
    v_pk_max_i16 v124, v124, 0
    v_pk_max_i16 v125, v125, 0
    v_lshlrev_b32 v120, 16, v124
    v_and_b32 v121, 0xffff0000, v124
    v_lshlrev_b32 v122, 16, v125
    v_and_b32 v123, 0xffff0000, v125
    v_pk_mul_f32 v[120:121], v[120:121], v[120:121]
    v_pk_mul_f32 v[122:123], v[122:123], v[122:123]
    v_cvt_pk_bf16_f32 v124, v120, v121
    v_cvt_pk_bf16_f32 v125, v122, v123
    buffer_store_dwordx2 v[124:125], v4, s[52:55], s66 offen offset:0
    v_accvgpr_read_b32 v128, a12
    v_accvgpr_read_b32 v129, a13
    v_accvgpr_read_b32 v130, a14
    v_accvgpr_read_b32 v131, a15
    v_cvt_pk_bf16_f32 v132, v128, v129
    v_cvt_pk_bf16_f32 v133, v130, v131
    v_lshlrev_b32 v128, 16, v132
    v_and_b32 v129, 0xffff0000, v132
    v_lshlrev_b32 v130, 16, v133
    v_and_b32 v131, 0xffff0000, v133
    v_pk_add_f32 v[128:129], v[128:129], v[144:145]
    v_pk_add_f32 v[130:131], v[130:131], v[146:147]
    v_cvt_pk_bf16_f32 v132, v128, v129
    v_cvt_pk_bf16_f32 v133, v130, v131
    v_pk_max_i16 v132, v132, 0
    v_pk_max_i16 v133, v133, 0
    v_lshlrev_b32 v128, 16, v132
    v_and_b32 v129, 0xffff0000, v132
    v_lshlrev_b32 v130, 16, v133
    v_and_b32 v131, 0xffff0000, v133
    v_pk_mul_f32 v[128:129], v[128:129], v[128:129]
    v_pk_mul_f32 v[130:131], v[130:131], v[130:131]
    v_cvt_pk_bf16_f32 v132, v128, v129
    v_cvt_pk_bf16_f32 v133, v130, v131
    buffer_store_dwordx2 v[132:133], v4, s[52:55], s67 offen offset:0
    v_accvgpr_read_b32 v120, a16
    v_accvgpr_read_b32 v121, a17
    v_accvgpr_read_b32 v122, a18
    v_accvgpr_read_b32 v123, a19
    v_cvt_pk_bf16_f32 v124, v120, v121
    v_cvt_pk_bf16_f32 v125, v122, v123
    v_lshlrev_b32 v120, 16, v124
    v_and_b32 v121, 0xffff0000, v124
    v_lshlrev_b32 v122, 16, v125
    v_and_b32 v123, 0xffff0000, v125
    v_pk_add_f32 v[120:121], v[120:121], v[148:149]
    v_pk_add_f32 v[122:123], v[122:123], v[150:151]
    v_cvt_pk_bf16_f32 v124, v120, v121
    v_cvt_pk_bf16_f32 v125, v122, v123
    v_pk_max_i16 v124, v124, 0
    v_pk_max_i16 v125, v125, 0
    v_lshlrev_b32 v120, 16, v124
    v_and_b32 v121, 0xffff0000, v124
    v_lshlrev_b32 v122, 16, v125
    v_and_b32 v123, 0xffff0000, v125
    v_pk_mul_f32 v[120:121], v[120:121], v[120:121]
    v_pk_mul_f32 v[122:123], v[122:123], v[122:123]
    v_cvt_pk_bf16_f32 v124, v120, v121
    v_cvt_pk_bf16_f32 v125, v122, v123
    buffer_store_dwordx2 v[124:125], v4, s[52:55], s64 offen offset:512
    v_accvgpr_read_b32 v128, a20
    v_accvgpr_read_b32 v129, a21
    v_accvgpr_read_b32 v130, a22
    v_accvgpr_read_b32 v131, a23
    v_cvt_pk_bf16_f32 v132, v128, v129
    v_cvt_pk_bf16_f32 v133, v130, v131
    v_lshlrev_b32 v128, 16, v132
    v_and_b32 v129, 0xffff0000, v132
    v_lshlrev_b32 v130, 16, v133
    v_and_b32 v131, 0xffff0000, v133
    v_pk_add_f32 v[128:129], v[128:129], v[148:149]
    v_pk_add_f32 v[130:131], v[130:131], v[150:151]
    v_cvt_pk_bf16_f32 v132, v128, v129
    v_cvt_pk_bf16_f32 v133, v130, v131
    v_pk_max_i16 v132, v132, 0
    v_pk_max_i16 v133, v133, 0
    v_lshlrev_b32 v128, 16, v132
    v_and_b32 v129, 0xffff0000, v132
    v_lshlrev_b32 v130, 16, v133
    v_and_b32 v131, 0xffff0000, v133
    v_pk_mul_f32 v[128:129], v[128:129], v[128:129]
    v_pk_mul_f32 v[130:131], v[130:131], v[130:131]
    v_cvt_pk_bf16_f32 v132, v128, v129
    v_cvt_pk_bf16_f32 v133, v130, v131
    buffer_store_dwordx2 v[132:133], v4, s[52:55], s65 offen offset:512
    v_accvgpr_read_b32 v120, a24
    v_accvgpr_read_b32 v121, a25
    v_accvgpr_read_b32 v122, a26
    v_accvgpr_read_b32 v123, a27
    v_cvt_pk_bf16_f32 v124, v120, v121
    v_cvt_pk_bf16_f32 v125, v122, v123
    v_lshlrev_b32 v120, 16, v124
    v_and_b32 v121, 0xffff0000, v124
    v_lshlrev_b32 v122, 16, v125
    v_and_b32 v123, 0xffff0000, v125
    v_pk_add_f32 v[120:121], v[120:121], v[148:149]
    v_pk_add_f32 v[122:123], v[122:123], v[150:151]
    v_cvt_pk_bf16_f32 v124, v120, v121
    v_cvt_pk_bf16_f32 v125, v122, v123
    v_pk_max_i16 v124, v124, 0
    v_pk_max_i16 v125, v125, 0
    v_lshlrev_b32 v120, 16, v124
    v_and_b32 v121, 0xffff0000, v124
    v_lshlrev_b32 v122, 16, v125
    v_and_b32 v123, 0xffff0000, v125
    v_pk_mul_f32 v[120:121], v[120:121], v[120:121]
    v_pk_mul_f32 v[122:123], v[122:123], v[122:123]
    v_cvt_pk_bf16_f32 v124, v120, v121
    v_cvt_pk_bf16_f32 v125, v122, v123
    buffer_store_dwordx2 v[124:125], v4, s[52:55], s66 offen offset:512
    v_accvgpr_read_b32 v128, a28
    v_accvgpr_read_b32 v129, a29
    v_accvgpr_read_b32 v130, a30
    v_accvgpr_read_b32 v131, a31
    v_cvt_pk_bf16_f32 v132, v128, v129
    v_cvt_pk_bf16_f32 v133, v130, v131
    v_lshlrev_b32 v128, 16, v132
    v_and_b32 v129, 0xffff0000, v132
    v_lshlrev_b32 v130, 16, v133
    v_and_b32 v131, 0xffff0000, v133
    v_pk_add_f32 v[128:129], v[128:129], v[148:149]
    v_pk_add_f32 v[130:131], v[130:131], v[150:151]
    v_cvt_pk_bf16_f32 v132, v128, v129
    v_cvt_pk_bf16_f32 v133, v130, v131
    v_pk_max_i16 v132, v132, 0
    v_pk_max_i16 v133, v133, 0
    v_lshlrev_b32 v128, 16, v132
    v_and_b32 v129, 0xffff0000, v132
    v_lshlrev_b32 v130, 16, v133
    v_and_b32 v131, 0xffff0000, v133
    v_pk_mul_f32 v[128:129], v[128:129], v[128:129]
    v_pk_mul_f32 v[130:131], v[130:131], v[130:131]
    v_cvt_pk_bf16_f32 v132, v128, v129
    v_cvt_pk_bf16_f32 v133, v130, v131
    buffer_store_dwordx2 v[132:133], v4, s[52:55], s67 offen offset:512
    v_accvgpr_read_b32 v120, a32
    v_accvgpr_read_b32 v121, a33
    v_accvgpr_read_b32 v122, a34
    v_accvgpr_read_b32 v123, a35
    v_cvt_pk_bf16_f32 v124, v120, v121
    v_cvt_pk_bf16_f32 v125, v122, v123
    v_lshlrev_b32 v120, 16, v124
    v_and_b32 v121, 0xffff0000, v124
    v_lshlrev_b32 v122, 16, v125
    v_and_b32 v123, 0xffff0000, v125
    v_pk_add_f32 v[120:121], v[120:121], v[152:153]
    v_pk_add_f32 v[122:123], v[122:123], v[154:155]
    v_cvt_pk_bf16_f32 v124, v120, v121
    v_cvt_pk_bf16_f32 v125, v122, v123
    v_pk_max_i16 v124, v124, 0
    v_pk_max_i16 v125, v125, 0
    v_lshlrev_b32 v120, 16, v124
    v_and_b32 v121, 0xffff0000, v124
    v_lshlrev_b32 v122, 16, v125
    v_and_b32 v123, 0xffff0000, v125
    v_pk_mul_f32 v[120:121], v[120:121], v[120:121]
    v_pk_mul_f32 v[122:123], v[122:123], v[122:123]
    v_cvt_pk_bf16_f32 v124, v120, v121
    v_cvt_pk_bf16_f32 v125, v122, v123
    buffer_store_dwordx2 v[124:125], v4, s[52:55], s64 offen offset:1024
    v_accvgpr_read_b32 v128, a36
    v_accvgpr_read_b32 v129, a37
    v_accvgpr_read_b32 v130, a38
    v_accvgpr_read_b32 v131, a39
    v_cvt_pk_bf16_f32 v132, v128, v129
    v_cvt_pk_bf16_f32 v133, v130, v131
    v_lshlrev_b32 v128, 16, v132
    v_and_b32 v129, 0xffff0000, v132
    v_lshlrev_b32 v130, 16, v133
    v_and_b32 v131, 0xffff0000, v133
    v_pk_add_f32 v[128:129], v[128:129], v[152:153]
    v_pk_add_f32 v[130:131], v[130:131], v[154:155]
    v_cvt_pk_bf16_f32 v132, v128, v129
    v_cvt_pk_bf16_f32 v133, v130, v131
    v_pk_max_i16 v132, v132, 0
    v_pk_max_i16 v133, v133, 0
    v_lshlrev_b32 v128, 16, v132
    v_and_b32 v129, 0xffff0000, v132
    v_lshlrev_b32 v130, 16, v133
    v_and_b32 v131, 0xffff0000, v133
    v_pk_mul_f32 v[128:129], v[128:129], v[128:129]
    v_pk_mul_f32 v[130:131], v[130:131], v[130:131]
    v_cvt_pk_bf16_f32 v132, v128, v129
    v_cvt_pk_bf16_f32 v133, v130, v131
    buffer_store_dwordx2 v[132:133], v4, s[52:55], s65 offen offset:1024
    v_accvgpr_read_b32 v120, a40
    v_accvgpr_read_b32 v121, a41
    v_accvgpr_read_b32 v122, a42
    v_accvgpr_read_b32 v123, a43
    v_cvt_pk_bf16_f32 v124, v120, v121
    v_cvt_pk_bf16_f32 v125, v122, v123
    v_lshlrev_b32 v120, 16, v124
    v_and_b32 v121, 0xffff0000, v124
    v_lshlrev_b32 v122, 16, v125
    v_and_b32 v123, 0xffff0000, v125
    v_pk_add_f32 v[120:121], v[120:121], v[152:153]
    v_pk_add_f32 v[122:123], v[122:123], v[154:155]
    v_cvt_pk_bf16_f32 v124, v120, v121
    v_cvt_pk_bf16_f32 v125, v122, v123
    v_pk_max_i16 v124, v124, 0
    v_pk_max_i16 v125, v125, 0
    v_lshlrev_b32 v120, 16, v124
    v_and_b32 v121, 0xffff0000, v124
    v_lshlrev_b32 v122, 16, v125
    v_and_b32 v123, 0xffff0000, v125
    v_pk_mul_f32 v[120:121], v[120:121], v[120:121]
    v_pk_mul_f32 v[122:123], v[122:123], v[122:123]
    v_cvt_pk_bf16_f32 v124, v120, v121
    v_cvt_pk_bf16_f32 v125, v122, v123
    buffer_store_dwordx2 v[124:125], v4, s[52:55], s66 offen offset:1024
    v_accvgpr_read_b32 v128, a44
    v_accvgpr_read_b32 v129, a45
    v_accvgpr_read_b32 v130, a46
    v_accvgpr_read_b32 v131, a47
    v_cvt_pk_bf16_f32 v132, v128, v129
    v_cvt_pk_bf16_f32 v133, v130, v131
    v_lshlrev_b32 v128, 16, v132
    v_and_b32 v129, 0xffff0000, v132
    v_lshlrev_b32 v130, 16, v133
    v_and_b32 v131, 0xffff0000, v133
    v_pk_add_f32 v[128:129], v[128:129], v[152:153]
    v_pk_add_f32 v[130:131], v[130:131], v[154:155]
    v_cvt_pk_bf16_f32 v132, v128, v129
    v_cvt_pk_bf16_f32 v133, v130, v131
    v_pk_max_i16 v132, v132, 0
    v_pk_max_i16 v133, v133, 0
    v_lshlrev_b32 v128, 16, v132
    v_and_b32 v129, 0xffff0000, v132
    v_lshlrev_b32 v130, 16, v133
    v_and_b32 v131, 0xffff0000, v133
    v_pk_mul_f32 v[128:129], v[128:129], v[128:129]
    v_pk_mul_f32 v[130:131], v[130:131], v[130:131]
    v_cvt_pk_bf16_f32 v132, v128, v129
    v_cvt_pk_bf16_f32 v133, v130, v131
    buffer_store_dwordx2 v[132:133], v4, s[52:55], s67 offen offset:1024
    v_accvgpr_read_b32 v120, a48
    v_accvgpr_read_b32 v121, a49
    v_accvgpr_read_b32 v122, a50
    v_accvgpr_read_b32 v123, a51
    v_cvt_pk_bf16_f32 v124, v120, v121
    v_cvt_pk_bf16_f32 v125, v122, v123
    v_lshlrev_b32 v120, 16, v124
    v_and_b32 v121, 0xffff0000, v124
    v_lshlrev_b32 v122, 16, v125
    v_and_b32 v123, 0xffff0000, v125
    v_pk_add_f32 v[120:121], v[120:121], v[156:157]
    v_pk_add_f32 v[122:123], v[122:123], v[158:159]
    v_cvt_pk_bf16_f32 v124, v120, v121
    v_cvt_pk_bf16_f32 v125, v122, v123
    v_pk_max_i16 v124, v124, 0
    v_pk_max_i16 v125, v125, 0
    v_lshlrev_b32 v120, 16, v124
    v_and_b32 v121, 0xffff0000, v124
    v_lshlrev_b32 v122, 16, v125
    v_and_b32 v123, 0xffff0000, v125
    v_pk_mul_f32 v[120:121], v[120:121], v[120:121]
    v_pk_mul_f32 v[122:123], v[122:123], v[122:123]
    v_cvt_pk_bf16_f32 v124, v120, v121
    v_cvt_pk_bf16_f32 v125, v122, v123
    buffer_store_dwordx2 v[124:125], v4, s[52:55], s64 offen offset:1536
    v_accvgpr_read_b32 v128, a52
    v_accvgpr_read_b32 v129, a53
    v_accvgpr_read_b32 v130, a54
    v_accvgpr_read_b32 v131, a55
    v_cvt_pk_bf16_f32 v132, v128, v129
    v_cvt_pk_bf16_f32 v133, v130, v131
    v_lshlrev_b32 v128, 16, v132
    v_and_b32 v129, 0xffff0000, v132
    v_lshlrev_b32 v130, 16, v133
    v_and_b32 v131, 0xffff0000, v133
    v_pk_add_f32 v[128:129], v[128:129], v[156:157]
    v_pk_add_f32 v[130:131], v[130:131], v[158:159]
    v_cvt_pk_bf16_f32 v132, v128, v129
    v_cvt_pk_bf16_f32 v133, v130, v131
    v_pk_max_i16 v132, v132, 0
    v_pk_max_i16 v133, v133, 0
    v_lshlrev_b32 v128, 16, v132
    v_and_b32 v129, 0xffff0000, v132
    v_lshlrev_b32 v130, 16, v133
    v_and_b32 v131, 0xffff0000, v133
    v_pk_mul_f32 v[128:129], v[128:129], v[128:129]
    v_pk_mul_f32 v[130:131], v[130:131], v[130:131]
    v_cvt_pk_bf16_f32 v132, v128, v129
    v_cvt_pk_bf16_f32 v133, v130, v131
    buffer_store_dwordx2 v[132:133], v4, s[52:55], s65 offen offset:1536
    v_accvgpr_read_b32 v120, a56
    v_accvgpr_read_b32 v121, a57
    v_accvgpr_read_b32 v122, a58
    v_accvgpr_read_b32 v123, a59
    v_cvt_pk_bf16_f32 v124, v120, v121
    v_cvt_pk_bf16_f32 v125, v122, v123
    v_lshlrev_b32 v120, 16, v124
    v_and_b32 v121, 0xffff0000, v124
    v_lshlrev_b32 v122, 16, v125
    v_and_b32 v123, 0xffff0000, v125
    v_pk_add_f32 v[120:121], v[120:121], v[156:157]
    v_pk_add_f32 v[122:123], v[122:123], v[158:159]
    v_cvt_pk_bf16_f32 v124, v120, v121
    v_cvt_pk_bf16_f32 v125, v122, v123
    v_pk_max_i16 v124, v124, 0
    v_pk_max_i16 v125, v125, 0
    v_lshlrev_b32 v120, 16, v124
    v_and_b32 v121, 0xffff0000, v124
    v_lshlrev_b32 v122, 16, v125
    v_and_b32 v123, 0xffff0000, v125
    v_pk_mul_f32 v[120:121], v[120:121], v[120:121]
    v_pk_mul_f32 v[122:123], v[122:123], v[122:123]
    v_cvt_pk_bf16_f32 v124, v120, v121
    v_cvt_pk_bf16_f32 v125, v122, v123
    buffer_store_dwordx2 v[124:125], v4, s[52:55], s66 offen offset:1536
    v_accvgpr_read_b32 v128, a60
    v_accvgpr_read_b32 v129, a61
    v_accvgpr_read_b32 v130, a62
    v_accvgpr_read_b32 v131, a63
    v_cvt_pk_bf16_f32 v132, v128, v129
    v_cvt_pk_bf16_f32 v133, v130, v131
    v_lshlrev_b32 v128, 16, v132
    v_and_b32 v129, 0xffff0000, v132
    v_lshlrev_b32 v130, 16, v133
    v_and_b32 v131, 0xffff0000, v133
    v_pk_add_f32 v[128:129], v[128:129], v[156:157]
    v_pk_add_f32 v[130:131], v[130:131], v[158:159]
    v_cvt_pk_bf16_f32 v132, v128, v129
    v_cvt_pk_bf16_f32 v133, v130, v131
    v_pk_max_i16 v132, v132, 0
    v_pk_max_i16 v133, v133, 0
    v_lshlrev_b32 v128, 16, v132
    v_and_b32 v129, 0xffff0000, v132
    v_lshlrev_b32 v130, 16, v133
    v_and_b32 v131, 0xffff0000, v133
    v_pk_mul_f32 v[128:129], v[128:129], v[128:129]
    v_pk_mul_f32 v[130:131], v[130:131], v[130:131]
    v_cvt_pk_bf16_f32 v132, v128, v129
    v_cvt_pk_bf16_f32 v133, v130, v131
    buffer_store_dwordx2 v[132:133], v4, s[52:55], s67 offen offset:1536
    s_branch .end_k7b1_kernel_1
.end_k7b1_kernel_1:
    s_endpgm
.section .rodata,"a"
.p2align 6
.amdhsa_kernel k7b1_kernel
  .amdhsa_next_free_vgpr 248
  .amdhsa_next_free_sgpr 100
  .amdhsa_accum_offset 184
  .amdhsa_group_segment_fixed_size 0
  .amdhsa_kernarg_size 104
  .amdhsa_user_sgpr_count 2
  .amdhsa_user_sgpr_kernarg_segment_ptr 1
  .amdhsa_system_sgpr_workgroup_id_x 1
  .amdhsa_float_denorm_mode_32 3
.end_amdhsa_kernel
.text

.globl k8b2_kernel
.p2align 8
.type k8b2_kernel,@function
k8b2_kernel:
    s_load_dwordx16 s[16:31], s[0:1], 0
    s_load_dwordx8 s[32:39], s[0:1], 64
    s_load_dwordx2 s[40:41], s[0:1], 96
    s_cmp_ge_u32 s2, 256
    s_cbranch_scc1 .end_k8b2_kernel_1
    v_lshrrev_b32 v2, 6, v0
    v_and_b32 v1, 63, v0
    v_readfirstlane_b32 s3, v2
    s_and_b32 s6, s2, 7
    s_lshr_b32 s7, s2, 3
    s_lshr_b32 s4, s7, 3
    s_lshl_b32 s6, s6, 2
    s_add_u32 s4, s4, s6
    s_and_b32 s5, s7, 7
    s_waitcnt lgkmcnt(0)
    s_add_u32 s44, s40, 0x400000
    s_addc_u32 s45, s41, 0
    s_mov_b32 s46, 0x700000
    s_mov_b32 s47, 0x00020000
    s_add_u32 s48, s40, 0x1300000
    s_addc_u32 s49, s41, 0
    s_mov_b32 s50, 0x1c0000
    s_mov_b32 s51, 0x00020000
    s_mov_b32 s56, s34
    s_mov_b32 s57, s35
    s_mov_b32 s58, 0x400
    s_mov_b32 s59, 0x00020000
    s_mul_i32 s6, s3, 0x3800
    s_mul_i32 s7, s4, 0x38000
    s_add_u32 s60, s6, s7
    s_mul_i32 s7, s5, 0x38000
    s_add_u32 s61, s6, s7
    s_add_u32 s64, s40, 0xf00000
    s_addc_u32 s65, s41, 0
    s_mov_b32 s66, 0x200000
    s_mov_b32 s67, 0x00020000
    s_mov_b32 s68, s36
    s_mov_b32 s69, s37
    s_mov_b32 s70, 0x200000
    s_mov_b32 s71, 0x00020000
    v_and_b32 v10, 15, v1
    v_lshrrev_b32 v11, 4, v1
    v_lshlrev_b32 v12, 12, v10
    v_lshl_add_u32 v12, v11, 4, v12
    v_lshlrev_b32 v17, 4, v1
    v_add_u32 v2, 0x0, v17
    v_add_u32 v6, 0x0, v17
    v_add_u32 v3, 0xe000, v17
    v_add_u32 v7, 0xe000, v17
    v_add_u32 v4, 0x1c000, v17
    v_add_u32 v8, 0x1c000, v17
    v_add_u32 v5, 0x2a000, v17
    v_add_u32 v9, 0x2a000, v17
    buffer_load_dwordx4 v[40:43], v2, s[44:47], s60 offen
    buffer_load_dwordx4 v[44:47], v3, s[44:47], s60 offen
    buffer_load_dwordx4 v[48:51], v4, s[44:47], s60 offen
    buffer_load_dwordx4 v[52:55], v5, s[44:47], s60 offen
    buffer_load_dwordx4 v[56:59], v6, s[48:51], s61 offen
    buffer_load_dwordx4 v[60:63], v7, s[48:51], s61 offen
    buffer_load_dwordx4 v[64:67], v8, s[48:51], s61 offen
    buffer_load_dwordx4 v[68:71], v9, s[48:51], s61 offen
    s_add_u32 s60, s60, 0x400
    s_add_u32 s61, s61, 0x400
    buffer_load_dwordx4 v[72:75], v2, s[44:47], s60 offen
    buffer_load_dwordx4 v[76:79], v3, s[44:47], s60 offen
    buffer_load_dwordx4 v[80:83], v4, s[44:47], s60 offen
    buffer_load_dwordx4 v[84:87], v5, s[44:47], s60 offen
    buffer_load_dwordx4 v[88:91], v6, s[48:51], s61 offen
    buffer_load_dwordx4 v[92:95], v7, s[48:51], s61 offen
    buffer_load_dwordx4 v[96:99], v8, s[48:51], s61 offen
    buffer_load_dwordx4 v[100:103], v9, s[48:51], s61 offen
    s_add_u32 s60, s60, 0x400
    s_add_u32 s61, s61, 0x400
    buffer_load_dwordx4 v[104:107], v2, s[44:47], s60 offen
    buffer_load_dwordx4 v[108:111], v3, s[44:47], s60 offen
    buffer_load_dwordx4 v[112:115], v4, s[44:47], s60 offen
    buffer_load_dwordx4 v[116:119], v5, s[44:47], s60 offen
    buffer_load_dwordx4 v[120:123], v6, s[48:51], s61 offen
    buffer_load_dwordx4 v[124:127], v7, s[48:51], s61 offen
    buffer_load_dwordx4 v[128:131], v8, s[48:51], s61 offen
    buffer_load_dwordx4 v[132:135], v9, s[48:51], s61 offen
    s_add_u32 s60, s60, 0x400
    s_add_u32 s61, s61, 0x400
    buffer_load_dwordx4 v[136:139], v2, s[44:47], s60 offen
    buffer_load_dwordx4 v[140:143], v3, s[44:47], s60 offen
    buffer_load_dwordx4 v[144:147], v4, s[44:47], s60 offen
    buffer_load_dwordx4 v[148:151], v5, s[44:47], s60 offen
    buffer_load_dwordx4 v[152:155], v6, s[48:51], s61 offen
    buffer_load_dwordx4 v[156:159], v7, s[48:51], s61 offen
    buffer_load_dwordx4 v[160:163], v8, s[48:51], s61 offen
    buffer_load_dwordx4 v[164:167], v9, s[48:51], s61 offen
    s_add_u32 s60, s60, 0x400
    s_add_u32 s61, s61, 0x400
    buffer_load_dwordx4 v[168:171], v2, s[44:47], s60 offen
    buffer_load_dwordx4 v[172:175], v3, s[44:47], s60 offen
    buffer_load_dwordx4 v[176:179], v4, s[44:47], s60 offen
    buffer_load_dwordx4 v[180:183], v5, s[44:47], s60 offen
    buffer_load_dwordx4 v[184:187], v6, s[48:51], s61 offen
    buffer_load_dwordx4 v[188:191], v7, s[48:51], s61 offen
    buffer_load_dwordx4 v[192:195], v8, s[48:51], s61 offen
    buffer_load_dwordx4 v[196:199], v9, s[48:51], s61 offen
    s_add_u32 s60, s60, 0x400
    s_add_u32 s61, s61, 0x400
    v_lshlrev_b32 v13, 10, v10
    v_lshl_add_u32 v13, v11, 3, v13
    v_mov_b32 v16, v13
    s_lshl_b32 s6, s4, 16
    s_lshl_b32 s7, s3, 14
    s_add_u32 s6, s6, s7
    s_lshl_b32 s7, s5, 7
    s_add_u32 s62, s6, s7
    buffer_load_dwordx2 v[24:25], v16, s[64:67], s62 offen offset:0
    buffer_load_dwordx2 v[26:27], v16, s[64:67], s62 offen offset:32
    buffer_load_dwordx2 v[28:29], v16, s[64:67], s62 offen offset:64
    buffer_load_dwordx2 v[30:31], v16, s[64:67], s62 offen offset:96
    v_lshlrev_b32 v14, 3, v11
    s_lshl_b32 s63, s5, 7
    buffer_load_dwordx2 v[32:33], v14, s[56:59], s63 offen offset:0
    buffer_load_dwordx2 v[34:35], v14, s[56:59], s63 offen offset:32
    buffer_load_dwordx2 v[36:37], v14, s[56:59], s63 offen offset:64
    buffer_load_dwordx2 v[38:39], v14, s[56:59], s63 offen offset:96
    s_waitcnt vmcnt(40)
    v_mfma_f32_16x16x32_bf16 a[0:3], v[56:59], v[40:43], 0
    v_mfma_f32_16x16x32_bf16 a[4:7], v[56:59], v[44:47], 0
    v_mfma_f32_16x16x32_bf16 a[8:11], v[56:59], v[48:51], 0
    v_mfma_f32_16x16x32_bf16 a[12:15], v[56:59], v[52:55], 0
    v_mfma_f32_16x16x32_bf16 a[16:19], v[60:63], v[40:43], 0
    v_mfma_f32_16x16x32_bf16 a[20:23], v[60:63], v[44:47], 0
    v_mfma_f32_16x16x32_bf16 a[24:27], v[60:63], v[48:51], 0
    v_mfma_f32_16x16x32_bf16 a[28:31], v[60:63], v[52:55], 0
    v_mfma_f32_16x16x32_bf16 a[32:35], v[64:67], v[40:43], 0
    v_mfma_f32_16x16x32_bf16 a[36:39], v[64:67], v[44:47], 0
    v_mfma_f32_16x16x32_bf16 a[40:43], v[64:67], v[48:51], 0
    v_mfma_f32_16x16x32_bf16 a[44:47], v[64:67], v[52:55], 0
    v_mfma_f32_16x16x32_bf16 a[48:51], v[68:71], v[40:43], 0
    v_mfma_f32_16x16x32_bf16 a[52:55], v[68:71], v[44:47], 0
    v_mfma_f32_16x16x32_bf16 a[56:59], v[68:71], v[48:51], 0
    v_mfma_f32_16x16x32_bf16 a[60:63], v[68:71], v[52:55], 0
    buffer_load_dwordx4 v[40:43], v2, s[44:47], s60 offen
    buffer_load_dwordx4 v[44:47], v3, s[44:47], s60 offen
    buffer_load_dwordx4 v[48:51], v4, s[44:47], s60 offen
    buffer_load_dwordx4 v[52:55], v5, s[44:47], s60 offen
    buffer_load_dwordx4 v[56:59], v6, s[48:51], s61 offen
    buffer_load_dwordx4 v[60:63], v7, s[48:51], s61 offen
    buffer_load_dwordx4 v[64:67], v8, s[48:51], s61 offen
    buffer_load_dwordx4 v[68:71], v9, s[48:51], s61 offen
    s_add_u32 s60, s60, 0x400
    s_add_u32 s61, s61, 0x400
    s_waitcnt vmcnt(40)
    v_mfma_f32_16x16x32_bf16 a[0:3], v[88:91], v[72:75], a[0:3]
    v_mfma_f32_16x16x32_bf16 a[4:7], v[88:91], v[76:79], a[4:7]
    v_mfma_f32_16x16x32_bf16 a[8:11], v[88:91], v[80:83], a[8:11]
    v_mfma_f32_16x16x32_bf16 a[12:15], v[88:91], v[84:87], a[12:15]
    v_mfma_f32_16x16x32_bf16 a[16:19], v[92:95], v[72:75], a[16:19]
    v_mfma_f32_16x16x32_bf16 a[20:23], v[92:95], v[76:79], a[20:23]
    v_mfma_f32_16x16x32_bf16 a[24:27], v[92:95], v[80:83], a[24:27]
    v_mfma_f32_16x16x32_bf16 a[28:31], v[92:95], v[84:87], a[28:31]
    v_mfma_f32_16x16x32_bf16 a[32:35], v[96:99], v[72:75], a[32:35]
    v_mfma_f32_16x16x32_bf16 a[36:39], v[96:99], v[76:79], a[36:39]
    v_mfma_f32_16x16x32_bf16 a[40:43], v[96:99], v[80:83], a[40:43]
    v_mfma_f32_16x16x32_bf16 a[44:47], v[96:99], v[84:87], a[44:47]
    v_mfma_f32_16x16x32_bf16 a[48:51], v[100:103], v[72:75], a[48:51]
    v_mfma_f32_16x16x32_bf16 a[52:55], v[100:103], v[76:79], a[52:55]
    v_mfma_f32_16x16x32_bf16 a[56:59], v[100:103], v[80:83], a[56:59]
    v_mfma_f32_16x16x32_bf16 a[60:63], v[100:103], v[84:87], a[60:63]
    buffer_load_dwordx4 v[72:75], v2, s[44:47], s60 offen
    buffer_load_dwordx4 v[76:79], v3, s[44:47], s60 offen
    buffer_load_dwordx4 v[80:83], v4, s[44:47], s60 offen
    buffer_load_dwordx4 v[84:87], v5, s[44:47], s60 offen
    buffer_load_dwordx4 v[88:91], v6, s[48:51], s61 offen
    buffer_load_dwordx4 v[92:95], v7, s[48:51], s61 offen
    buffer_load_dwordx4 v[96:99], v8, s[48:51], s61 offen
    buffer_load_dwordx4 v[100:103], v9, s[48:51], s61 offen
    s_add_u32 s60, s60, 0x400
    s_add_u32 s61, s61, 0x400
    s_waitcnt vmcnt(40)
    v_mfma_f32_16x16x32_bf16 a[0:3], v[120:123], v[104:107], a[0:3]
    v_mfma_f32_16x16x32_bf16 a[4:7], v[120:123], v[108:111], a[4:7]
    v_mfma_f32_16x16x32_bf16 a[8:11], v[120:123], v[112:115], a[8:11]
    v_mfma_f32_16x16x32_bf16 a[12:15], v[120:123], v[116:119], a[12:15]
    v_mfma_f32_16x16x32_bf16 a[16:19], v[124:127], v[104:107], a[16:19]
    v_mfma_f32_16x16x32_bf16 a[20:23], v[124:127], v[108:111], a[20:23]
    v_mfma_f32_16x16x32_bf16 a[24:27], v[124:127], v[112:115], a[24:27]
    v_mfma_f32_16x16x32_bf16 a[28:31], v[124:127], v[116:119], a[28:31]
    v_mfma_f32_16x16x32_bf16 a[32:35], v[128:131], v[104:107], a[32:35]
    v_mfma_f32_16x16x32_bf16 a[36:39], v[128:131], v[108:111], a[36:39]
    v_mfma_f32_16x16x32_bf16 a[40:43], v[128:131], v[112:115], a[40:43]
    v_mfma_f32_16x16x32_bf16 a[44:47], v[128:131], v[116:119], a[44:47]
    v_mfma_f32_16x16x32_bf16 a[48:51], v[132:135], v[104:107], a[48:51]
    v_mfma_f32_16x16x32_bf16 a[52:55], v[132:135], v[108:111], a[52:55]
    v_mfma_f32_16x16x32_bf16 a[56:59], v[132:135], v[112:115], a[56:59]
    v_mfma_f32_16x16x32_bf16 a[60:63], v[132:135], v[116:119], a[60:63]
    buffer_load_dwordx4 v[104:107], v2, s[44:47], s60 offen
    buffer_load_dwordx4 v[108:111], v3, s[44:47], s60 offen
    buffer_load_dwordx4 v[112:115], v4, s[44:47], s60 offen
    buffer_load_dwordx4 v[116:119], v5, s[44:47], s60 offen
    buffer_load_dwordx4 v[120:123], v6, s[48:51], s61 offen
    buffer_load_dwordx4 v[124:127], v7, s[48:51], s61 offen
    buffer_load_dwordx4 v[128:131], v8, s[48:51], s61 offen
    buffer_load_dwordx4 v[132:135], v9, s[48:51], s61 offen
    s_add_u32 s60, s60, 0x400
    s_add_u32 s61, s61, 0x400
    s_waitcnt vmcnt(40)
    v_mfma_f32_16x16x32_bf16 a[0:3], v[152:155], v[136:139], a[0:3]
    v_mfma_f32_16x16x32_bf16 a[4:7], v[152:155], v[140:143], a[4:7]
    v_mfma_f32_16x16x32_bf16 a[8:11], v[152:155], v[144:147], a[8:11]
    v_mfma_f32_16x16x32_bf16 a[12:15], v[152:155], v[148:151], a[12:15]
    v_mfma_f32_16x16x32_bf16 a[16:19], v[156:159], v[136:139], a[16:19]
    v_mfma_f32_16x16x32_bf16 a[20:23], v[156:159], v[140:143], a[20:23]
    v_mfma_f32_16x16x32_bf16 a[24:27], v[156:159], v[144:147], a[24:27]
    v_mfma_f32_16x16x32_bf16 a[28:31], v[156:159], v[148:151], a[28:31]
    v_mfma_f32_16x16x32_bf16 a[32:35], v[160:163], v[136:139], a[32:35]
    v_mfma_f32_16x16x32_bf16 a[36:39], v[160:163], v[140:143], a[36:39]
    v_mfma_f32_16x16x32_bf16 a[40:43], v[160:163], v[144:147], a[40:43]
    v_mfma_f32_16x16x32_bf16 a[44:47], v[160:163], v[148:151], a[44:47]
    v_mfma_f32_16x16x32_bf16 a[48:51], v[164:167], v[136:139], a[48:51]
    v_mfma_f32_16x16x32_bf16 a[52:55], v[164:167], v[140:143], a[52:55]
    v_mfma_f32_16x16x32_bf16 a[56:59], v[164:167], v[144:147], a[56:59]
    v_mfma_f32_16x16x32_bf16 a[60:63], v[164:167], v[148:151], a[60:63]
    buffer_load_dwordx4 v[136:139], v2, s[44:47], s60 offen
    buffer_load_dwordx4 v[140:143], v3, s[44:47], s60 offen
    buffer_load_dwordx4 v[144:147], v4, s[44:47], s60 offen
    buffer_load_dwordx4 v[148:151], v5, s[44:47], s60 offen
    buffer_load_dwordx4 v[152:155], v6, s[48:51], s61 offen
    buffer_load_dwordx4 v[156:159], v7, s[48:51], s61 offen
    buffer_load_dwordx4 v[160:163], v8, s[48:51], s61 offen
    buffer_load_dwordx4 v[164:167], v9, s[48:51], s61 offen
    s_add_u32 s60, s60, 0x400
    s_add_u32 s61, s61, 0x400
    s_waitcnt vmcnt(40)
    v_mfma_f32_16x16x32_bf16 a[0:3], v[184:187], v[168:171], a[0:3]
    v_mfma_f32_16x16x32_bf16 a[4:7], v[184:187], v[172:175], a[4:7]
    v_mfma_f32_16x16x32_bf16 a[8:11], v[184:187], v[176:179], a[8:11]
    v_mfma_f32_16x16x32_bf16 a[12:15], v[184:187], v[180:183], a[12:15]
    v_mfma_f32_16x16x32_bf16 a[16:19], v[188:191], v[168:171], a[16:19]
    v_mfma_f32_16x16x32_bf16 a[20:23], v[188:191], v[172:175], a[20:23]
    v_mfma_f32_16x16x32_bf16 a[24:27], v[188:191], v[176:179], a[24:27]
    v_mfma_f32_16x16x32_bf16 a[28:31], v[188:191], v[180:183], a[28:31]
    v_mfma_f32_16x16x32_bf16 a[32:35], v[192:195], v[168:171], a[32:35]
    v_mfma_f32_16x16x32_bf16 a[36:39], v[192:195], v[172:175], a[36:39]
    v_mfma_f32_16x16x32_bf16 a[40:43], v[192:195], v[176:179], a[40:43]
    v_mfma_f32_16x16x32_bf16 a[44:47], v[192:195], v[180:183], a[44:47]
    v_mfma_f32_16x16x32_bf16 a[48:51], v[196:199], v[168:171], a[48:51]
    v_mfma_f32_16x16x32_bf16 a[52:55], v[196:199], v[172:175], a[52:55]
    v_mfma_f32_16x16x32_bf16 a[56:59], v[196:199], v[176:179], a[56:59]
    v_mfma_f32_16x16x32_bf16 a[60:63], v[196:199], v[180:183], a[60:63]
    buffer_load_dwordx4 v[168:171], v2, s[44:47], s60 offen
    buffer_load_dwordx4 v[172:175], v3, s[44:47], s60 offen
    buffer_load_dwordx4 v[176:179], v4, s[44:47], s60 offen
    buffer_load_dwordx4 v[180:183], v5, s[44:47], s60 offen
    buffer_load_dwordx4 v[184:187], v6, s[48:51], s61 offen
    buffer_load_dwordx4 v[188:191], v7, s[48:51], s61 offen
    buffer_load_dwordx4 v[192:195], v8, s[48:51], s61 offen
    buffer_load_dwordx4 v[196:199], v9, s[48:51], s61 offen
    s_add_u32 s60, s60, 0x400
    s_add_u32 s61, s61, 0x400
    s_waitcnt vmcnt(32)
    v_mfma_f32_16x16x32_bf16 a[0:3], v[56:59], v[40:43], a[0:3]
    v_mfma_f32_16x16x32_bf16 a[4:7], v[56:59], v[44:47], a[4:7]
    v_mfma_f32_16x16x32_bf16 a[8:11], v[56:59], v[48:51], a[8:11]
    v_mfma_f32_16x16x32_bf16 a[12:15], v[56:59], v[52:55], a[12:15]
    v_mfma_f32_16x16x32_bf16 a[16:19], v[60:63], v[40:43], a[16:19]
    v_mfma_f32_16x16x32_bf16 a[20:23], v[60:63], v[44:47], a[20:23]
    v_mfma_f32_16x16x32_bf16 a[24:27], v[60:63], v[48:51], a[24:27]
    v_mfma_f32_16x16x32_bf16 a[28:31], v[60:63], v[52:55], a[28:31]
    v_mfma_f32_16x16x32_bf16 a[32:35], v[64:67], v[40:43], a[32:35]
    v_mfma_f32_16x16x32_bf16 a[36:39], v[64:67], v[44:47], a[36:39]
    v_mfma_f32_16x16x32_bf16 a[40:43], v[64:67], v[48:51], a[40:43]
    v_mfma_f32_16x16x32_bf16 a[44:47], v[64:67], v[52:55], a[44:47]
    v_mfma_f32_16x16x32_bf16 a[48:51], v[68:71], v[40:43], a[48:51]
    v_mfma_f32_16x16x32_bf16 a[52:55], v[68:71], v[44:47], a[52:55]
    v_mfma_f32_16x16x32_bf16 a[56:59], v[68:71], v[48:51], a[56:59]
    v_mfma_f32_16x16x32_bf16 a[60:63], v[68:71], v[52:55], a[60:63]
    buffer_load_dwordx4 v[40:43], v2, s[44:47], s60 offen
    buffer_load_dwordx4 v[44:47], v3, s[44:47], s60 offen
    buffer_load_dwordx4 v[48:51], v4, s[44:47], s60 offen
    buffer_load_dwordx4 v[52:55], v5, s[44:47], s60 offen
    buffer_load_dwordx4 v[56:59], v6, s[48:51], s61 offen
    buffer_load_dwordx4 v[60:63], v7, s[48:51], s61 offen
    buffer_load_dwordx4 v[64:67], v8, s[48:51], s61 offen
    buffer_load_dwordx4 v[68:71], v9, s[48:51], s61 offen
    s_add_u32 s60, s60, 0x400
    s_add_u32 s61, s61, 0x400
    s_waitcnt vmcnt(32)
    v_mfma_f32_16x16x32_bf16 a[0:3], v[88:91], v[72:75], a[0:3]
    v_mfma_f32_16x16x32_bf16 a[4:7], v[88:91], v[76:79], a[4:7]
    v_mfma_f32_16x16x32_bf16 a[8:11], v[88:91], v[80:83], a[8:11]
    v_mfma_f32_16x16x32_bf16 a[12:15], v[88:91], v[84:87], a[12:15]
    v_mfma_f32_16x16x32_bf16 a[16:19], v[92:95], v[72:75], a[16:19]
    v_mfma_f32_16x16x32_bf16 a[20:23], v[92:95], v[76:79], a[20:23]
    v_mfma_f32_16x16x32_bf16 a[24:27], v[92:95], v[80:83], a[24:27]
    v_mfma_f32_16x16x32_bf16 a[28:31], v[92:95], v[84:87], a[28:31]
    v_mfma_f32_16x16x32_bf16 a[32:35], v[96:99], v[72:75], a[32:35]
    v_mfma_f32_16x16x32_bf16 a[36:39], v[96:99], v[76:79], a[36:39]
    v_mfma_f32_16x16x32_bf16 a[40:43], v[96:99], v[80:83], a[40:43]
    v_mfma_f32_16x16x32_bf16 a[44:47], v[96:99], v[84:87], a[44:47]
    v_mfma_f32_16x16x32_bf16 a[48:51], v[100:103], v[72:75], a[48:51]
    v_mfma_f32_16x16x32_bf16 a[52:55], v[100:103], v[76:79], a[52:55]
    v_mfma_f32_16x16x32_bf16 a[56:59], v[100:103], v[80:83], a[56:59]
    v_mfma_f32_16x16x32_bf16 a[60:63], v[100:103], v[84:87], a[60:63]
    buffer_load_dwordx4 v[72:75], v2, s[44:47], s60 offen
    buffer_load_dwordx4 v[76:79], v3, s[44:47], s60 offen
    buffer_load_dwordx4 v[80:83], v4, s[44:47], s60 offen
    buffer_load_dwordx4 v[84:87], v5, s[44:47], s60 offen
    buffer_load_dwordx4 v[88:91], v6, s[48:51], s61 offen
    buffer_load_dwordx4 v[92:95], v7, s[48:51], s61 offen
    buffer_load_dwordx4 v[96:99], v8, s[48:51], s61 offen
    buffer_load_dwordx4 v[100:103], v9, s[48:51], s61 offen
    s_add_u32 s60, s60, 0x400
    s_add_u32 s61, s61, 0x400
    s_waitcnt vmcnt(32)
    v_mfma_f32_16x16x32_bf16 a[0:3], v[120:123], v[104:107], a[0:3]
    v_mfma_f32_16x16x32_bf16 a[4:7], v[120:123], v[108:111], a[4:7]
    v_mfma_f32_16x16x32_bf16 a[8:11], v[120:123], v[112:115], a[8:11]
    v_mfma_f32_16x16x32_bf16 a[12:15], v[120:123], v[116:119], a[12:15]
    v_mfma_f32_16x16x32_bf16 a[16:19], v[124:127], v[104:107], a[16:19]
    v_mfma_f32_16x16x32_bf16 a[20:23], v[124:127], v[108:111], a[20:23]
    v_mfma_f32_16x16x32_bf16 a[24:27], v[124:127], v[112:115], a[24:27]
    v_mfma_f32_16x16x32_bf16 a[28:31], v[124:127], v[116:119], a[28:31]
    v_mfma_f32_16x16x32_bf16 a[32:35], v[128:131], v[104:107], a[32:35]
    v_mfma_f32_16x16x32_bf16 a[36:39], v[128:131], v[108:111], a[36:39]
    v_mfma_f32_16x16x32_bf16 a[40:43], v[128:131], v[112:115], a[40:43]
    v_mfma_f32_16x16x32_bf16 a[44:47], v[128:131], v[116:119], a[44:47]
    v_mfma_f32_16x16x32_bf16 a[48:51], v[132:135], v[104:107], a[48:51]
    v_mfma_f32_16x16x32_bf16 a[52:55], v[132:135], v[108:111], a[52:55]
    v_mfma_f32_16x16x32_bf16 a[56:59], v[132:135], v[112:115], a[56:59]
    v_mfma_f32_16x16x32_bf16 a[60:63], v[132:135], v[116:119], a[60:63]
    buffer_load_dwordx4 v[104:107], v2, s[44:47], s60 offen
    buffer_load_dwordx4 v[108:111], v3, s[44:47], s60 offen
    buffer_load_dwordx4 v[112:115], v4, s[44:47], s60 offen
    buffer_load_dwordx4 v[116:119], v5, s[44:47], s60 offen
    buffer_load_dwordx4 v[120:123], v6, s[48:51], s61 offen
    buffer_load_dwordx4 v[124:127], v7, s[48:51], s61 offen
    buffer_load_dwordx4 v[128:131], v8, s[48:51], s61 offen
    buffer_load_dwordx4 v[132:135], v9, s[48:51], s61 offen
    s_add_u32 s60, s60, 0x400
    s_add_u32 s61, s61, 0x400
    s_waitcnt vmcnt(32)
    v_mfma_f32_16x16x32_bf16 a[0:3], v[152:155], v[136:139], a[0:3]
    v_mfma_f32_16x16x32_bf16 a[4:7], v[152:155], v[140:143], a[4:7]
    v_mfma_f32_16x16x32_bf16 a[8:11], v[152:155], v[144:147], a[8:11]
    v_mfma_f32_16x16x32_bf16 a[12:15], v[152:155], v[148:151], a[12:15]
    v_mfma_f32_16x16x32_bf16 a[16:19], v[156:159], v[136:139], a[16:19]
    v_mfma_f32_16x16x32_bf16 a[20:23], v[156:159], v[140:143], a[20:23]
    v_mfma_f32_16x16x32_bf16 a[24:27], v[156:159], v[144:147], a[24:27]
    v_mfma_f32_16x16x32_bf16 a[28:31], v[156:159], v[148:151], a[28:31]
    v_mfma_f32_16x16x32_bf16 a[32:35], v[160:163], v[136:139], a[32:35]
    v_mfma_f32_16x16x32_bf16 a[36:39], v[160:163], v[140:143], a[36:39]
    v_mfma_f32_16x16x32_bf16 a[40:43], v[160:163], v[144:147], a[40:43]
    v_mfma_f32_16x16x32_bf16 a[44:47], v[160:163], v[148:151], a[44:47]
    v_mfma_f32_16x16x32_bf16 a[48:51], v[164:167], v[136:139], a[48:51]
    v_mfma_f32_16x16x32_bf16 a[52:55], v[164:167], v[140:143], a[52:55]
    v_mfma_f32_16x16x32_bf16 a[56:59], v[164:167], v[144:147], a[56:59]
    v_mfma_f32_16x16x32_bf16 a[60:63], v[164:167], v[148:151], a[60:63]
    buffer_load_dwordx4 v[136:139], v2, s[44:47], s60 offen
    buffer_load_dwordx4 v[140:143], v3, s[44:47], s60 offen
    buffer_load_dwordx4 v[144:147], v4, s[44:47], s60 offen
    buffer_load_dwordx4 v[148:151], v5, s[44:47], s60 offen
    buffer_load_dwordx4 v[152:155], v6, s[48:51], s61 offen
    buffer_load_dwordx4 v[156:159], v7, s[48:51], s61 offen
    buffer_load_dwordx4 v[160:163], v8, s[48:51], s61 offen
    buffer_load_dwordx4 v[164:167], v9, s[48:51], s61 offen
    s_add_u32 s60, s60, 0x400
    s_add_u32 s61, s61, 0x400
    s_waitcnt vmcnt(32)
    v_mfma_f32_16x16x32_bf16 a[0:3], v[184:187], v[168:171], a[0:3]
    v_mfma_f32_16x16x32_bf16 a[4:7], v[184:187], v[172:175], a[4:7]
    v_mfma_f32_16x16x32_bf16 a[8:11], v[184:187], v[176:179], a[8:11]
    v_mfma_f32_16x16x32_bf16 a[12:15], v[184:187], v[180:183], a[12:15]
    v_mfma_f32_16x16x32_bf16 a[16:19], v[188:191], v[168:171], a[16:19]
    v_mfma_f32_16x16x32_bf16 a[20:23], v[188:191], v[172:175], a[20:23]
    v_mfma_f32_16x16x32_bf16 a[24:27], v[188:191], v[176:179], a[24:27]
    v_mfma_f32_16x16x32_bf16 a[28:31], v[188:191], v[180:183], a[28:31]
    v_mfma_f32_16x16x32_bf16 a[32:35], v[192:195], v[168:171], a[32:35]
    v_mfma_f32_16x16x32_bf16 a[36:39], v[192:195], v[172:175], a[36:39]
    v_mfma_f32_16x16x32_bf16 a[40:43], v[192:195], v[176:179], a[40:43]
    v_mfma_f32_16x16x32_bf16 a[44:47], v[192:195], v[180:183], a[44:47]
    v_mfma_f32_16x16x32_bf16 a[48:51], v[196:199], v[168:171], a[48:51]
    v_mfma_f32_16x16x32_bf16 a[52:55], v[196:199], v[172:175], a[52:55]
    v_mfma_f32_16x16x32_bf16 a[56:59], v[196:199], v[176:179], a[56:59]
    v_mfma_f32_16x16x32_bf16 a[60:63], v[196:199], v[180:183], a[60:63]
    s_waitcnt vmcnt(24)
    v_mfma_f32_16x16x32_bf16 a[0:3], v[56:59], v[40:43], a[0:3]
    v_mfma_f32_16x16x32_bf16 a[4:7], v[56:59], v[44:47], a[4:7]
    v_mfma_f32_16x16x32_bf16 a[8:11], v[56:59], v[48:51], a[8:11]
    v_mfma_f32_16x16x32_bf16 a[12:15], v[56:59], v[52:55], a[12:15]
    v_mfma_f32_16x16x32_bf16 a[16:19], v[60:63], v[40:43], a[16:19]
    v_mfma_f32_16x16x32_bf16 a[20:23], v[60:63], v[44:47], a[20:23]
    v_mfma_f32_16x16x32_bf16 a[24:27], v[60:63], v[48:51], a[24:27]
    v_mfma_f32_16x16x32_bf16 a[28:31], v[60:63], v[52:55], a[28:31]
    v_mfma_f32_16x16x32_bf16 a[32:35], v[64:67], v[40:43], a[32:35]
    v_mfma_f32_16x16x32_bf16 a[36:39], v[64:67], v[44:47], a[36:39]
    v_mfma_f32_16x16x32_bf16 a[40:43], v[64:67], v[48:51], a[40:43]
    v_mfma_f32_16x16x32_bf16 a[44:47], v[64:67], v[52:55], a[44:47]
    v_mfma_f32_16x16x32_bf16 a[48:51], v[68:71], v[40:43], a[48:51]
    v_mfma_f32_16x16x32_bf16 a[52:55], v[68:71], v[44:47], a[52:55]
    v_mfma_f32_16x16x32_bf16 a[56:59], v[68:71], v[48:51], a[56:59]
    v_mfma_f32_16x16x32_bf16 a[60:63], v[68:71], v[52:55], a[60:63]
    s_waitcnt vmcnt(16)
    v_mfma_f32_16x16x32_bf16 a[0:3], v[88:91], v[72:75], a[0:3]
    v_mfma_f32_16x16x32_bf16 a[4:7], v[88:91], v[76:79], a[4:7]
    v_mfma_f32_16x16x32_bf16 a[8:11], v[88:91], v[80:83], a[8:11]
    v_mfma_f32_16x16x32_bf16 a[12:15], v[88:91], v[84:87], a[12:15]
    v_mfma_f32_16x16x32_bf16 a[16:19], v[92:95], v[72:75], a[16:19]
    v_mfma_f32_16x16x32_bf16 a[20:23], v[92:95], v[76:79], a[20:23]
    v_mfma_f32_16x16x32_bf16 a[24:27], v[92:95], v[80:83], a[24:27]
    v_mfma_f32_16x16x32_bf16 a[28:31], v[92:95], v[84:87], a[28:31]
    v_mfma_f32_16x16x32_bf16 a[32:35], v[96:99], v[72:75], a[32:35]
    v_mfma_f32_16x16x32_bf16 a[36:39], v[96:99], v[76:79], a[36:39]
    v_mfma_f32_16x16x32_bf16 a[40:43], v[96:99], v[80:83], a[40:43]
    v_mfma_f32_16x16x32_bf16 a[44:47], v[96:99], v[84:87], a[44:47]
    v_mfma_f32_16x16x32_bf16 a[48:51], v[100:103], v[72:75], a[48:51]
    v_mfma_f32_16x16x32_bf16 a[52:55], v[100:103], v[76:79], a[52:55]
    v_mfma_f32_16x16x32_bf16 a[56:59], v[100:103], v[80:83], a[56:59]
    v_mfma_f32_16x16x32_bf16 a[60:63], v[100:103], v[84:87], a[60:63]
    s_waitcnt vmcnt(8)
    v_mfma_f32_16x16x32_bf16 a[0:3], v[120:123], v[104:107], a[0:3]
    v_mfma_f32_16x16x32_bf16 a[4:7], v[120:123], v[108:111], a[4:7]
    v_mfma_f32_16x16x32_bf16 a[8:11], v[120:123], v[112:115], a[8:11]
    v_mfma_f32_16x16x32_bf16 a[12:15], v[120:123], v[116:119], a[12:15]
    v_mfma_f32_16x16x32_bf16 a[16:19], v[124:127], v[104:107], a[16:19]
    v_mfma_f32_16x16x32_bf16 a[20:23], v[124:127], v[108:111], a[20:23]
    v_mfma_f32_16x16x32_bf16 a[24:27], v[124:127], v[112:115], a[24:27]
    v_mfma_f32_16x16x32_bf16 a[28:31], v[124:127], v[116:119], a[28:31]
    v_mfma_f32_16x16x32_bf16 a[32:35], v[128:131], v[104:107], a[32:35]
    v_mfma_f32_16x16x32_bf16 a[36:39], v[128:131], v[108:111], a[36:39]
    v_mfma_f32_16x16x32_bf16 a[40:43], v[128:131], v[112:115], a[40:43]
    v_mfma_f32_16x16x32_bf16 a[44:47], v[128:131], v[116:119], a[44:47]
    v_mfma_f32_16x16x32_bf16 a[48:51], v[132:135], v[104:107], a[48:51]
    v_mfma_f32_16x16x32_bf16 a[52:55], v[132:135], v[108:111], a[52:55]
    v_mfma_f32_16x16x32_bf16 a[56:59], v[132:135], v[112:115], a[56:59]
    v_mfma_f32_16x16x32_bf16 a[60:63], v[132:135], v[116:119], a[60:63]
    s_waitcnt vmcnt(0)
    v_mfma_f32_16x16x32_bf16 a[0:3], v[152:155], v[136:139], a[0:3]
    v_mfma_f32_16x16x32_bf16 a[4:7], v[152:155], v[140:143], a[4:7]
    v_mfma_f32_16x16x32_bf16 a[8:11], v[152:155], v[144:147], a[8:11]
    v_mfma_f32_16x16x32_bf16 a[12:15], v[152:155], v[148:151], a[12:15]
    v_mfma_f32_16x16x32_bf16 a[16:19], v[156:159], v[136:139], a[16:19]
    v_mfma_f32_16x16x32_bf16 a[20:23], v[156:159], v[140:143], a[20:23]
    v_mfma_f32_16x16x32_bf16 a[24:27], v[156:159], v[144:147], a[24:27]
    v_mfma_f32_16x16x32_bf16 a[28:31], v[156:159], v[148:151], a[28:31]
    v_mfma_f32_16x16x32_bf16 a[32:35], v[160:163], v[136:139], a[32:35]
    v_mfma_f32_16x16x32_bf16 a[36:39], v[160:163], v[140:143], a[36:39]
    v_mfma_f32_16x16x32_bf16 a[40:43], v[160:163], v[144:147], a[40:43]
    v_mfma_f32_16x16x32_bf16 a[44:47], v[160:163], v[148:151], a[44:47]
    v_mfma_f32_16x16x32_bf16 a[48:51], v[164:167], v[136:139], a[48:51]
    v_mfma_f32_16x16x32_bf16 a[52:55], v[164:167], v[140:143], a[52:55]
    v_mfma_f32_16x16x32_bf16 a[56:59], v[164:167], v[144:147], a[56:59]
    v_mfma_f32_16x16x32_bf16 a[60:63], v[164:167], v[148:151], a[60:63]
    v_lshlrev_b32 v13, 4, v1
    s_lshl_b32 s6, s3, 12
    v_add_u32 v14, s6, v13
    s_lshl_b32 s7, s3, 14
    v_add_u32 v15, s7, v13
    s_nop 7
    s_nop 3
    ds_write_b128 v14, a[0:3] offset:0
    ds_write_b128 v14, a[16:19] offset:1024
    ds_write_b128 v14, a[32:35] offset:2048
    ds_write_b128 v14, a[48:51] offset:3072
    ds_write_b128 v14, a[4:7] offset:16384
    ds_write_b128 v14, a[20:23] offset:17408
    ds_write_b128 v14, a[36:39] offset:18432
    ds_write_b128 v14, a[52:55] offset:19456
    ds_write_b128 v14, a[8:11] offset:32768
    ds_write_b128 v14, a[24:27] offset:33792
    ds_write_b128 v14, a[40:43] offset:34816
    ds_write_b128 v14, a[56:59] offset:35840
    ds_write_b128 v14, a[12:15] offset:49152
    ds_write_b128 v14, a[28:31] offset:50176
    ds_write_b128 v14, a[44:47] offset:51200
    ds_write_b128 v14, a[60:63] offset:52224
    s_waitcnt lgkmcnt(0)
    s_barrier
    ds_read_b128 v[40:43], v15 offset:0
    ds_read_b128 v[44:47], v15 offset:1024
    ds_read_b128 v[48:51], v15 offset:2048
    ds_read_b128 v[52:55], v15 offset:3072
    ds_read_b128 v[56:59], v15 offset:4096
    ds_read_b128 v[60:63], v15 offset:5120
    ds_read_b128 v[64:67], v15 offset:6144
    ds_read_b128 v[68:71], v15 offset:7168
    ds_read_b128 v[72:75], v15 offset:8192
    ds_read_b128 v[76:79], v15 offset:9216
    ds_read_b128 v[80:83], v15 offset:10240
    ds_read_b128 v[84:87], v15 offset:11264
    ds_read_b128 v[88:91], v15 offset:12288
    ds_read_b128 v[92:95], v15 offset:13312
    ds_read_b128 v[96:99], v15 offset:14336
    ds_read_b128 v[100:103], v15 offset:15360
    s_waitcnt lgkmcnt(3)
    v_add_f32 v40, v40, v56
    v_add_f32 v72, v72, v88
    v_add_f32 v41, v41, v57
    v_add_f32 v73, v73, v89
    v_add_f32 v42, v42, v58
    v_add_f32 v74, v74, v90
    v_add_f32 v43, v43, v59
    v_add_f32 v75, v75, v91
    v_add_f32 v40, v40, v72
    v_add_f32 v41, v41, v73
    v_add_f32 v42, v42, v74
    v_add_f32 v43, v43, v75
    v_cvt_pk_bf16_f32 v104, v40, v41
    v_cvt_pk_bf16_f32 v105, v42, v43
    v_lshlrev_b32 v40, 16, v104
    v_and_b32 v41, 0xffff0000, v104
    v_lshlrev_b32 v42, 16, v105
    v_and_b32 v43, 0xffff0000, v105
    v_lshlrev_b32 v72, 16, v32
    v_and_b32 v73, 0xffff0000, v32
    v_lshlrev_b32 v74, 16, v33
    v_and_b32 v75, 0xffff0000, v33
    v_add_f32 v40, v40, v72
    v_add_f32 v41, v41, v73
    v_add_f32 v42, v42, v74
    v_add_f32 v43, v43, v75
    v_cvt_pk_bf16_f32 v104, v40, v41
    v_cvt_pk_bf16_f32 v105, v42, v43
    v_lshlrev_b32 v40, 16, v104
    v_and_b32 v41, 0xffff0000, v104
    v_lshlrev_b32 v42, 16, v105
    v_and_b32 v43, 0xffff0000, v105
    v_lshlrev_b32 v72, 16, v24
    v_and_b32 v73, 0xffff0000, v24
    v_lshlrev_b32 v74, 16, v25
    v_and_b32 v75, 0xffff0000, v25
    v_add_f32 v40, v40, v72
    v_add_f32 v41, v41, v73
    v_add_f32 v42, v42, v74
    v_add_f32 v43, v43, v75
    v_cvt_pk_bf16_f32 v108, v40, v41
    v_cvt_pk_bf16_f32 v109, v42, v43
    buffer_store_dwordx2 v[108:109], v16, s[68:71], s62 offen offset:0
    s_waitcnt lgkmcnt(2)
    v_add_f32 v44, v44, v60
    v_add_f32 v76, v76, v92
    v_add_f32 v45, v45, v61
    v_add_f32 v77, v77, v93
    v_add_f32 v46, v46, v62
    v_add_f32 v78, v78, v94
    v_add_f32 v47, v47, v63
    v_add_f32 v79, v79, v95
    v_add_f32 v44, v44, v76
    v_add_f32 v45, v45, v77
    v_add_f32 v46, v46, v78
    v_add_f32 v47, v47, v79
    v_cvt_pk_bf16_f32 v104, v44, v45
    v_cvt_pk_bf16_f32 v105, v46, v47
    v_lshlrev_b32 v44, 16, v104
    v_and_b32 v45, 0xffff0000, v104
    v_lshlrev_b32 v46, 16, v105
    v_and_b32 v47, 0xffff0000, v105
    v_lshlrev_b32 v76, 16, v34
    v_and_b32 v77, 0xffff0000, v34
    v_lshlrev_b32 v78, 16, v35
    v_and_b32 v79, 0xffff0000, v35
    v_add_f32 v44, v44, v76
    v_add_f32 v45, v45, v77
    v_add_f32 v46, v46, v78
    v_add_f32 v47, v47, v79
    v_cvt_pk_bf16_f32 v104, v44, v45
    v_cvt_pk_bf16_f32 v105, v46, v47
    v_lshlrev_b32 v44, 16, v104
    v_and_b32 v45, 0xffff0000, v104
    v_lshlrev_b32 v46, 16, v105
    v_and_b32 v47, 0xffff0000, v105
    v_lshlrev_b32 v76, 16, v26
    v_and_b32 v77, 0xffff0000, v26
    v_lshlrev_b32 v78, 16, v27
    v_and_b32 v79, 0xffff0000, v27
    v_add_f32 v44, v44, v76
    v_add_f32 v45, v45, v77
    v_add_f32 v46, v46, v78
    v_add_f32 v47, v47, v79
    v_cvt_pk_bf16_f32 v110, v44, v45
    v_cvt_pk_bf16_f32 v111, v46, v47
    buffer_store_dwordx2 v[110:111], v16, s[68:71], s62 offen offset:32
    s_waitcnt lgkmcnt(1)
    v_add_f32 v48, v48, v64
    v_add_f32 v80, v80, v96
    v_add_f32 v49, v49, v65
    v_add_f32 v81, v81, v97
    v_add_f32 v50, v50, v66
    v_add_f32 v82, v82, v98
    v_add_f32 v51, v51, v67
    v_add_f32 v83, v83, v99
    v_add_f32 v48, v48, v80
    v_add_f32 v49, v49, v81
    v_add_f32 v50, v50, v82
    v_add_f32 v51, v51, v83
    v_cvt_pk_bf16_f32 v104, v48, v49
    v_cvt_pk_bf16_f32 v105, v50, v51
    v_lshlrev_b32 v48, 16, v104
    v_and_b32 v49, 0xffff0000, v104
    v_lshlrev_b32 v50, 16, v105
    v_and_b32 v51, 0xffff0000, v105
    v_lshlrev_b32 v80, 16, v36
    v_and_b32 v81, 0xffff0000, v36
    v_lshlrev_b32 v82, 16, v37
    v_and_b32 v83, 0xffff0000, v37
    v_add_f32 v48, v48, v80
    v_add_f32 v49, v49, v81
    v_add_f32 v50, v50, v82
    v_add_f32 v51, v51, v83
    v_cvt_pk_bf16_f32 v104, v48, v49
    v_cvt_pk_bf16_f32 v105, v50, v51
    v_lshlrev_b32 v48, 16, v104
    v_and_b32 v49, 0xffff0000, v104
    v_lshlrev_b32 v50, 16, v105
    v_and_b32 v51, 0xffff0000, v105
    v_lshlrev_b32 v80, 16, v28
    v_and_b32 v81, 0xffff0000, v28
    v_lshlrev_b32 v82, 16, v29
    v_and_b32 v83, 0xffff0000, v29
    v_add_f32 v48, v48, v80
    v_add_f32 v49, v49, v81
    v_add_f32 v50, v50, v82
    v_add_f32 v51, v51, v83
    v_cvt_pk_bf16_f32 v108, v48, v49
    v_cvt_pk_bf16_f32 v109, v50, v51
    buffer_store_dwordx2 v[108:109], v16, s[68:71], s62 offen offset:64
    s_waitcnt lgkmcnt(0)
    v_add_f32 v52, v52, v68
    v_add_f32 v84, v84, v100
    v_add_f32 v53, v53, v69
    v_add_f32 v85, v85, v101
    v_add_f32 v54, v54, v70
    v_add_f32 v86, v86, v102
    v_add_f32 v55, v55, v71
    v_add_f32 v87, v87, v103
    v_add_f32 v52, v52, v84
    v_add_f32 v53, v53, v85
    v_add_f32 v54, v54, v86
    v_add_f32 v55, v55, v87
    v_cvt_pk_bf16_f32 v104, v52, v53
    v_cvt_pk_bf16_f32 v105, v54, v55
    v_lshlrev_b32 v52, 16, v104
    v_and_b32 v53, 0xffff0000, v104
    v_lshlrev_b32 v54, 16, v105
    v_and_b32 v55, 0xffff0000, v105
    v_lshlrev_b32 v84, 16, v38
    v_and_b32 v85, 0xffff0000, v38
    v_lshlrev_b32 v86, 16, v39
    v_and_b32 v87, 0xffff0000, v39
    v_add_f32 v52, v52, v84
    v_add_f32 v53, v53, v85
    v_add_f32 v54, v54, v86
    v_add_f32 v55, v55, v87
    v_cvt_pk_bf16_f32 v104, v52, v53
    v_cvt_pk_bf16_f32 v105, v54, v55
    v_lshlrev_b32 v52, 16, v104
    v_and_b32 v53, 0xffff0000, v104
    v_lshlrev_b32 v54, 16, v105
    v_and_b32 v55, 0xffff0000, v105
    v_lshlrev_b32 v84, 16, v30
    v_and_b32 v85, 0xffff0000, v30
    v_lshlrev_b32 v86, 16, v31
    v_and_b32 v87, 0xffff0000, v31
    v_add_f32 v52, v52, v84
    v_add_f32 v53, v53, v85
    v_add_f32 v54, v54, v86
    v_add_f32 v55, v55, v87
    v_cvt_pk_bf16_f32 v110, v52, v53
    v_cvt_pk_bf16_f32 v111, v54, v55
    buffer_store_dwordx2 v[110:111], v16, s[68:71], s62 offen offset:96
.end_k8b2_kernel_1:
    s_endpgm
.section .rodata,"a"
.p2align 6
.amdhsa_kernel k8b2_kernel
  .amdhsa_next_free_vgpr 264
  .amdhsa_next_free_sgpr 100
  .amdhsa_accum_offset 200
  .amdhsa_group_segment_fixed_size 0
  .amdhsa_kernarg_size 104
  .amdhsa_user_sgpr_count 2
  .amdhsa_user_sgpr_kernarg_segment_ptr 1
  .amdhsa_system_sgpr_workgroup_id_x 1
  .amdhsa_float_denorm_mode_32 3
.end_amdhsa_kernel
.text
```
